```python
import torch

def _softmax(x, axis=-1):
    return torch.softmax(x, dim=axis)
def _gelu(x):
    return torch.nn.functional.gelu(x, approximate="tanh")
def _silu(x):
    return torch.nn.functional.silu(x)
def _sigmoid(x):
    return torch.sigmoid(x)
def _layernorm(x, axis=-1, eps=1e-5):
    m = x.mean(dim=axis, keepdim=True)
    v = x.var(dim=axis, keepdim=True, unbiased=False)
    return (x - m) / torch.sqrt(v + eps)
def _scatter_add(tgt, idx, src, axis=0):
    return tgt.clone().index_add_(axis, idx, src)
def _segment_sum(src, seg, n):
    out = torch.zeros((n,) + src.shape[1:], dtype=src.dtype)
    return out.index_add_(0, seg, src)
def _pad(x, pw):
    flat = tuple(v for pair in reversed(pw) for v in pair)
    return torch.nn.functional.pad(x, flat)

kernel_name = 'gated_mix__grouped_kv_mqa__mixer_token_mlp__prompt'

def setup_inputs():

    _w = (lambda a: (lambda t: t.to(torch.bfloat16) if t.is_floating_point() else t)(torch.as_tensor(a)))
    def _A_setup():
        B, S, D, H = 1, 2048, 640, 32
        Dh = D // H
        return {
            "x": _w((lambda *s: torch.randn(*s, dtype=torch.bfloat16) * 0.05)(B, S, D)),
            "wq": _w((lambda *s: torch.randn(*s, dtype=torch.bfloat16) * 0.8)(D, H * Dh)),
            "wk": _w((lambda *s: torch.randn(*s, dtype=torch.bfloat16) * 0.8)(D, Dh)),
            "wv": _w((lambda *s: torch.randn(*s, dtype=torch.bfloat16) * 0.05)(D, Dh)),
            "wo": _w((lambda *s: torch.randn(*s, dtype=torch.bfloat16) * 0.05)(H * Dh, D)),
        }
    _A_in = _A_setup()

    def _B_setup():
        B, S, D, F = 1, 2048, 640, 1728
        return {
            "x": _w((lambda *s: torch.randn(*s, dtype=torch.bfloat16) * 0.05)(B, S, D)),
            "w1": _w((lambda *s: torch.randn(*s, dtype=torch.bfloat16) * 0.2)(S, F) * (S ** -0.5)),
            "b1": _w((lambda *s: torch.randn(*s, dtype=torch.bfloat16) * 3.2)(F) * 0.02),
            "w2": _w((lambda *s: torch.randn(*s, dtype=torch.bfloat16) * 0.05)(F, S) * (F ** -0.5)),
            "b2": _w((lambda *s: torch.randn(*s, dtype=torch.bfloat16) * 0.1)(S) * 0.02),
        }
    _B_in = _B_setup()

    return {
        "A_x": _A_in["x"],
        "A_wq": _A_in["wq"],
        "A_wk": _A_in["wk"],
        "A_wv": _A_in["wv"],
        "A_wo": _A_in["wo"],
        "B_x": _B_in["x"],
        "B_w1": _B_in["w1"],
        "B_b1": _B_in["b1"],
        "B_w2": _B_in["w2"],
        "B_b2": _B_in["b2"],
        "gate_w": _w((lambda *s: torch.randn(*s, dtype=torch.bfloat16) * 0.05)(640) * 16.0),
    }

def reference(A_x, A_wq, A_wk, A_wv, A_wo, B_x, B_w1, B_b1, B_w2, B_b2, gate_w):
    def _A_ref(x, wq, wk, wv, wo):
        B, S, D = x.shape
        H = 32
        Dh = D // H
        q = (lambda x, *d: x.permute(*d))((x @ wq).reshape(B, S, H, Dh), 0, 2, 1, 3)
        k = x @ wk
        v = x @ wv
        scores = torch.einsum("bhqd,bkd->bhqk", q, k) * (Dh ** -0.5)
        p = _softmax(scores, axis=-1)
        o = torch.einsum("bhqk,bkd->bhqd", p, v)
        return (lambda x, *d: x.permute(*d))(o, 0, 2, 1, 3).reshape(B, S, H * Dh) @ wo

    def _B_ref(x, w1, b1, w2, b2):
        B, S, D = x.shape
        h = _layernorm(x, axis=-1)
        u = torch.einsum("bsd,sf->bdf", h, w1) + b1
        u = _gelu(u)
        y = torch.einsum("bdf,fs->bds", u, w2) + b2
        return (lambda x, *d: x.permute(*d))(y, 0, 2, 1)

    x = A_x
    g = _sigmoid((x * gate_w).sum(-1, keepdims=True))
    a = _A_ref(x, A_wq, A_wk, A_wv, A_wo)
    b = _B_ref(x, B_w1, B_b1, B_w2, B_b2)
    return g * a + (1 - g) * b
```

```asm
; @launch grid=(256,1,1) block=(512,1,1) lds=163840
.amdgcn_target "amdgcn-amd-amdhsa--gfx950"
.text
.globl gated_mix__grouped_kv_mqa__mixer_token_mlp__prompt_kernel
.p2align 8
.type gated_mix__grouped_kv_mqa__mixer_token_mlp__prompt_kernel,@function
gated_mix__grouped_kv_mqa__mixer_token_mlp__prompt_kernel:
    s_cmpk_ge_u32 s2, 256
    s_cbranch_scc1 L_end
    s_load_dwordx16 s[4:19], s[0:1], 0
    s_load_dwordx8 s[20:27], s[0:1], 64
    s_load_dwordx4 s[28:31], s[0:1], 96
    s_getpc_b64 s[58:59]
L_pc:
    v_lshrrev_b32 v1, 6, v0
    s_andn2_b32 s54, s2, 7
    v_add_u32 v2, s54, v1
    v_lshlrev_b32 v2, 7, v2
    v_and_b32 v3, 32, v0
    v_lshl_add_u32 v2, v3, 10, v2
    v_min_u32 v2, L_last-L_pc, v2
    global_load_dword v245, v2, s[58:59]
    v_and_b32 v0, 63, v0
    v_readfirstlane_b32 s48, v1
    s_bfe_u32 s54, s2, 0x20003
    s_and_b32 s55, s2, 1
    s_lshl2_add_u32 s49, s55, s54
    s_and_b32 s55, s2, 6
    s_lshr_b32 s54, s2, 5
    s_lshl2_add_u32 s50, s55, s54
    s_add_u32 s54, s50, s49
    s_mul_i32 s55, s54, 52
    s_lshr_b32 s55, s55, 8
    s_mul_i32 s55, s55, 5
    s_sub_u32 s54, s54, s55
    s_lshl_b32 s3, s54, 8
    s_cmp_ge_u32 s48, 4
    s_cbranch_scc1 L_gemm
    s_setprio 3
    v_lshrrev_b32 v1, 4, v0
    v_and_b32 v4, 15, v0
    v_xor_b32 v9, v4, v1
    v_mul_u32_u24 v8, 1280, v1
    s_lshl_b32 s54, s48, 2
    v_xor_b32 v5, s54, v9
    v_lshl_add_u32 v2, v5, 4, v8
    s_lshr_b32 s57, s49, 1
    s_lshl2_add_u32 s55, s57, s48
    s_lshl4_add_u32 s54, s50, s55
    s_mulk_i32 s54, 5120
    s_lshl_b32 s55, s55, 10
    s_mov_b32 s38, 2621440
    s_mov_b32 s39, 0x00020000
    s_mov_b32 m0, s55
    s_add_u32 s60, s54, s3
    s_waitcnt lgkmcnt(0)
    s_mov_b64 s[36:37], s[4:5]
    buffer_load_dwordx4 v2, s[36:39], s60 offen lds
    s_add_u32 s98, s3, 256
    s_cmpk_eq_u32 s98, 1280
    s_cselect_b32 s98, 0, s98
    s_add_u32 m0, s55, 16384
    s_add_u32 s60, s54, s98
    buffer_load_dwordx4 v2, s[36:39], s60 offen lds
    s_add_u32 s99, s98, 256
    s_cmpk_eq_u32 s99, 1280
    s_cselect_b32 s99, 0, s99
    s_add_u32 m0, s55, 32768
    s_add_u32 s60, s54, s99
    buffer_load_dwordx4 v2, s[36:39], s60 offen lds
    s_add_u32 s100, s99, 256
    s_cmpk_eq_u32 s100, 1280
    s_cselect_b32 s100, 0, s100
    s_add_u32 m0, s55, 49152
    s_add_u32 s60, s54, s100
    buffer_load_dwordx4 v2, s[36:39], s60 offen lds
    s_add_u32 s101, s100, 256
    s_cmpk_eq_u32 s101, 1280
    s_cselect_b32 s101, 0, s101
    s_add_u32 m0, s55, 65536
    s_add_u32 s60, s54, s101
    buffer_load_dwordx4 v2, s[36:39], s60 offen lds
    s_load_dword s52, s[30:31], 0
    v_and_b32_e64 v7, 31, v0
    v_lshlrev_b32 v7, 3, v7
    s_mov_b64 s[44:45], s[24:25]
    s_mov_b32 s46, 1280
    s_mov_b32 s47, 0x00020000
    buffer_load_dwordx2 v[214:215], v7, s[44:47], s3 offen
    buffer_load_dwordx2 v[216:217], v7, s[44:47], s98 offen
    buffer_load_dwordx2 v[218:219], v7, s[44:47], s99 offen
    buffer_load_dwordx2 v[220:221], v7, s[44:47], s100 offen
    buffer_load_dwordx2 v[222:223], v7, s[44:47], s101 offen
    v_lshlrev_b32 v6, 4, v0
    v_lshlrev_b32 v3, 2, v0
    s_mul_i32 s59, s48, 1280
    s_mul_i32 s58, s48, 16640
    s_add_u32 s58, s58, 92672
    s_mov_b32 s42, 25600
    s_mov_b32 s43, 0x00020000
    s_bitcmp1_b32 s49, 0
    s_cselect_b64 s[40:41], s[10:11], s[8:9]
    s_add_u32 m0, s58, 0
    s_mul_i32 s60, s3, 20
    s_add_u32 s60, s60, s59
    buffer_load_dwordx4 v6, s[40:43], s60 offen lds
    buffer_load_dword v3, s[40:43], s60 offen offset:1024 lds
    s_add_u32 m0, s58, 1280
    s_mul_i32 s60, s98, 20
    s_add_u32 s60, s60, s59
    buffer_load_dwordx4 v6, s[40:43], s60 offen lds
    buffer_load_dword v3, s[40:43], s60 offen offset:1024 lds
    s_add_u32 m0, s58, 2560
    s_mul_i32 s60, s99, 20
    s_add_u32 s60, s60, s59
    buffer_load_dwordx4 v6, s[40:43], s60 offen lds
    buffer_load_dword v3, s[40:43], s60 offen offset:1024 lds
    s_add_u32 m0, s58, 3840
    s_mul_i32 s60, s100, 20
    s_add_u32 s60, s60, s59
    buffer_load_dwordx4 v6, s[40:43], s60 offen lds
    buffer_load_dword v3, s[40:43], s60 offen offset:1024 lds
    s_add_u32 m0, s58, 5120
    s_mul_i32 s60, s101, 20
    s_add_u32 s60, s60, s59
    buffer_load_dwordx4 v6, s[40:43], s60 offen lds
    buffer_load_dword v3, s[40:43], s60 offen offset:1024 lds
    s_barrier
    s_lshl3_add_u32 s51, s50, s49
    s_mov_b64 s[32:33], s[30:31]
    s_mov_b32 s34, 12582912
    s_mov_b32 s35, 0x00020000
    v_lshlrev_b32 v5, 4, v5
    v_lshl_add_u32 v11, v4, 8, v5
    s_lshl_b32 s54, s57, 12
    v_add_u32 v11, s54, v11
    v_add_u32 v12, 0x10000, v11
    v_bfe_u32 v5, v0, 2, 2
    v_lshl_add_u32 v10, v1, 3, v5
    v_mul_u32_u24 v10, 40, v10
    v_and_b32 v6, 3, v0
    v_lshl_add_u32 v10, v6, 3, v10
    v_add_u32 v10, s58, v10
    s_bitcmp1_b32 s49, 0
    s_cselect_b32 s54, 5, 9
    s_lshl_b32 s54, s54, 4
    v_mul_u32_u24 v13, s54, v4
    v_lshl_add_u32 v13, v1, 4, v13
    v_add_u32 v13, s58, v13
    s_lshl_b32 s54, s49, 2
    s_add_u32 s54, s54, s48
    s_lshl_b32 s54, s54, 1
    v_lshrrev_b32 v2, 5, v0
    v_add_u32 v8, s54, v2
    v_bfe_u32 v9, v0, 1, 4
    v_xor_b32 v9, v9, v8
    v_and_b32 v9, 15, v9
    v_lshlrev_b32 v8, 8, v8
    v_lshl_add_u32 v8, v9, 4, v8
    v_and_b32 v9, 1, v0
    v_lshl_add_u32 v234, v9, 3, v8
    v_add_u32 v235, 0x10000, v234
    s_lshl_b32 s54, s48, 1
    v_add_u32 v2, s54, v2
    v_mul_u32_u24 v8, 1344, v2
    v_add_u32 v8, v8, v7
    v_add_u32 v236, 81920, v8
    v_lshlrev_b32 v2, 2, v2
    v_add_u32 v237, 163424, v2
    v_mul_u32_u24 v8, 1344, v5
    v_lshl_add_u32 v8, v1, 5, v8
    v_lshl_add_u32 v8, v6, 3, v8
    s_mul_i32 s54, s48, 384
    s_add_u32 s54, s54, 81536
    v_add_u32 v238, s54, v8
    v_lshlrev_b32 v8, 4, v4
    v_lshl_add_u32 v239, v1, 10, v8
    v_add_u32 v253, 163328, v3
    v_mov_b32 v254, 0
    v_writelane_b32 v254, 1, 0
    s_mov_b32 s97, 0
    v_mov_b32 v241, v3
    s_waitcnt vmcnt(15) lgkmcnt(0)
    ds_add_u32 v253, v254 offset:48
    s_mul_i32 s52, s52, 0x9E3779B1
    s_add_u32 s52, s52, 0x7F4A7C15
L_wc_1:
    ds_read_b32 v252, v253 offset:48
    s_waitcnt lgkmcnt(0)
    v_readfirstlane_b32 s96, v252
    s_cmp_ge_u32 s96, 4
    s_cbranch_scc1 L_wd_2
    s_add_u32 s97, s97, 1
    s_cmp_lt_u32 s97, 1048576
    s_cbranch_scc1 L_wc_1
L_wd_2:
    ds_read_b64 v[224:225], v234 offset:0
    ds_read_b64 v[226:227], v234 offset:16384
    ds_read_b64 v[228:229], v234 offset:32768
    ds_read_b64 v[230:231], v234 offset:49152
    ds_read_b64 v[232:233], v235
    v_mov_b32 v46, 0x3f803f80
    v_mov_b32 v8, 0
    v_mov_b32 v42, 0
    s_waitcnt vmcnt(10) lgkmcnt(0)
    v_dot2c_f32_bf16 v8, v224, v46
    v_dot2c_f32_bf16 v42, v224, v214
    v_dot2c_f32_bf16 v8, v225, v46
    v_dot2c_f32_bf16 v42, v225, v215
    v_dot2c_f32_bf16 v8, v226, v46
    v_dot2c_f32_bf16 v42, v226, v216
    v_dot2c_f32_bf16 v8, v227, v46
    v_dot2c_f32_bf16 v42, v227, v217
    v_dot2c_f32_bf16 v8, v228, v46
    v_dot2c_f32_bf16 v42, v228, v218
    v_dot2c_f32_bf16 v8, v229, v46
    v_dot2c_f32_bf16 v42, v229, v219
    v_dot2c_f32_bf16 v8, v230, v46
    v_dot2c_f32_bf16 v42, v230, v220
    v_dot2c_f32_bf16 v8, v231, v46
    v_dot2c_f32_bf16 v42, v231, v221
    v_dot2c_f32_bf16 v8, v232, v46
    v_dot2c_f32_bf16 v42, v232, v222
    v_dot2c_f32_bf16 v8, v233, v46
    v_dot2c_f32_bf16 v42, v233, v223
    v_lshlrev_b32 v16, 16, v224
    v_and_b32 v17, 0xffff0000, v224
    v_lshlrev_b32 v18, 16, v225
    v_and_b32 v19, 0xffff0000, v225
    v_lshlrev_b32 v20, 16, v226
    v_and_b32 v21, 0xffff0000, v226
    v_lshlrev_b32 v22, 16, v227
    v_and_b32 v23, 0xffff0000, v227
    v_lshlrev_b32 v24, 16, v228
    v_and_b32 v25, 0xffff0000, v228
    v_add_f32_dpp v8, v8, v8 row_ror:8 row_mask:0xf bank_mask:0xf
    v_add_f32_dpp v42, v42, v42 row_ror:8 row_mask:0xf bank_mask:0xf
    v_lshlrev_b32 v26, 16, v229
    v_and_b32 v27, 0xffff0000, v229
    v_add_f32_dpp v8, v8, v8 row_ror:4 row_mask:0xf bank_mask:0xf
    v_add_f32_dpp v42, v42, v42 row_ror:4 row_mask:0xf bank_mask:0xf
    v_lshlrev_b32 v28, 16, v230
    v_and_b32 v29, 0xffff0000, v230
    v_add_f32_dpp v8, v8, v8 row_ror:2 row_mask:0xf bank_mask:0xf
    v_add_f32_dpp v42, v42, v42 row_ror:2 row_mask:0xf bank_mask:0xf
    v_lshlrev_b32 v30, 16, v231
    v_and_b32 v31, 0xffff0000, v231
    v_add_f32_dpp v8, v8, v8 row_ror:1 row_mask:0xf bank_mask:0xf
    v_add_f32_dpp v42, v42, v42 row_ror:1 row_mask:0xf bank_mask:0xf
    v_lshlrev_b32 v32, 16, v232
    v_and_b32 v33, 0xffff0000, v232
    v_mov_b32 v9, v8
    v_mov_b32 v43, v42
    v_lshlrev_b32 v34, 16, v233
    v_and_b32 v35, 0xffff0000, v233
    v_permlane16_swap_b32 v8, v9
    v_permlane16_swap_b32 v42, v43
    v_add_f32 v8, v8, v9
    v_add_f32 v42, v42, v43
    v_mul_f32 v8, 0xbacccccd, v8
    v_mul_f32 v42, 0x3fb8aa3b, v42
    v_min_f32 v42, 0x42800000, v42
    v_exp_f32 v44, v42
    s_waitcnt vmcnt(0)
    s_nop 0
    ds_read_b128 v[86:89], v11 offset:0
    ds_read_b64_tr_b16 v[106:107], v10 offset:0
    ds_read_b64_tr_b16 v[108:109], v10 offset:160
    ds_read_b64_tr_b16 v[110:111], v10 offset:32
    ds_read_b64_tr_b16 v[112:113], v10 offset:192
    ds_read_b128 v[90:93], v11 offset:16384
    ds_read_b64_tr_b16 v[114:115], v10 offset:1280
    ds_read_b64_tr_b16 v[116:117], v10 offset:1440
    ds_read_b64_tr_b16 v[118:119], v10 offset:1312
    ds_read_b64_tr_b16 v[120:121], v10 offset:1472
    ds_read_b128 v[94:97], v11 offset:32768
    ds_read_b64_tr_b16 v[122:123], v10 offset:2560
    ds_read_b64_tr_b16 v[124:125], v10 offset:2720
    ds_read_b64_tr_b16 v[126:127], v10 offset:2592
    ds_read_b64_tr_b16 v[128:129], v10 offset:2752
    ds_read_b128 v[98:101], v11 offset:49152
    ds_read_b64_tr_b16 v[130:131], v10 offset:3840
    ds_read_b64_tr_b16 v[132:133], v10 offset:4000
    ds_read_b64_tr_b16 v[134:135], v10 offset:3872
    ds_read_b64_tr_b16 v[136:137], v10 offset:4032
    ds_read_b128 v[102:105], v12
    ds_read_b64_tr_b16 v[138:139], v10 offset:5120
    ds_read_b64_tr_b16 v[140:141], v10 offset:5280
    ds_read_b64_tr_b16 v[142:143], v10 offset:5152
    ds_read_b64_tr_b16 v[144:145], v10 offset:5312
    v_pk_add_f32 v[16:17], v[16:17], v[8:9] op_sel_hi:[1,0]
    v_pk_add_f32 v[18:19], v[18:19], v[8:9] op_sel_hi:[1,0]
    v_pk_add_f32 v[20:21], v[20:21], v[8:9] op_sel_hi:[1,0]
    v_pk_add_f32 v[22:23], v[22:23], v[8:9] op_sel_hi:[1,0]
    v_pk_add_f32 v[24:25], v[24:25], v[8:9] op_sel_hi:[1,0]
    v_pk_add_f32 v[26:27], v[26:27], v[8:9] op_sel_hi:[1,0]
    v_pk_add_f32 v[28:29], v[28:29], v[8:9] op_sel_hi:[1,0]
    v_pk_add_f32 v[30:31], v[30:31], v[8:9] op_sel_hi:[1,0]
    v_pk_add_f32 v[32:33], v[32:33], v[8:9] op_sel_hi:[1,0]
    v_pk_add_f32 v[34:35], v[34:35], v[8:9] op_sel_hi:[1,0]
    v_pk_mul_f32 v[8:9], v[16:17], v[16:17]
    ds_write_b32 v237, v44
    v_pk_fma_f32 v[8:9], v[18:19], v[18:19], v[8:9]
    v_pk_fma_f32 v[8:9], v[20:21], v[20:21], v[8:9]
    v_pk_fma_f32 v[8:9], v[22:23], v[22:23], v[8:9]
    v_pk_fma_f32 v[8:9], v[24:25], v[24:25], v[8:9]
    v_pk_fma_f32 v[8:9], v[26:27], v[26:27], v[8:9]
    v_pk_fma_f32 v[8:9], v[28:29], v[28:29], v[8:9]
    v_pk_fma_f32 v[8:9], v[30:31], v[30:31], v[8:9]
    v_pk_fma_f32 v[8:9], v[32:33], v[32:33], v[8:9]
    v_pk_fma_f32 v[8:9], v[34:35], v[34:35], v[8:9]
    v_add_f32 v8, v8, v9
    v_add_u32 v36, s3, v236
    s_nop 0
    v_add_f32_dpp v8, v8, v8 row_ror:8 row_mask:0xf bank_mask:0xf
    v_add_u32 v37, s98, v236
    s_nop 0
    v_add_f32_dpp v8, v8, v8 row_ror:4 row_mask:0xf bank_mask:0xf
    v_add_u32 v38, s99, v236
    s_nop 0
    v_add_f32_dpp v8, v8, v8 row_ror:2 row_mask:0xf bank_mask:0xf
    v_add_u32 v39, s100, v236
    s_nop 0
    v_add_f32_dpp v8, v8, v8 row_ror:1 row_mask:0xf bank_mask:0xf
    v_mov_b32 v9, v8
    v_add_u32 v40, s101, v236
    s_nop 0
    v_permlane16_swap_b32 v8, v9
    v_add_f32 v8, v8, v9
    v_mul_f32 v8, 0x3acccccd, v8
    v_add_f32 v8, 0x3727c5ac, v8
    v_rsq_f32 v8, v8
    s_nop 0
    v_pk_mul_f32 v[16:17], v[16:17], v[8:9] op_sel_hi:[1,0]
    v_pk_mul_f32 v[18:19], v[18:19], v[8:9] op_sel_hi:[1,0]
    v_cvt_pk_bf16_f32 v214, v16, v17
    v_cvt_pk_bf16_f32 v215, v18, v19
    ds_write_b64 v36, v[214:215]
    v_pk_mul_f32 v[20:21], v[20:21], v[8:9] op_sel_hi:[1,0]
    v_pk_mul_f32 v[22:23], v[22:23], v[8:9] op_sel_hi:[1,0]
    v_cvt_pk_bf16_f32 v216, v20, v21
    v_cvt_pk_bf16_f32 v217, v22, v23
    ds_write_b64 v37, v[216:217]
    v_pk_mul_f32 v[24:25], v[24:25], v[8:9] op_sel_hi:[1,0]
    v_pk_mul_f32 v[26:27], v[26:27], v[8:9] op_sel_hi:[1,0]
    v_cvt_pk_bf16_f32 v218, v24, v25
    v_cvt_pk_bf16_f32 v219, v26, v27
    ds_write_b64 v38, v[218:219]
    v_pk_mul_f32 v[28:29], v[28:29], v[8:9] op_sel_hi:[1,0]
    v_pk_mul_f32 v[30:31], v[30:31], v[8:9] op_sel_hi:[1,0]
    v_cvt_pk_bf16_f32 v220, v28, v29
    v_cvt_pk_bf16_f32 v221, v30, v31
    ds_write_b64 v39, v[220:221]
    v_pk_mul_f32 v[32:33], v[32:33], v[8:9] op_sel_hi:[1,0]
    v_pk_mul_f32 v[34:35], v[34:35], v[8:9] op_sel_hi:[1,0]
    v_cvt_pk_bf16_f32 v222, v32, v33
    v_cvt_pk_bf16_f32 v223, v34, v35
    ds_write_b64 v40, v[222:223]
    ds_add_u32 v253, v254 offset:56
    s_bitcmp1_b32 s49, 0
    s_waitcnt lgkmcnt(7)
    s_cbranch_scc1 L_vpart
    s_nop 0
    v_mfma_f32_16x16x32_bf16 v[76:79], v[106:109], v[86:89], 0
    v_mfma_f32_16x16x32_bf16 v[80:83], v[110:113], v[86:89], 0
    v_mfma_f32_16x16x32_bf16 v[76:79], v[114:117], v[90:93], v[76:79]
    v_mfma_f32_16x16x32_bf16 v[80:83], v[118:121], v[90:93], v[80:83]
    v_mfma_f32_16x16x32_bf16 v[76:79], v[122:125], v[94:97], v[76:79]
    v_mfma_f32_16x16x32_bf16 v[80:83], v[126:129], v[94:97], v[80:83]
    v_mfma_f32_16x16x32_bf16 v[76:79], v[130:133], v[98:101], v[76:79]
    v_mfma_f32_16x16x32_bf16 v[80:83], v[134:137], v[98:101], v[80:83]
    v_mfma_f32_16x16x32_bf16 v[76:79], v[138:141], v[102:105], v[76:79]
    v_mfma_f32_16x16x32_bf16 v[80:83], v[142:145], v[102:105], v[80:83]
    s_nop 6
    ds_write_b128 v13, v[76:79]
    ds_write_b128 v13, v[80:83] offset:64
    s_branch L_kvpd
L_vpart:
    v_mfma_f32_16x16x32_bf16 v[76:79], v[86:89], v[106:109], 0
    v_mfma_f32_16x16x32_bf16 v[80:83], v[86:89], v[110:113], 0
    v_mfma_f32_16x16x32_bf16 v[76:79], v[90:93], v[114:117], v[76:79]
    v_mfma_f32_16x16x32_bf16 v[80:83], v[90:93], v[118:121], v[80:83]
    v_mfma_f32_16x16x32_bf16 v[76:79], v[94:97], v[122:125], v[76:79]
    v_mfma_f32_16x16x32_bf16 v[80:83], v[94:97], v[126:129], v[80:83]
    v_mfma_f32_16x16x32_bf16 v[76:79], v[98:101], v[130:133], v[76:79]
    v_mfma_f32_16x16x32_bf16 v[80:83], v[98:101], v[134:137], v[80:83]
    v_mfma_f32_16x16x32_bf16 v[76:79], v[102:105], v[138:141], v[76:79]
    v_mfma_f32_16x16x32_bf16 v[80:83], v[102:105], v[142:145], v[80:83]
    s_nop 6
    ds_write_b128 v13, v[76:79]
    ds_write_b128 v13, v[80:83] offset:1280
L_kvpd:
    ds_add_u32 v253, v254 offset:52
    s_lshl_b32 s62, s51, 7
    s_cmp_eq_u32 s48, 0
    s_cbranch_scc1 L_kvfin
    s_lshr_b32 s61, s51, 2
    s_mul_i32 s61, s61, 40960
    s_and_b32 s55, s49, 3
    s_lshl_b32 s55, s55, 8
    s_add_u32 s61, s61, s55
    s_mul_i32 s55, s48, 12288
    s_add_u32 s61, s61, s55
    s_add_u32 s61, s61, 1036288
    s_lshl_b32 s59, s51, 7
    s_add_u32 s59, s59, 163840
L_wc_3:
    ds_read_b32 v252, v253 offset:56
    s_waitcnt lgkmcnt(0)
    v_readfirstlane_b32 s96, v252
    s_cmp_ge_u32 s96, 4
    s_cbranch_scc1 L_wd_4
    s_add_u32 s97, s97, 1
    s_cmp_lt_u32 s97, 1048576
    s_cbranch_scc1 L_wc_3
L_wd_4:
    ds_read_b64_tr_b16 v[54:55], v238 offset:0
    ds_read_b64_tr_b16 v[56:57], v238 offset:5376
    ds_read_b64_tr_b16 v[58:59], v238 offset:128
    ds_read_b64_tr_b16 v[60:61], v238 offset:5504
    ds_read_b64_tr_b16 v[62:63], v238 offset:256
    ds_read_b64_tr_b16 v[64:65], v238 offset:5632
    ds_read_b64_tr_b16 v[66:67], v238 offset:384
    ds_read_b64_tr_b16 v[68:69], v238 offset:5760
    ds_read_b32 v242, v253 offset:96
    s_waitcnt lgkmcnt(0)
    s_nop 0
    buffer_store_dwordx4 v[54:57], v239, s[32:35], s61 offen sc1
    s_add_u32 s61, s61, 4096
    buffer_store_dwordx4 v[58:61], v239, s[32:35], s61 offen sc1
    s_add_u32 s61, s61, 4096
    buffer_store_dwordx4 v[62:65], v239, s[32:35], s61 offen sc1
    s_add_u32 s61, s61, 4096
    s_cmp_lg_u32 s48, 3
    s_cbranch_scc1 L_nt9
    buffer_store_dwordx4 v[66:69], v239, s[32:35], s61 offen sc1
L_nt9:
    s_cmp_lg_u32 s48, 1
    s_cbranch_scc1 L_ngs
    s_mov_b64 exec, 0xff
    buffer_store_dword v242, v241, s[32:35], s59 offen sc1
    s_mov_b64 exec, -1
L_ngs:
    s_branch L_kvflag
L_kvfin:
    s_bitcmp1_b32 s49, 0
    s_cselect_b32 s54, 31, 15
    s_cselect_b32 s55, 5, 4
    s_cselect_b32 s56, 5, 9
    s_lshl_b32 s56, s56, 4
    v_and_b32 v2, s54, v0
    v_lshrrev_b32 v3, s55, v0
    v_mul_u32_u24 v4, s56, v2
    v_lshl_add_u32 v4, v3, 5, v4
    v_add_u32 v4, 92672, v4
L_wc_5:
    ds_read_b32 v252, v253 offset:52
    s_waitcnt lgkmcnt(0)
    v_readfirstlane_b32 s96, v252
    s_cmp_ge_u32 s96, 4
    s_cbranch_scc1 L_wd_6
    s_add_u32 s97, s97, 1
    s_cmp_lt_u32 s97, 1048576
    s_cbranch_scc1 L_wc_5
L_wd_6:
    ds_read_b128 v[8:11], v4 offset:0
    ds_read_b128 v[12:15], v4 offset:16
    ds_read_b128 v[16:19], v4 offset:16640
    ds_read_b128 v[20:23], v4 offset:16656
    ds_read_b128 v[24:27], v4 offset:33280
    ds_read_b128 v[28:31], v4 offset:33296
    ds_read_b128 v[32:35], v4 offset:49920
    ds_read_b128 v[36:39], v4 offset:49936
    s_lshr_b32 s54, s51, 2
    s_mul_i32 s54, s54, 3072
    s_add_u32 s54, s54, 262144
    s_bfe_u32 s57, s49, 0x10001
    s_waitcnt lgkmcnt(0)
    v_pk_add_f32 v[8:9], v[8:9], v[16:17]
    v_pk_add_f32 v[24:25], v[24:25], v[32:33]
    v_pk_add_f32 v[10:11], v[10:11], v[18:19]
    v_pk_add_f32 v[26:27], v[26:27], v[34:35]
    v_pk_add_f32 v[12:13], v[12:13], v[20:21]
    v_pk_add_f32 v[28:29], v[28:29], v[36:37]
    v_pk_add_f32 v[14:15], v[14:15], v[22:23]
    v_pk_add_f32 v[30:31], v[30:31], v[38:39]
    v_pk_add_f32 v[8:9], v[8:9], v[24:25]
    v_pk_add_f32 v[10:11], v[10:11], v[26:27]
    v_pk_add_f32 v[12:13], v[12:13], v[28:29]
    v_pk_add_f32 v[14:15], v[14:15], v[30:31]
    v_cvt_pk_bf16_f32 v60, v8, v9
    v_cvt_pk_bf16_f32 v61, v10, v11
    v_cvt_pk_bf16_f32 v62, v12, v13
    v_cvt_pk_bf16_f32 v63, v14, v15
    s_bitcmp1_b32 s49, 0
    s_cbranch_scc1 L_vfin
    s_lshl_b32 s57, s57, 4
    v_add_u32 v2, s57, v2
    v_lshlrev_b32 v4, 4, v2
    v_lshl_add_u32 v4, v3, 9, v4
    v_and_b32 v5, 1, v3
    v_mul_u32_u24 v5, 1792, v5
    v_lshl_add_u32 v5, v2, 3, v5
    s_mov_b32 exec_hi, 0
    buffer_store_dwordx4 v[60:63], v4, s[32:35], s54 offen sc1
    s_mov_b32 exec_lo, 0
    s_mov_b32 exec_hi, 0xffff0000
    v_mov_b32 v60, 0x3f803f80
    v_mov_b32 v61, 0x00003f80
    s_mov_b32 exec_hi, -1
    buffer_store_dwordx2 v[60:61], v5, s[32:35], s54 offen offset:1024 sc1
    s_mov_b64 exec, -1
    v_mov_b32 v65, 0
    s_mov_b32 exec_hi, 0xffff
    v_fmac_f32 v65, v8, v8
    v_fmac_f32 v65, v9, v9
    v_fmac_f32 v65, v10, v10
    v_fmac_f32 v65, v11, v11
    s_mov_b32 exec_hi, 0
    v_fmac_f32 v65, v12, v12
    v_fmac_f32 v65, v13, v13
    v_fmac_f32 v65, v14, v14
    v_fmac_f32 v65, v15, v15
    s_mov_b64 exec, -1
    v_mov_b32 v22, v65
    s_nop 1
    v_permlane32_swap_b32 v65, v22
    v_add_f32 v65, v65, v22
    v_mov_b32 v22, v65
    s_nop 1
    v_permlane16_swap_b32 v65, v22
    v_add_f32 v65, v65, v22
    s_nop 1
    v_max_u32_dpp v65, v65, v65 row_ror:8 row_mask:0xf bank_mask:0xf
    s_nop 1
    v_max_u32_dpp v65, v65, v65 row_ror:4 row_mask:0xf bank_mask:0xf
    s_nop 1
    v_max_u32_dpp v65, v65, v65 row_ror:2 row_mask:0xf bank_mask:0xf
    s_nop 1
    v_max_u32_dpp v65, v65, v65 row_ror:1 row_mask:0xf bank_mask:0xf
    s_branch L_kvflag
L_vfin:
    s_mul_i32 s57, s57, 672
    s_add_u32 s54, s54, s57
    s_nop 0
    v_mul_u32_u24 v4, 336, v3
    v_lshl_add_u32 v4, v2, 4, v4
    s_mov_b32 exec_lo, 0x100000
    s_mov_b32 exec_hi, 0x100000
    v_mov_b32 v60, 0x3f803f80
    v_mov_b32 v61, 0x3f803f80
    v_mov_b32 v62, 0x3f803f80
    v_mov_b32 v63, 0x3f803f80
    s_mov_b32 exec_lo, 0x1fffff
    s_mov_b32 exec_hi, 0x1fffff
    buffer_store_dwordx4 v[60:63], v4, s[32:35], s54 offen offset:1280 sc1
    s_mov_b32 exec_lo, 0xfffff
    s_mov_b32 exec_hi, 0xfffff
    v_max3_f32 v8, |v8|, |v9|, |v10|
    v_max3_f32 v8, v8, |v11|, |v12|
    v_max3_f32 v8, v8, |v13|, |v14|
    v_max_f32_e64 v8, v8, |v15|
    v_cmp_nge_f32 vcc, 0x5d800000, v8
    s_cmp_eq_u64 vcc, 0
    s_cselect_b32 s54, 0, 0x7f800000
    v_mov_b32 v65, s54
    s_mov_b64 exec, -1
L_kvflag:
    ds_add_u32 v253, v254 offset:12
    s_setprio 0
    v_mul_u32_u24 v78, 32, v0
    v_lshlrev_b32 v1, 4, v0
    v_and_b32 v5, 31, v0
    v_lshlrev_b32 v2, 3, v5
    v_lshrrev_b32 v3, 5, v0
    v_lshl_add_u32 v2, v3, 30, v2
    v_mul_u32_u24 v3, 336, v3
    v_lshl_add_u32 v3, v5, 4, v3
    v_mov_b32 v6, 1073741824
    v_cmp_lt_u32 vcc, 20, v5
    s_mov_b32 s63, 0
    v_mov_b32 v0, 0xdddddddd
    v_mov_b32 v4, v253
    v_cndmask_b32 v3, v3, v6, vcc
    v_mov_b64 v[10:11], 0
    v_mov_b64 v[16:17], 0
    v_mov_b64 v[22:23], 0
    v_mov_b64 v[28:29], 0
    v_mov_b64 v[34:35], 0
    v_mov_b64 v[40:41], 0
    v_mov_b64 v[46:47], 0
    v_mov_b64 v[52:53], 0
    v_mov_b64 v[84:85], 0
    s_nop 1
    v_mfma_f32_32x32x8_bf16 v[86:101], v[84:85], v[84:85], 0
    v_mfma_f32_32x32x8_bf16 v[102:117], v[84:85], v[84:85], 0
    v_mfma_f32_32x32x8_bf16 v[118:133], v[84:85], v[84:85], 0
    v_mfma_f32_32x32x8_bf16 v[134:149], v[84:85], v[84:85], 0
    v_mfma_f32_32x32x8_bf16 v[150:165], v[84:85], v[84:85], 0
    v_mfma_f32_32x32x8_bf16 v[166:181], v[84:85], v[84:85], 0
    v_mfma_f32_32x32x8_bf16 v[182:197], v[84:85], v[84:85], 0
    v_mfma_f32_32x32x8_bf16 v[198:213], v[84:85], v[84:85], 0
    s_mul_i32 s4, s48, 49152
    s_add_u32 s4, s4, 262144
    s_add_u32 s5, s4, 3072
    s_add_u32 s6, s4, 6144
    s_add_u32 s7, s4, 9216
    s_add_u32 s8, s4, 12288
    s_add_u32 s9, s4, 15360
    s_add_u32 s10, s4, 18432
    s_add_u32 s11, s4, 21504
    s_add_u32 s12, s4, 24576
    s_add_u32 s13, s4, 27648
    s_add_u32 s14, s4, 30720
    s_add_u32 s15, s4, 33792
    s_add_u32 s16, s4, 36864
    s_add_u32 s17, s4, 39936
    s_add_u32 s18, s4, 43008
    s_add_u32 s19, s4, 46080
    s_add_u32 s36, s48, 1
    s_and_b32 s36, s36, 3
    s_mul_i32 s36, s36, 18432
    s_add_u32 s36, s36, 0
    s_add_u32 s37, s48, 2
    s_and_b32 s37, s37, 3
    s_mul_i32 s37, s37, 18432
    s_add_u32 s37, s37, 6144
    s_add_u32 s38, s48, 3
    s_and_b32 s38, s38, 3
    s_mul_i32 s38, s38, 18432
    s_add_u32 s38, s38, 12288
    s_mul_i32 s39, s48, 18432
    s_mul_i32 s40, s50, 81920
    s_lshr_b32 s55, s49, 1
    s_mul_i32 s55, s55, 20480
    s_add_u32 s40, s40, s55
    s_add_u32 s40, s40, 7340032
    s_and_b32 s55, s49, 1
    s_lshl_b32 s55, s55, 1
    s_lshr_b32 s56, s48, 1
    s_add_u32 s55, s55, s56
    s_and_b32 s56, s48, 1
    s_lshl_b32 s56, s56, 9
    s_add_u32 s40, s40, s56
    s_lshl_b32 s41, s55, 7
    s_add_u32 s41, s41, s40
    s_add_u32 s41, s41, 16384
    s_lshl_b32 s55, s55, 12
    s_add_u32 s40, s40, s55
    s_lshl_b32 s42, s51, 7
    s_mul_i32 s55, s48, 0
    s_add_u32 s42, s42, s55
    s_add_u32 s42, s42, 131072
    s_add_u32 s55, s48, 1
    s_and_b32 s55, s55, 3
    s_mul_i32 s55, s55, 2560
    v_add_u32 v70, s55, v1
    v_add_u32 v74, s55, v2
    s_add_u32 s55, s48, 2
    s_and_b32 s55, s55, 3
    s_mul_i32 s55, s55, 2560
    v_add_u32 v71, s55, v1
    v_add_u32 v75, s55, v2
    s_add_u32 s55, s48, 3
    s_and_b32 s55, s55, 3
    s_mul_i32 s55, s55, 2560
    v_add_u32 v72, s55, v1
    v_add_u32 v76, s55, v2
    s_add_u32 s55, s48, 4
    s_and_b32 s55, s55, 3
    s_mul_i32 s55, s55, 2560
    v_add_u32 v73, s55, v1
    v_add_u32 v77, s55, v2
    s_waitcnt vmcnt(0)
    s_setprio 3
    s_cmp_eq_u32 s48, 0
    s_cbranch_scc1 L_kvpoll
    ds_add_u32 v253, v254 offset:0
L_wc_7:
    ds_read_b32 v252, v253 offset:68
    s_waitcnt lgkmcnt(0)
    v_readfirstlane_b32 s96, v252
    s_cmp_ge_u32 s96, 1
    s_cbranch_scc1 L_wd_8
    s_sleep 1
    s_add_u32 s97, s97, 1
    s_cmp_lt_u32 s97, 1048576
    s_cbranch_scc1 L_wc_7
L_wd_8:
    buffer_load_dwordx4 v[214:217], v1, s[32:35], s4 offen sc1
    buffer_load_dwordx2 v[218:219], v2, s[32:35], s4 offen offset:1024 sc1
    buffer_load_dwordx4 v[220:223], v3, s[32:35], s4 offen offset:1280 sc1
    buffer_load_dwordx4 v[224:227], v3, s[32:35], s4 offen offset:1952 sc1
    buffer_load_dwordx4 v[228:231], v1, s[32:35], s5 offen sc1
    buffer_load_dwordx2 v[232:233], v2, s[32:35], s5 offen offset:1024 sc1
    buffer_load_dwordx4 v[234:237], v3, s[32:35], s5 offen offset:1280 sc1
    buffer_load_dwordx4 v[238:241], v3, s[32:35], s5 offen offset:1952 sc1
    s_branch L_kvd
L_kvpoll:
L_wc_9:
    ds_read_b32 v252, v253 offset:12
    s_waitcnt lgkmcnt(0)
    v_readfirstlane_b32 s96, v252
    s_cmp_ge_u32 s96, 8
    s_cbranch_scc1 L_wd_10
    s_add_u32 s97, s97, 1
    s_cmp_lt_u32 s97, 1048576
    s_cbranch_scc1 L_wc_9
L_wd_10:
L_wc_11:
    ds_read_b32 v252, v253 offset:0
    s_waitcnt lgkmcnt(0)
    v_readfirstlane_b32 s96, v252
    s_cmp_ge_u32 s96, 3
    s_cbranch_scc1 L_wd_12
    s_add_u32 s97, s97, 1
    s_cmp_lt_u32 s97, 1048576
    s_cbranch_scc1 L_wc_11
L_wd_12:
    s_mul_i32 s58, s51, 32
    s_add_u32 s58, s58, 32768
    s_mov_b64 exec, 1
    v_mov_b32 v64, s52
    buffer_store_dwordx2 v[64:65], v1, s[32:35], s58 offen sc1
    s_mov_b64 exec, -1
L_wc_13:
    ds_read_b32 v252, v253 offset:60
    s_waitcnt lgkmcnt(0)
    v_readfirstlane_b32 s96, v252
    s_cmp_ge_u32 s96, 4
    s_cbranch_scc1 L_wd_14
    s_sleep 1
    s_add_u32 s97, s97, 1
    s_cmp_lt_u32 s97, 1048576
    s_cbranch_scc1 L_wc_13
L_wd_14:
    s_mov_b32 s54, 32768
    s_mov_b32 s55, 34816
    s_mov_b32 s56, 36864
    s_mov_b32 s57, 38912
L_kp:
    buffer_load_dwordx2 v[54:55], v78, s[32:35], s54 offen sc1
    buffer_load_dwordx2 v[56:57], v78, s[32:35], s55 offen sc1
    buffer_load_dwordx2 v[58:59], v78, s[32:35], s56 offen sc1
    buffer_load_dwordx2 v[60:61], v78, s[32:35], s57 offen sc1
    s_add_u32 s97, s97, 16
    s_waitcnt vmcnt(0)
    v_xor_b32 v54, s52, v54
    v_xor_b32 v56, s52, v56
    v_xor_b32 v58, s52, v58
    v_xor_b32 v60, s52, v60
    v_or3_b32 v54, v54, v56, v58
    v_or_b32 v54, v54, v60
    v_cmp_ne_u32 vcc, 0, v54
    s_cbranch_vccz L_kpd
    s_mov_b64 exec, vcc
    s_sleep 1
    s_cmp_lt_u32 s97, 1048576
    s_cbranch_scc1 L_kp
L_kpd:
    s_mov_b64 exec, -1
    s_nop 0
    ds_add_u32 v253, v254 offset:68
    buffer_load_dwordx4 v[214:217], v1, s[32:35], s4 offen sc1
    buffer_load_dwordx2 v[218:219], v2, s[32:35], s4 offen offset:1024 sc1
    buffer_load_dwordx4 v[220:223], v3, s[32:35], s4 offen offset:1280 sc1
    buffer_load_dwordx4 v[224:227], v3, s[32:35], s4 offen offset:1952 sc1
    buffer_load_dwordx4 v[228:231], v1, s[32:35], s5 offen sc1
    buffer_load_dwordx2 v[232:233], v2, s[32:35], s5 offen offset:1024 sc1
    buffer_load_dwordx4 v[234:237], v3, s[32:35], s5 offen offset:1280 sc1
    buffer_load_dwordx4 v[238:241], v3, s[32:35], s5 offen offset:1952 sc1
    v_max3_u32 v5, v55, v57, v59
    v_max_u32 v5, v5, v61
    s_nop 1
    v_max_u32_dpp v5, v5, v5 row_ror:8 row_mask:0xf bank_mask:0xf
    s_nop 1
    v_max_u32_dpp v5, v5, v5 row_ror:4 row_mask:0xf bank_mask:0xf
    s_nop 1
    v_max_u32_dpp v5, v5, v5 row_ror:2 row_mask:0xf bank_mask:0xf
    s_nop 1
    v_max_u32_dpp v5, v5, v5 row_ror:1 row_mask:0xf bank_mask:0xf
    v_mov_b32 v252, 163328
    s_mov_b32 exec_lo, 0x10001
    s_mov_b32 exec_hi, 0x10001
    ds_max_u32 v252, v5 offset:36
    s_mov_b64 exec, -1
L_kvd:
    ds_add_u32 v253, v254 offset:76
    s_setprio 0
L_wc_15:
    ds_read_b32 v252, v253 offset:20
    s_waitcnt lgkmcnt(0)
    v_readfirstlane_b32 s96, v252
    s_cmp_ge_u32 s96, 4
    s_cbranch_scc1 L_wd_16
    s_add_u32 s97, s97, 1
    s_cmp_lt_u32 s97, 1048576
    s_cbranch_scc1 L_wc_15
L_wd_16:
    s_setprio 1
    s_mov_b32 exec_hi, 0
    s_nop 0
    ds_read_b64 v[10:11], v74 offset:1024
    ds_read_b64 v[16:17], v74 offset:2304
    ds_read_b64 v[22:23], v75 offset:1024
    ds_read_b64 v[28:29], v75 offset:2304
    ds_read_b64 v[34:35], v76 offset:1024
    ds_read_b64 v[40:41], v76 offset:2304
    ds_read_b64 v[46:47], v77 offset:1024
    ds_read_b64 v[52:53], v77 offset:2304
    s_mov_b32 exec_hi, -1
    s_nop 0
    ds_read_b128 v[6:9], v70 offset:0
    ds_read_b128 v[12:15], v70 offset:1280
    ds_read_b128 v[18:21], v71 offset:0
    ds_read_b128 v[24:27], v71 offset:1280
    ds_read_b128 v[30:33], v72 offset:0
    ds_read_b128 v[36:39], v72 offset:1280
    ds_read_b128 v[42:45], v73 offset:0
    ds_read_b128 v[48:51], v73 offset:1280
    ds_add_u32 v253, v254 offset:24
L_astart:
    s_waitcnt vmcnt(4) lgkmcnt(8)
    s_nop 0
    v_mfma_f32_32x32x16_bf16 v[54:69], v[214:217], v[6:9], 0
    v_mfma_f32_32x32x8_bf16 v[54:69], v[218:219], v[10:11], v[54:69]
    buffer_load_dwordx4 v[242:245], v1, s[32:35], s6 offen sc1
    buffer_load_dwordx2 v[246:247], v2, s[32:35], s6 offen offset:1024 sc1
    buffer_load_dwordx4 v[248:251], v3, s[32:35], s6 offen offset:1280 sc1
    buffer_load_dwordx4 v[252:255], v3, s[32:35], s6 offen offset:1952 sc1
    s_waitcnt lgkmcnt(0)
    s_nop 6
    v_exp_f32 v54, v54
    v_exp_f32 v55, v55
    v_exp_f32 v56, v56
    v_exp_f32 v57, v57
    v_mfma_f32_32x32x16_bf16 v[70:85], v[214:217], v[12:15], 0
    v_exp_f32 v58, v58
    v_exp_f32 v59, v59
    v_exp_f32 v60, v60
    v_exp_f32 v61, v61
    v_mfma_f32_32x32x8_bf16 v[70:85], v[218:219], v[16:17], v[70:85]
    v_exp_f32 v62, v62
    v_exp_f32 v63, v63
    v_exp_f32 v64, v64
    v_exp_f32 v65, v65
    v_exp_f32 v66, v66
    v_exp_f32 v67, v67
    v_exp_f32 v68, v68
    v_exp_f32 v69, v69
    v_smfmac_f32_32x32x32_bf16 v[86:101], v[220:223], v[54:61], v0
    v_exp_f32 v70, v70
    v_exp_f32 v71, v71
    v_smfmac_f32_32x32x32_bf16 v[86:101], v[224:227], v[62:69], v0
    v_exp_f32 v72, v72
    v_exp_f32 v73, v73
    v_mfma_f32_32x32x16_bf16 v[54:69], v[214:217], v[18:21], 0
    v_exp_f32 v74, v74
    v_exp_f32 v75, v75
    v_exp_f32 v76, v76
    v_exp_f32 v77, v77
    v_mfma_f32_32x32x8_bf16 v[54:69], v[218:219], v[22:23], v[54:69]
    v_exp_f32 v78, v78
    v_exp_f32 v79, v79
    v_exp_f32 v80, v80
    v_exp_f32 v81, v81
    v_exp_f32 v82, v82
    v_exp_f32 v83, v83
    v_exp_f32 v84, v84
    v_exp_f32 v85, v85
    v_smfmac_f32_32x32x32_bf16 v[102:117], v[220:223], v[70:77], v0
    v_exp_f32 v54, v54
    v_exp_f32 v55, v55
    v_smfmac_f32_32x32x32_bf16 v[102:117], v[224:227], v[78:85], v0
    v_exp_f32 v56, v56
    v_exp_f32 v57, v57
    v_mfma_f32_32x32x16_bf16 v[70:85], v[214:217], v[24:27], 0
    v_exp_f32 v58, v58
    v_exp_f32 v59, v59
    v_exp_f32 v60, v60
    v_exp_f32 v61, v61
    v_mfma_f32_32x32x8_bf16 v[70:85], v[218:219], v[28:29], v[70:85]
    v_exp_f32 v62, v62
    v_exp_f32 v63, v63
    v_exp_f32 v64, v64
    v_exp_f32 v65, v65
    v_exp_f32 v66, v66
    v_exp_f32 v67, v67
    v_exp_f32 v68, v68
    v_exp_f32 v69, v69
    v_smfmac_f32_32x32x32_bf16 v[118:133], v[220:223], v[54:61], v0
    v_exp_f32 v70, v70
    v_exp_f32 v71, v71
    v_smfmac_f32_32x32x32_bf16 v[118:133], v[224:227], v[62:69], v0
    v_exp_f32 v72, v72
    v_exp_f32 v73, v73
    v_mfma_f32_32x32x16_bf16 v[54:69], v[214:217], v[30:33], 0
    v_exp_f32 v74, v74
    v_exp_f32 v75, v75
    v_exp_f32 v76, v76
    v_exp_f32 v77, v77
    v_mfma_f32_32x32x8_bf16 v[54:69], v[218:219], v[34:35], v[54:69]
    v_exp_f32 v78, v78
    v_exp_f32 v79, v79
    v_exp_f32 v80, v80
    v_exp_f32 v81, v81
    v_exp_f32 v82, v82
    v_exp_f32 v83, v83
    v_exp_f32 v84, v84
    v_exp_f32 v85, v85
    v_smfmac_f32_32x32x32_bf16 v[134:149], v[220:223], v[70:77], v0
    v_exp_f32 v54, v54
    v_exp_f32 v55, v55
    v_smfmac_f32_32x32x32_bf16 v[134:149], v[224:227], v[78:85], v0
    v_exp_f32 v56, v56
    v_exp_f32 v57, v57
    v_mfma_f32_32x32x16_bf16 v[70:85], v[214:217], v[36:39], 0
    v_exp_f32 v58, v58
    v_exp_f32 v59, v59
    v_exp_f32 v60, v60
    v_exp_f32 v61, v61
    v_mfma_f32_32x32x8_bf16 v[70:85], v[218:219], v[40:41], v[70:85]
    v_exp_f32 v62, v62
    v_exp_f32 v63, v63
    v_exp_f32 v64, v64
    v_exp_f32 v65, v65
    v_exp_f32 v66, v66
    v_exp_f32 v67, v67
    v_exp_f32 v68, v68
    v_exp_f32 v69, v69
    v_smfmac_f32_32x32x32_bf16 v[150:165], v[220:223], v[54:61], v0
    v_exp_f32 v70, v70
    v_exp_f32 v71, v71
    v_smfmac_f32_32x32x32_bf16 v[150:165], v[224:227], v[62:69], v0
    v_exp_f32 v72, v72
    v_exp_f32 v73, v73
    v_mfma_f32_32x32x16_bf16 v[54:69], v[214:217], v[42:45], 0
    v_exp_f32 v74, v74
    v_exp_f32 v75, v75
    v_exp_f32 v76, v76
    v_exp_f32 v77, v77
    v_mfma_f32_32x32x8_bf16 v[54:69], v[218:219], v[46:47], v[54:69]
    v_exp_f32 v78, v78
    v_exp_f32 v79, v79
    v_exp_f32 v80, v80
    v_exp_f32 v81, v81
    v_exp_f32 v82, v82
    v_exp_f32 v83, v83
    v_exp_f32 v84, v84
    v_exp_f32 v85, v85
    v_smfmac_f32_32x32x32_bf16 v[166:181], v[220:223], v[70:77], v0
    v_exp_f32 v54, v54
    v_exp_f32 v55, v55
    v_smfmac_f32_32x32x32_bf16 v[166:181], v[224:227], v[78:85], v0
    v_exp_f32 v56, v56
    v_exp_f32 v57, v57
    v_mfma_f32_32x32x16_bf16 v[70:85], v[214:217], v[48:51], 0
    v_exp_f32 v58, v58
    v_exp_f32 v59, v59
    v_exp_f32 v60, v60
    v_exp_f32 v61, v61
    v_mfma_f32_32x32x8_bf16 v[70:85], v[218:219], v[52:53], v[70:85]
    v_exp_f32 v62, v62
    v_exp_f32 v63, v63
    v_exp_f32 v64, v64
    v_exp_f32 v65, v65
    v_exp_f32 v66, v66
    v_exp_f32 v67, v67
    v_exp_f32 v68, v68
    v_exp_f32 v69, v69
    v_smfmac_f32_32x32x32_bf16 v[182:197], v[220:223], v[54:61], v0
    v_exp_f32 v70, v70
    v_exp_f32 v71, v71
    v_smfmac_f32_32x32x32_bf16 v[182:197], v[224:227], v[62:69], v0
    v_exp_f32_e64 v72, v72
    v_exp_f32 v73, v73
    s_waitcnt vmcnt(4)
    v_mfma_f32_32x32x16_bf16 v[54:69], v[228:231], v[6:9], 0
    v_exp_f32 v74, v74
    v_exp_f32 v75, v75
    v_exp_f32 v76, v76
    v_exp_f32 v77, v77
    v_mfma_f32_32x32x8_bf16 v[54:69], v[232:233], v[10:11], v[54:69]
    v_exp_f32 v78, v78
    v_exp_f32 v79, v79
    v_exp_f32 v80, v80
    v_exp_f32 v81, v81
    v_exp_f32 v82, v82
    v_exp_f32 v83, v83
    v_exp_f32 v84, v84
    v_exp_f32 v85, v85
    v_smfmac_f32_32x32x32_bf16 v[198:213], v[220:223], v[70:77], v0
    v_exp_f32 v54, v54
    v_exp_f32 v55, v55
    v_smfmac_f32_32x32x32_bf16 v[198:213], v[224:227], v[78:85], v0
    buffer_load_dwordx4 v[214:217], v1, s[32:35], s7 offen sc1
    buffer_load_dwordx2 v[218:219], v2, s[32:35], s7 offen offset:1024 sc1
    buffer_load_dwordx4 v[220:223], v3, s[32:35], s7 offen offset:1280 sc1
    buffer_load_dwordx4 v[224:227], v3, s[32:35], s7 offen offset:1952 sc1
    v_exp_f32 v56, v56
    v_exp_f32 v57, v57
    v_mfma_f32_32x32x16_bf16 v[70:85], v[228:231], v[12:15], 0
    v_exp_f32 v58, v58
    v_exp_f32 v59, v59
    v_exp_f32 v60, v60
    v_exp_f32 v61, v61
    v_mfma_f32_32x32x8_bf16 v[70:85], v[232:233], v[16:17], v[70:85]
    v_exp_f32 v62, v62
    v_exp_f32 v63, v63
    v_exp_f32 v64, v64
    v_exp_f32 v65, v65
    v_exp_f32 v66, v66
    v_exp_f32 v67, v67
    v_exp_f32 v68, v68
    v_exp_f32 v69, v69
    v_smfmac_f32_32x32x32_bf16 v[86:101], v[234:237], v[54:61], v0
    v_exp_f32 v70, v70
    v_exp_f32 v71, v71
    v_smfmac_f32_32x32x32_bf16 v[86:101], v[238:241], v[62:69], v0
    v_exp_f32 v72, v72
    v_exp_f32 v73, v73
    v_mfma_f32_32x32x16_bf16 v[54:69], v[228:231], v[18:21], 0
    v_exp_f32 v74, v74
    v_exp_f32 v75, v75
    v_exp_f32 v76, v76
    v_exp_f32 v77, v77
    v_mfma_f32_32x32x8_bf16 v[54:69], v[232:233], v[22:23], v[54:69]
    v_exp_f32 v78, v78
    v_exp_f32 v79, v79
    v_exp_f32 v80, v80
    v_exp_f32 v81, v81
    v_exp_f32 v82, v82
    v_exp_f32 v83, v83
    v_exp_f32 v84, v84
    v_exp_f32 v85, v85
    v_smfmac_f32_32x32x32_bf16 v[102:117], v[234:237], v[70:77], v0
    v_exp_f32 v54, v54
    v_exp_f32 v55, v55
    v_smfmac_f32_32x32x32_bf16 v[102:117], v[238:241], v[78:85], v0
    v_exp_f32 v56, v56
    v_exp_f32 v57, v57
    v_mfma_f32_32x32x16_bf16 v[70:85], v[228:231], v[24:27], 0
    v_exp_f32 v58, v58
    v_exp_f32 v59, v59
    v_exp_f32 v60, v60
    v_exp_f32 v61, v61
    v_mfma_f32_32x32x8_bf16 v[70:85], v[232:233], v[28:29], v[70:85]
    v_exp_f32 v62, v62
    v_exp_f32 v63, v63
    v_exp_f32 v64, v64
    v_exp_f32 v65, v65
    v_exp_f32 v66, v66
    v_exp_f32 v67, v67
    v_exp_f32 v68, v68
    v_exp_f32 v69, v69
    v_smfmac_f32_32x32x32_bf16 v[118:133], v[234:237], v[54:61], v0
    v_exp_f32 v70, v70
    v_exp_f32 v71, v71
    v_smfmac_f32_32x32x32_bf16 v[118:133], v[238:241], v[62:69], v0
    v_exp_f32 v72, v72
    v_exp_f32 v73, v73
    v_mfma_f32_32x32x16_bf16 v[54:69], v[228:231], v[30:33], 0
    v_exp_f32 v74, v74
    v_exp_f32 v75, v75
    v_exp_f32 v76, v76
    v_exp_f32 v77, v77
    v_mfma_f32_32x32x8_bf16 v[54:69], v[232:233], v[34:35], v[54:69]
    v_exp_f32 v78, v78
    v_exp_f32 v79, v79
    v_exp_f32 v80, v80
    v_exp_f32 v81, v81
    v_exp_f32 v82, v82
    v_exp_f32 v83, v83
    v_exp_f32 v84, v84
    v_exp_f32 v85, v85
    v_smfmac_f32_32x32x32_bf16 v[134:149], v[234:237], v[70:77], v0
    v_exp_f32 v54, v54
    v_exp_f32 v55, v55
    v_smfmac_f32_32x32x32_bf16 v[134:149], v[238:241], v[78:85], v0
    v_exp_f32 v56, v56
    v_exp_f32 v57, v57
    v_mfma_f32_32x32x16_bf16 v[70:85], v[228:231], v[36:39], 0
    v_exp_f32 v58, v58
    v_exp_f32 v59, v59
    v_exp_f32 v60, v60
    v_exp_f32 v61, v61
    v_mfma_f32_32x32x8_bf16 v[70:85], v[232:233], v[40:41], v[70:85]
    v_exp_f32 v62, v62
    v_exp_f32 v63, v63
    v_exp_f32 v64, v64
    v_exp_f32 v65, v65
    v_exp_f32 v66, v66
    v_exp_f32 v67, v67
    v_exp_f32 v68, v68
    v_exp_f32 v69, v69
    v_smfmac_f32_32x32x32_bf16 v[150:165], v[234:237], v[54:61], v0
    v_exp_f32 v70, v70
    v_exp_f32 v71, v71
    v_smfmac_f32_32x32x32_bf16 v[150:165], v[238:241], v[62:69], v0
    v_exp_f32 v72, v72
    v_exp_f32 v73, v73
    v_mfma_f32_32x32x16_bf16 v[54:69], v[228:231], v[42:45], 0
    v_exp_f32 v74, v74
    v_exp_f32 v75, v75
    v_exp_f32 v76, v76
    v_exp_f32 v77, v77
    v_mfma_f32_32x32x8_bf16 v[54:69], v[232:233], v[46:47], v[54:69]
    v_exp_f32 v78, v78
    v_exp_f32 v79, v79
    v_exp_f32 v80, v80
    v_exp_f32 v81, v81
    v_exp_f32 v82, v82
    v_exp_f32 v83, v83
    v_exp_f32 v84, v84
    v_exp_f32 v85, v85
    v_smfmac_f32_32x32x32_bf16 v[166:181], v[234:237], v[70:77], v0
    v_exp_f32 v54, v54
    v_exp_f32 v55, v55
    v_smfmac_f32_32x32x32_bf16 v[166:181], v[238:241], v[78:85], v0
    v_exp_f32 v56, v56
    v_exp_f32 v57, v57
    v_mfma_f32_32x32x16_bf16 v[70:85], v[228:231], v[48:51], 0
    v_exp_f32 v58, v58
    v_exp_f32 v59, v59
    v_exp_f32 v60, v60
    v_exp_f32 v61, v61
    v_mfma_f32_32x32x8_bf16 v[70:85], v[232:233], v[52:53], v[70:85]
    v_exp_f32 v62, v62
    v_exp_f32 v63, v63
    v_exp_f32 v64, v64
    v_exp_f32 v65, v65
    v_exp_f32 v66, v66
    v_exp_f32 v67, v67
    v_exp_f32 v68, v68
    v_exp_f32 v69, v69
    v_smfmac_f32_32x32x32_bf16 v[182:197], v[234:237], v[54:61], v0
    v_exp_f32 v70, v70
    v_exp_f32 v71, v71
    v_smfmac_f32_32x32x32_bf16 v[182:197], v[238:241], v[62:69], v0
    v_exp_f32_e64 v72, v72
    v_exp_f32 v73, v73
    s_waitcnt vmcnt(4)
    v_mfma_f32_32x32x16_bf16 v[54:69], v[242:245], v[6:9], 0
    v_exp_f32 v74, v74
    v_exp_f32 v75, v75
    v_exp_f32 v76, v76
    v_exp_f32 v77, v77
    v_mfma_f32_32x32x8_bf16 v[54:69], v[246:247], v[10:11], v[54:69]
    v_exp_f32 v78, v78
    v_exp_f32 v79, v79
    v_exp_f32 v80, v80
    v_exp_f32 v81, v81
    v_exp_f32 v82, v82
    v_exp_f32 v83, v83
    v_exp_f32 v84, v84
    v_exp_f32 v85, v85
    v_smfmac_f32_32x32x32_bf16 v[198:213], v[234:237], v[70:77], v0
    v_exp_f32 v54, v54
    v_exp_f32 v55, v55
    v_smfmac_f32_32x32x32_bf16 v[198:213], v[238:241], v[78:85], v0
    buffer_load_dwordx4 v[228:231], v1, s[32:35], s8 offen sc1
    buffer_load_dwordx2 v[232:233], v2, s[32:35], s8 offen offset:1024 sc1
    buffer_load_dwordx4 v[234:237], v3, s[32:35], s8 offen offset:1280 sc1
    buffer_load_dwordx4 v[238:241], v3, s[32:35], s8 offen offset:1952 sc1
    v_exp_f32 v56, v56
    v_exp_f32 v57, v57
    v_mfma_f32_32x32x16_bf16 v[70:85], v[242:245], v[12:15], 0
    v_exp_f32 v58, v58
    v_exp_f32 v59, v59
    v_exp_f32 v60, v60
    v_exp_f32 v61, v61
    v_mfma_f32_32x32x8_bf16 v[70:85], v[246:247], v[16:17], v[70:85]
    v_exp_f32 v62, v62
    v_exp_f32 v63, v63
    v_exp_f32 v64, v64
    v_exp_f32 v65, v65
    v_exp_f32 v66, v66
    v_exp_f32 v67, v67
    v_exp_f32 v68, v68
    v_exp_f32 v69, v69
    v_smfmac_f32_32x32x32_bf16 v[86:101], v[248:251], v[54:61], v0
    v_exp_f32 v70, v70
    v_exp_f32 v71, v71
    v_smfmac_f32_32x32x32_bf16 v[86:101], v[252:255], v[62:69], v0
    v_exp_f32 v72, v72
    v_exp_f32 v73, v73
    v_mfma_f32_32x32x16_bf16 v[54:69], v[242:245], v[18:21], 0
    v_exp_f32 v74, v74
    v_exp_f32 v75, v75
    v_exp_f32 v76, v76
    v_exp_f32 v77, v77
    v_mfma_f32_32x32x8_bf16 v[54:69], v[246:247], v[22:23], v[54:69]
    v_exp_f32 v78, v78
    v_exp_f32 v79, v79
    v_exp_f32 v80, v80
    v_exp_f32 v81, v81
    v_exp_f32 v82, v82
    v_exp_f32 v83, v83
    v_exp_f32 v84, v84
    v_exp_f32 v85, v85
    v_smfmac_f32_32x32x32_bf16 v[102:117], v[248:251], v[70:77], v0
    v_exp_f32 v54, v54
    v_exp_f32 v55, v55
    v_smfmac_f32_32x32x32_bf16 v[102:117], v[252:255], v[78:85], v0
    v_exp_f32 v56, v56
    v_exp_f32 v57, v57
    v_mfma_f32_32x32x16_bf16 v[70:85], v[242:245], v[24:27], 0
    v_exp_f32 v58, v58
    v_exp_f32 v59, v59
    v_exp_f32 v60, v60
    v_exp_f32 v61, v61
    v_mfma_f32_32x32x8_bf16 v[70:85], v[246:247], v[28:29], v[70:85]
    v_exp_f32 v62, v62
    v_exp_f32 v63, v63
    v_exp_f32 v64, v64
    v_exp_f32 v65, v65
    v_exp_f32 v66, v66
    v_exp_f32 v67, v67
    v_exp_f32 v68, v68
    v_exp_f32 v69, v69
    v_smfmac_f32_32x32x32_bf16 v[118:133], v[248:251], v[54:61], v0
    v_exp_f32 v70, v70
    v_exp_f32 v71, v71
    v_smfmac_f32_32x32x32_bf16 v[118:133], v[252:255], v[62:69], v0
    v_exp_f32 v72, v72
    v_exp_f32 v73, v73
    v_mfma_f32_32x32x16_bf16 v[54:69], v[242:245], v[30:33], 0
    v_exp_f32 v74, v74
    v_exp_f32 v75, v75
    v_exp_f32 v76, v76
    v_exp_f32 v77, v77
    v_mfma_f32_32x32x8_bf16 v[54:69], v[246:247], v[34:35], v[54:69]
    v_exp_f32 v78, v78
    v_exp_f32 v79, v79
    v_exp_f32 v80, v80
    v_exp_f32 v81, v81
    v_exp_f32 v82, v82
    v_exp_f32 v83, v83
    v_exp_f32 v84, v84
    v_exp_f32 v85, v85
    v_smfmac_f32_32x32x32_bf16 v[134:149], v[248:251], v[70:77], v0
    v_exp_f32 v54, v54
    v_exp_f32 v55, v55
    v_smfmac_f32_32x32x32_bf16 v[134:149], v[252:255], v[78:85], v0
    v_exp_f32 v56, v56
    v_exp_f32 v57, v57
    v_mfma_f32_32x32x16_bf16 v[70:85], v[242:245], v[36:39], 0
    v_exp_f32 v58, v58
    v_exp_f32 v59, v59
    v_exp_f32 v60, v60
    v_exp_f32 v61, v61
    v_mfma_f32_32x32x8_bf16 v[70:85], v[246:247], v[40:41], v[70:85]
    v_exp_f32 v62, v62
    v_exp_f32 v63, v63
    v_exp_f32 v64, v64
    v_exp_f32 v65, v65
    v_exp_f32 v66, v66
    v_exp_f32 v67, v67
    v_exp_f32 v68, v68
    v_exp_f32 v69, v69
    v_smfmac_f32_32x32x32_bf16 v[150:165], v[248:251], v[54:61], v0
    v_exp_f32 v70, v70
    v_exp_f32 v71, v71
    v_smfmac_f32_32x32x32_bf16 v[150:165], v[252:255], v[62:69], v0
    v_exp_f32 v72, v72
    v_exp_f32 v73, v73
    v_mfma_f32_32x32x16_bf16 v[54:69], v[242:245], v[42:45], 0
    v_exp_f32 v74, v74
    v_exp_f32 v75, v75
    v_exp_f32 v76, v76
    v_exp_f32 v77, v77
    v_mfma_f32_32x32x8_bf16 v[54:69], v[246:247], v[46:47], v[54:69]
    v_exp_f32 v78, v78
    v_exp_f32 v79, v79
    v_exp_f32 v80, v80
    v_exp_f32 v81, v81
    v_exp_f32 v82, v82
    v_exp_f32 v83, v83
    v_exp_f32 v84, v84
    v_exp_f32 v85, v85
    v_smfmac_f32_32x32x32_bf16 v[166:181], v[248:251], v[70:77], v0
    v_exp_f32 v54, v54
    v_exp_f32 v55, v55
    v_smfmac_f32_32x32x32_bf16 v[166:181], v[252:255], v[78:85], v0
    v_exp_f32 v56, v56
    v_exp_f32 v57, v57
    v_mfma_f32_32x32x16_bf16 v[70:85], v[242:245], v[48:51], 0
    v_exp_f32 v58, v58
    v_exp_f32 v59, v59
    v_exp_f32 v60, v60
    v_exp_f32 v61, v61
    v_mfma_f32_32x32x8_bf16 v[70:85], v[246:247], v[52:53], v[70:85]
    v_exp_f32 v62, v62
    v_exp_f32 v63, v63
    v_exp_f32 v64, v64
    v_exp_f32 v65, v65
    v_exp_f32 v66, v66
    v_exp_f32 v67, v67
    v_exp_f32 v68, v68
    v_exp_f32 v69, v69
    v_smfmac_f32_32x32x32_bf16 v[182:197], v[248:251], v[54:61], v0
    v_exp_f32 v70, v70
    v_exp_f32 v71, v71
    v_smfmac_f32_32x32x32_bf16 v[182:197], v[252:255], v[62:69], v0
    v_exp_f32_e64 v72, v72
    v_exp_f32 v73, v73
    s_waitcnt vmcnt(4)
    v_mfma_f32_32x32x16_bf16 v[54:69], v[214:217], v[6:9], 0
    v_exp_f32 v74, v74
    v_exp_f32 v75, v75
    v_exp_f32 v76, v76
    v_exp_f32 v77, v77
    v_mfma_f32_32x32x8_bf16 v[54:69], v[218:219], v[10:11], v[54:69]
    v_exp_f32 v78, v78
    v_exp_f32 v79, v79
    v_exp_f32 v80, v80
    v_exp_f32 v81, v81
    v_exp_f32 v82, v82
    v_exp_f32 v83, v83
    v_exp_f32 v84, v84
    v_exp_f32 v85, v85
    v_smfmac_f32_32x32x32_bf16 v[198:213], v[248:251], v[70:77], v0
    v_exp_f32 v54, v54
    v_exp_f32 v55, v55
    v_smfmac_f32_32x32x32_bf16 v[198:213], v[252:255], v[78:85], v0
    buffer_load_dwordx4 v[242:245], v1, s[32:35], s9 offen sc1
    buffer_load_dwordx2 v[246:247], v2, s[32:35], s9 offen offset:1024 sc1
    buffer_load_dwordx4 v[248:251], v3, s[32:35], s9 offen offset:1280 sc1
    buffer_load_dwordx4 v[252:255], v3, s[32:35], s9 offen offset:1952 sc1
    v_exp_f32 v56, v56
    v_exp_f32 v57, v57
    v_mfma_f32_32x32x16_bf16 v[70:85], v[214:217], v[12:15], 0
    v_exp_f32 v58, v58
    v_exp_f32 v59, v59
    v_exp_f32 v60, v60
    v_exp_f32 v61, v61
    v_mfma_f32_32x32x8_bf16 v[70:85], v[218:219], v[16:17], v[70:85]
    v_exp_f32 v62, v62
    v_exp_f32 v63, v63
    v_exp_f32 v64, v64
    v_exp_f32 v65, v65
    v_exp_f32 v66, v66
    v_exp_f32 v67, v67
    v_exp_f32 v68, v68
    v_exp_f32 v69, v69
    v_smfmac_f32_32x32x32_bf16 v[86:101], v[220:223], v[54:61], v0
    v_exp_f32 v70, v70
    v_exp_f32 v71, v71
    v_smfmac_f32_32x32x32_bf16 v[86:101], v[224:227], v[62:69], v0
    v_exp_f32 v72, v72
    v_exp_f32 v73, v73
    v_mfma_f32_32x32x16_bf16 v[54:69], v[214:217], v[18:21], 0
    v_exp_f32 v74, v74
    v_exp_f32 v75, v75
    v_exp_f32 v76, v76
    v_exp_f32 v77, v77
    v_mfma_f32_32x32x8_bf16 v[54:69], v[218:219], v[22:23], v[54:69]
    v_exp_f32 v78, v78
    v_exp_f32 v79, v79
    v_exp_f32 v80, v80
    v_exp_f32 v81, v81
    v_exp_f32 v82, v82
    v_exp_f32 v83, v83
    v_exp_f32 v84, v84
    v_exp_f32 v85, v85
    v_smfmac_f32_32x32x32_bf16 v[102:117], v[220:223], v[70:77], v0
    v_exp_f32 v54, v54
    v_exp_f32 v55, v55
    v_smfmac_f32_32x32x32_bf16 v[102:117], v[224:227], v[78:85], v0
    v_exp_f32 v56, v56
    v_exp_f32 v57, v57
    v_mfma_f32_32x32x16_bf16 v[70:85], v[214:217], v[24:27], 0
    v_exp_f32 v58, v58
    v_exp_f32 v59, v59
    v_exp_f32 v60, v60
    v_exp_f32 v61, v61
    v_mfma_f32_32x32x8_bf16 v[70:85], v[218:219], v[28:29], v[70:85]
    v_exp_f32 v62, v62
    v_exp_f32 v63, v63
    v_exp_f32 v64, v64
    v_exp_f32 v65, v65
    v_exp_f32 v66, v66
    v_exp_f32 v67, v67
    v_exp_f32 v68, v68
    v_exp_f32 v69, v69
    v_smfmac_f32_32x32x32_bf16 v[118:133], v[220:223], v[54:61], v0
    v_exp_f32 v70, v70
    v_exp_f32 v71, v71
    v_smfmac_f32_32x32x32_bf16 v[118:133], v[224:227], v[62:69], v0
    v_exp_f32 v72, v72
    v_exp_f32 v73, v73
    v_mfma_f32_32x32x16_bf16 v[54:69], v[214:217], v[30:33], 0
    v_exp_f32 v74, v74
    v_exp_f32 v75, v75
    v_exp_f32 v76, v76
    v_exp_f32 v77, v77
    v_mfma_f32_32x32x8_bf16 v[54:69], v[218:219], v[34:35], v[54:69]
    v_exp_f32 v78, v78
    v_exp_f32 v79, v79
    v_exp_f32 v80, v80
    v_exp_f32 v81, v81
    v_exp_f32 v82, v82
    v_exp_f32 v83, v83
    v_exp_f32 v84, v84
    v_exp_f32 v85, v85
    v_smfmac_f32_32x32x32_bf16 v[134:149], v[220:223], v[70:77], v0
    v_exp_f32 v54, v54
    v_exp_f32 v55, v55
    v_smfmac_f32_32x32x32_bf16 v[134:149], v[224:227], v[78:85], v0
    v_exp_f32 v56, v56
    v_exp_f32 v57, v57
    v_mfma_f32_32x32x16_bf16 v[70:85], v[214:217], v[36:39], 0
    v_exp_f32 v58, v58
    v_exp_f32 v59, v59
    v_exp_f32 v60, v60
    v_exp_f32 v61, v61
    v_mfma_f32_32x32x8_bf16 v[70:85], v[218:219], v[40:41], v[70:85]
    v_exp_f32 v62, v62
    v_exp_f32 v63, v63
    v_exp_f32 v64, v64
    v_exp_f32 v65, v65
    v_exp_f32 v66, v66
    v_exp_f32 v67, v67
    v_exp_f32 v68, v68
    v_exp_f32 v69, v69
    v_smfmac_f32_32x32x32_bf16 v[150:165], v[220:223], v[54:61], v0
    v_exp_f32 v70, v70
    v_exp_f32 v71, v71
    v_smfmac_f32_32x32x32_bf16 v[150:165], v[224:227], v[62:69], v0
    v_exp_f32 v72, v72
    v_exp_f32 v73, v73
    v_mfma_f32_32x32x16_bf16 v[54:69], v[214:217], v[42:45], 0
    v_exp_f32 v74, v74
    v_exp_f32 v75, v75
    v_exp_f32 v76, v76
    v_exp_f32 v77, v77
    v_mfma_f32_32x32x8_bf16 v[54:69], v[218:219], v[46:47], v[54:69]
    v_exp_f32 v78, v78
    v_exp_f32 v79, v79
    v_exp_f32 v80, v80
    v_exp_f32 v81, v81
    v_exp_f32 v82, v82
    v_exp_f32 v83, v83
    v_exp_f32 v84, v84
    v_exp_f32 v85, v85
    v_smfmac_f32_32x32x32_bf16 v[166:181], v[220:223], v[70:77], v0
    v_exp_f32 v54, v54
    v_exp_f32 v55, v55
    v_smfmac_f32_32x32x32_bf16 v[166:181], v[224:227], v[78:85], v0
    v_exp_f32 v56, v56
    v_exp_f32 v57, v57
    v_mfma_f32_32x32x16_bf16 v[70:85], v[214:217], v[48:51], 0
    v_exp_f32 v58, v58
    v_exp_f32 v59, v59
    v_exp_f32 v60, v60
    v_exp_f32 v61, v61
    v_mfma_f32_32x32x8_bf16 v[70:85], v[218:219], v[52:53], v[70:85]
    v_exp_f32 v62, v62
    v_exp_f32 v63, v63
    v_exp_f32 v64, v64
    v_exp_f32 v65, v65
    v_exp_f32 v66, v66
    v_exp_f32 v67, v67
    v_exp_f32 v68, v68
    v_exp_f32 v69, v69
    v_smfmac_f32_32x32x32_bf16 v[182:197], v[220:223], v[54:61], v0
    v_exp_f32 v70, v70
    v_exp_f32 v71, v71
    v_smfmac_f32_32x32x32_bf16 v[182:197], v[224:227], v[62:69], v0
    v_exp_f32_e64 v72, v72
    v_exp_f32 v73, v73
    s_waitcnt vmcnt(4)
    v_mfma_f32_32x32x16_bf16 v[54:69], v[228:231], v[6:9], 0
    v_exp_f32 v74, v74
    v_exp_f32 v75, v75
    v_exp_f32 v76, v76
    v_exp_f32 v77, v77
    v_mfma_f32_32x32x8_bf16 v[54:69], v[232:233], v[10:11], v[54:69]
    v_exp_f32 v78, v78
    v_exp_f32 v79, v79
    v_exp_f32 v80, v80
    v_exp_f32 v81, v81
    v_exp_f32 v82, v82
    v_exp_f32 v83, v83
    v_exp_f32 v84, v84
    v_exp_f32 v85, v85
    v_smfmac_f32_32x32x32_bf16 v[198:213], v[220:223], v[70:77], v0
    v_exp_f32 v54, v54
    v_exp_f32 v55, v55
    v_smfmac_f32_32x32x32_bf16 v[198:213], v[224:227], v[78:85], v0
    buffer_load_dwordx4 v[214:217], v1, s[32:35], s10 offen sc1
    buffer_load_dwordx2 v[218:219], v2, s[32:35], s10 offen offset:1024 sc1
    buffer_load_dwordx4 v[220:223], v3, s[32:35], s10 offen offset:1280 sc1
    buffer_load_dwordx4 v[224:227], v3, s[32:35], s10 offen offset:1952 sc1
    v_exp_f32 v56, v56
    v_exp_f32 v57, v57
    v_mfma_f32_32x32x16_bf16 v[70:85], v[228:231], v[12:15], 0
    v_exp_f32 v58, v58
    v_exp_f32 v59, v59
    v_exp_f32 v60, v60
    v_exp_f32 v61, v61
    v_mfma_f32_32x32x8_bf16 v[70:85], v[232:233], v[16:17], v[70:85]
    v_exp_f32 v62, v62
    v_exp_f32 v63, v63
    v_exp_f32 v64, v64
    v_exp_f32 v65, v65
    v_exp_f32 v66, v66
    v_exp_f32 v67, v67
    v_exp_f32 v68, v68
    v_exp_f32 v69, v69
    v_smfmac_f32_32x32x32_bf16 v[86:101], v[234:237], v[54:61], v0
    v_exp_f32 v70, v70
    v_exp_f32 v71, v71
    v_smfmac_f32_32x32x32_bf16 v[86:101], v[238:241], v[62:69], v0
    v_exp_f32 v72, v72
    v_exp_f32 v73, v73
    v_mfma_f32_32x32x16_bf16 v[54:69], v[228:231], v[18:21], 0
    v_exp_f32 v74, v74
    v_exp_f32 v75, v75
    v_exp_f32 v76, v76
    v_exp_f32 v77, v77
    v_mfma_f32_32x32x8_bf16 v[54:69], v[232:233], v[22:23], v[54:69]
    v_exp_f32 v78, v78
    v_exp_f32 v79, v79
    v_exp_f32 v80, v80
    v_exp_f32 v81, v81
    v_exp_f32 v82, v82
    v_exp_f32 v83, v83
    v_exp_f32 v84, v84
    v_exp_f32 v85, v85
    v_smfmac_f32_32x32x32_bf16 v[102:117], v[234:237], v[70:77], v0
    v_exp_f32 v54, v54
    v_exp_f32 v55, v55
    v_smfmac_f32_32x32x32_bf16 v[102:117], v[238:241], v[78:85], v0
    v_exp_f32 v56, v56
    v_exp_f32 v57, v57
    v_mfma_f32_32x32x16_bf16 v[70:85], v[228:231], v[24:27], 0
    v_exp_f32 v58, v58
    v_exp_f32 v59, v59
    v_exp_f32 v60, v60
    v_exp_f32 v61, v61
    v_mfma_f32_32x32x8_bf16 v[70:85], v[232:233], v[28:29], v[70:85]
    v_exp_f32 v62, v62
    v_exp_f32 v63, v63
    v_exp_f32 v64, v64
    v_exp_f32 v65, v65
    v_exp_f32 v66, v66
    v_exp_f32 v67, v67
    v_exp_f32 v68, v68
    v_exp_f32 v69, v69
    v_smfmac_f32_32x32x32_bf16 v[118:133], v[234:237], v[54:61], v0
    v_exp_f32 v70, v70
    v_exp_f32 v71, v71
    v_smfmac_f32_32x32x32_bf16 v[118:133], v[238:241], v[62:69], v0
    v_exp_f32 v72, v72
    v_exp_f32 v73, v73
    v_mfma_f32_32x32x16_bf16 v[54:69], v[228:231], v[30:33], 0
    v_exp_f32 v74, v74
    v_exp_f32 v75, v75
    v_exp_f32 v76, v76
    v_exp_f32 v77, v77
    v_mfma_f32_32x32x8_bf16 v[54:69], v[232:233], v[34:35], v[54:69]
    v_exp_f32 v78, v78
    v_exp_f32 v79, v79
    v_exp_f32 v80, v80
    v_exp_f32 v81, v81
    v_exp_f32 v82, v82
    v_exp_f32 v83, v83
    v_exp_f32 v84, v84
    v_exp_f32 v85, v85
    v_smfmac_f32_32x32x32_bf16 v[134:149], v[234:237], v[70:77], v0
    v_exp_f32 v54, v54
    v_exp_f32 v55, v55
    v_smfmac_f32_32x32x32_bf16 v[134:149], v[238:241], v[78:85], v0
    v_exp_f32 v56, v56
    v_exp_f32 v57, v57
    v_mfma_f32_32x32x16_bf16 v[70:85], v[228:231], v[36:39], 0
    v_exp_f32 v58, v58
    v_exp_f32 v59, v59
    v_exp_f32 v60, v60
    v_exp_f32 v61, v61
    v_mfma_f32_32x32x8_bf16 v[70:85], v[232:233], v[40:41], v[70:85]
    v_exp_f32 v62, v62
    v_exp_f32 v63, v63
    v_exp_f32 v64, v64
    v_exp_f32 v65, v65
    v_exp_f32 v66, v66
    v_exp_f32 v67, v67
    v_exp_f32 v68, v68
    v_exp_f32 v69, v69
    v_smfmac_f32_32x32x32_bf16 v[150:165], v[234:237], v[54:61], v0
    v_exp_f32 v70, v70
    v_exp_f32 v71, v71
    v_smfmac_f32_32x32x32_bf16 v[150:165], v[238:241], v[62:69], v0
    v_exp_f32 v72, v72
    v_exp_f32 v73, v73
    v_mfma_f32_32x32x16_bf16 v[54:69], v[228:231], v[42:45], 0
    v_exp_f32 v74, v74
    v_exp_f32 v75, v75
    v_exp_f32 v76, v76
    v_exp_f32 v77, v77
    v_mfma_f32_32x32x8_bf16 v[54:69], v[232:233], v[46:47], v[54:69]
    v_exp_f32 v78, v78
    v_exp_f32 v79, v79
    v_exp_f32 v80, v80
    v_exp_f32 v81, v81
    v_exp_f32 v82, v82
    v_exp_f32 v83, v83
    v_exp_f32 v84, v84
    v_exp_f32 v85, v85
    v_smfmac_f32_32x32x32_bf16 v[166:181], v[234:237], v[70:77], v0
    v_exp_f32 v54, v54
    v_exp_f32 v55, v55
    v_smfmac_f32_32x32x32_bf16 v[166:181], v[238:241], v[78:85], v0
    v_exp_f32 v56, v56
    v_exp_f32 v57, v57
    v_mfma_f32_32x32x16_bf16 v[70:85], v[228:231], v[48:51], 0
    v_exp_f32 v58, v58
    v_exp_f32 v59, v59
    v_exp_f32 v60, v60
    v_exp_f32 v61, v61
    v_mfma_f32_32x32x8_bf16 v[70:85], v[232:233], v[52:53], v[70:85]
    v_exp_f32 v62, v62
    v_exp_f32 v63, v63
    v_exp_f32 v64, v64
    v_exp_f32 v65, v65
    v_exp_f32 v66, v66
    v_exp_f32 v67, v67
    v_exp_f32 v68, v68
    v_exp_f32 v69, v69
    v_smfmac_f32_32x32x32_bf16 v[182:197], v[234:237], v[54:61], v0
    v_exp_f32 v70, v70
    v_exp_f32 v71, v71
    v_smfmac_f32_32x32x32_bf16 v[182:197], v[238:241], v[62:69], v0
    v_exp_f32_e64 v72, v72
    v_exp_f32 v73, v73
    s_waitcnt vmcnt(4)
    v_mfma_f32_32x32x16_bf16 v[54:69], v[242:245], v[6:9], 0
    v_exp_f32 v74, v74
    v_exp_f32 v75, v75
    v_exp_f32 v76, v76
    v_exp_f32 v77, v77
    v_mfma_f32_32x32x8_bf16 v[54:69], v[246:247], v[10:11], v[54:69]
    v_exp_f32 v78, v78
    v_exp_f32 v79, v79
    v_exp_f32 v80, v80
    v_exp_f32 v81, v81
    v_exp_f32 v82, v82
    v_exp_f32 v83, v83
    v_exp_f32 v84, v84
    v_exp_f32 v85, v85
    v_smfmac_f32_32x32x32_bf16 v[198:213], v[234:237], v[70:77], v0
    v_exp_f32 v54, v54
    v_exp_f32 v55, v55
    v_smfmac_f32_32x32x32_bf16 v[198:213], v[238:241], v[78:85], v0
    buffer_load_dwordx4 v[228:231], v1, s[32:35], s11 offen sc1
    buffer_load_dwordx2 v[232:233], v2, s[32:35], s11 offen offset:1024 sc1
    buffer_load_dwordx4 v[234:237], v3, s[32:35], s11 offen offset:1280 sc1
    buffer_load_dwordx4 v[238:241], v3, s[32:35], s11 offen offset:1952 sc1
    v_exp_f32 v56, v56
    v_exp_f32 v57, v57
    v_mfma_f32_32x32x16_bf16 v[70:85], v[242:245], v[12:15], 0
    v_exp_f32 v58, v58
    v_exp_f32 v59, v59
    v_exp_f32 v60, v60
    v_exp_f32 v61, v61
    v_mfma_f32_32x32x8_bf16 v[70:85], v[246:247], v[16:17], v[70:85]
    v_exp_f32 v62, v62
    v_exp_f32 v63, v63
    v_exp_f32 v64, v64
    v_exp_f32 v65, v65
    v_exp_f32 v66, v66
    v_exp_f32 v67, v67
    v_exp_f32 v68, v68
    v_exp_f32 v69, v69
    v_smfmac_f32_32x32x32_bf16 v[86:101], v[248:251], v[54:61], v0
    v_exp_f32 v70, v70
    v_exp_f32 v71, v71
    v_smfmac_f32_32x32x32_bf16 v[86:101], v[252:255], v[62:69], v0
    v_exp_f32 v72, v72
    v_exp_f32 v73, v73
    v_mfma_f32_32x32x16_bf16 v[54:69], v[242:245], v[18:21], 0
    v_exp_f32 v74, v74
    v_exp_f32 v75, v75
    v_exp_f32 v76, v76
    v_exp_f32 v77, v77
    v_mfma_f32_32x32x8_bf16 v[54:69], v[246:247], v[22:23], v[54:69]
    v_exp_f32 v78, v78
    v_exp_f32 v79, v79
    v_exp_f32 v80, v80
    v_exp_f32 v81, v81
    v_exp_f32 v82, v82
    v_exp_f32 v83, v83
    v_exp_f32 v84, v84
    v_exp_f32 v85, v85
    v_smfmac_f32_32x32x32_bf16 v[102:117], v[248:251], v[70:77], v0
    v_exp_f32 v54, v54
    v_exp_f32 v55, v55
    v_smfmac_f32_32x32x32_bf16 v[102:117], v[252:255], v[78:85], v0
    v_exp_f32 v56, v56
    v_exp_f32 v57, v57
    v_mfma_f32_32x32x16_bf16 v[70:85], v[242:245], v[24:27], 0
    v_exp_f32 v58, v58
    v_exp_f32 v59, v59
    v_exp_f32 v60, v60
    v_exp_f32 v61, v61
    v_mfma_f32_32x32x8_bf16 v[70:85], v[246:247], v[28:29], v[70:85]
    v_exp_f32 v62, v62
    v_exp_f32 v63, v63
    v_exp_f32 v64, v64
    v_exp_f32 v65, v65
    v_exp_f32 v66, v66
    v_exp_f32 v67, v67
    v_exp_f32 v68, v68
    v_exp_f32 v69, v69
    v_smfmac_f32_32x32x32_bf16 v[118:133], v[248:251], v[54:61], v0
    v_exp_f32 v70, v70
    v_exp_f32 v71, v71
    v_smfmac_f32_32x32x32_bf16 v[118:133], v[252:255], v[62:69], v0
    v_exp_f32 v72, v72
    v_exp_f32 v73, v73
    v_mfma_f32_32x32x16_bf16 v[54:69], v[242:245], v[30:33], 0
    v_exp_f32 v74, v74
    v_exp_f32 v75, v75
    v_exp_f32 v76, v76
    v_exp_f32 v77, v77
    v_mfma_f32_32x32x8_bf16 v[54:69], v[246:247], v[34:35], v[54:69]
    v_exp_f32 v78, v78
    v_exp_f32 v79, v79
    v_exp_f32 v80, v80
    v_exp_f32 v81, v81
    v_exp_f32 v82, v82
    v_exp_f32 v83, v83
    v_exp_f32 v84, v84
    v_exp_f32 v85, v85
    v_smfmac_f32_32x32x32_bf16 v[134:149], v[248:251], v[70:77], v0
    v_exp_f32 v54, v54
    v_exp_f32 v55, v55
    v_smfmac_f32_32x32x32_bf16 v[134:149], v[252:255], v[78:85], v0
    v_exp_f32 v56, v56
    v_exp_f32 v57, v57
    v_mfma_f32_32x32x16_bf16 v[70:85], v[242:245], v[36:39], 0
    v_exp_f32 v58, v58
    v_exp_f32 v59, v59
    v_exp_f32 v60, v60
    v_exp_f32 v61, v61
    v_mfma_f32_32x32x8_bf16 v[70:85], v[246:247], v[40:41], v[70:85]
    v_exp_f32 v62, v62
    v_exp_f32 v63, v63
    v_exp_f32 v64, v64
    v_exp_f32 v65, v65
    v_exp_f32 v66, v66
    v_exp_f32 v67, v67
    v_exp_f32 v68, v68
    v_exp_f32 v69, v69
    v_smfmac_f32_32x32x32_bf16 v[150:165], v[248:251], v[54:61], v0
    v_exp_f32 v70, v70
    v_exp_f32 v71, v71
    v_smfmac_f32_32x32x32_bf16 v[150:165], v[252:255], v[62:69], v0
    v_exp_f32 v72, v72
    v_exp_f32 v73, v73
    v_mfma_f32_32x32x16_bf16 v[54:69], v[242:245], v[42:45], 0
    v_exp_f32 v74, v74
    v_exp_f32 v75, v75
    v_exp_f32 v76, v76
    v_exp_f32 v77, v77
    v_mfma_f32_32x32x8_bf16 v[54:69], v[246:247], v[46:47], v[54:69]
    v_exp_f32 v78, v78
    v_exp_f32 v79, v79
    v_exp_f32 v80, v80
    v_exp_f32 v81, v81
    v_exp_f32 v82, v82
    v_exp_f32 v83, v83
    v_exp_f32 v84, v84
    v_exp_f32 v85, v85
    v_smfmac_f32_32x32x32_bf16 v[166:181], v[248:251], v[70:77], v0
    v_exp_f32 v54, v54
    v_exp_f32 v55, v55
    v_smfmac_f32_32x32x32_bf16 v[166:181], v[252:255], v[78:85], v0
    v_exp_f32 v56, v56
    v_exp_f32 v57, v57
    v_mfma_f32_32x32x16_bf16 v[70:85], v[242:245], v[48:51], 0
    v_exp_f32 v58, v58
    v_exp_f32 v59, v59
    v_exp_f32 v60, v60
    v_exp_f32 v61, v61
    v_mfma_f32_32x32x8_bf16 v[70:85], v[246:247], v[52:53], v[70:85]
    v_exp_f32 v62, v62
    v_exp_f32 v63, v63
    v_exp_f32 v64, v64
    v_exp_f32 v65, v65
    v_exp_f32 v66, v66
    v_exp_f32 v67, v67
    v_exp_f32 v68, v68
    v_exp_f32 v69, v69
    v_smfmac_f32_32x32x32_bf16 v[182:197], v[248:251], v[54:61], v0
    v_exp_f32 v70, v70
    v_exp_f32 v71, v71
    v_smfmac_f32_32x32x32_bf16 v[182:197], v[252:255], v[62:69], v0
    v_exp_f32_e64 v72, v72
    v_exp_f32 v73, v73
    s_waitcnt vmcnt(4)
    v_mfma_f32_32x32x16_bf16 v[54:69], v[214:217], v[6:9], 0
    v_exp_f32 v74, v74
    v_exp_f32 v75, v75
    v_exp_f32 v76, v76
    v_exp_f32 v77, v77
    v_mfma_f32_32x32x8_bf16 v[54:69], v[218:219], v[10:11], v[54:69]
    v_exp_f32 v78, v78
    v_exp_f32 v79, v79
    v_exp_f32 v80, v80
    v_exp_f32 v81, v81
    v_exp_f32 v82, v82
    v_exp_f32 v83, v83
    v_exp_f32 v84, v84
    v_exp_f32 v85, v85
    v_smfmac_f32_32x32x32_bf16 v[198:213], v[248:251], v[70:77], v0
    v_exp_f32 v54, v54
    v_exp_f32 v55, v55
    v_smfmac_f32_32x32x32_bf16 v[198:213], v[252:255], v[78:85], v0
    buffer_load_dwordx4 v[242:245], v1, s[32:35], s12 offen sc1
    buffer_load_dwordx2 v[246:247], v2, s[32:35], s12 offen offset:1024 sc1
    buffer_load_dwordx4 v[248:251], v3, s[32:35], s12 offen offset:1280 sc1
    buffer_load_dwordx4 v[252:255], v3, s[32:35], s12 offen offset:1952 sc1
    v_exp_f32 v56, v56
    v_exp_f32 v57, v57
    v_mfma_f32_32x32x16_bf16 v[70:85], v[214:217], v[12:15], 0
    v_exp_f32 v58, v58
    v_exp_f32 v59, v59
    v_exp_f32 v60, v60
    v_exp_f32 v61, v61
    v_mfma_f32_32x32x8_bf16 v[70:85], v[218:219], v[16:17], v[70:85]
    v_exp_f32 v62, v62
    v_exp_f32 v63, v63
    v_exp_f32 v64, v64
    v_exp_f32 v65, v65
    v_exp_f32 v66, v66
    v_exp_f32 v67, v67
    v_exp_f32 v68, v68
    v_exp_f32 v69, v69
    v_smfmac_f32_32x32x32_bf16 v[86:101], v[220:223], v[54:61], v0
    v_exp_f32 v70, v70
    v_exp_f32 v71, v71
    v_smfmac_f32_32x32x32_bf16 v[86:101], v[224:227], v[62:69], v0
    v_exp_f32 v72, v72
    v_exp_f32 v73, v73
    v_mfma_f32_32x32x16_bf16 v[54:69], v[214:217], v[18:21], 0
    v_exp_f32 v74, v74
    v_exp_f32 v75, v75
    v_exp_f32 v76, v76
    v_exp_f32 v77, v77
    v_mfma_f32_32x32x8_bf16 v[54:69], v[218:219], v[22:23], v[54:69]
    v_exp_f32 v78, v78
    v_exp_f32 v79, v79
    v_exp_f32 v80, v80
    v_exp_f32 v81, v81
    v_exp_f32 v82, v82
    v_exp_f32 v83, v83
    v_exp_f32 v84, v84
    v_exp_f32 v85, v85
    v_smfmac_f32_32x32x32_bf16 v[102:117], v[220:223], v[70:77], v0
    v_exp_f32 v54, v54
    v_exp_f32 v55, v55
    v_smfmac_f32_32x32x32_bf16 v[102:117], v[224:227], v[78:85], v0
    v_exp_f32 v56, v56
    v_exp_f32 v57, v57
    v_mfma_f32_32x32x16_bf16 v[70:85], v[214:217], v[24:27], 0
    v_exp_f32 v58, v58
    v_exp_f32 v59, v59
    v_exp_f32 v60, v60
    v_exp_f32 v61, v61
    v_mfma_f32_32x32x8_bf16 v[70:85], v[218:219], v[28:29], v[70:85]
    v_exp_f32 v62, v62
    v_exp_f32 v63, v63
    v_exp_f32 v64, v64
    v_exp_f32 v65, v65
    v_exp_f32 v66, v66
    v_exp_f32 v67, v67
    v_exp_f32 v68, v68
    v_exp_f32 v69, v69
    v_smfmac_f32_32x32x32_bf16 v[118:133], v[220:223], v[54:61], v0
    v_exp_f32 v70, v70
    v_exp_f32 v71, v71
    v_smfmac_f32_32x32x32_bf16 v[118:133], v[224:227], v[62:69], v0
    v_exp_f32 v72, v72
    v_exp_f32 v73, v73
    v_mfma_f32_32x32x16_bf16 v[54:69], v[214:217], v[30:33], 0
    v_exp_f32 v74, v74
    v_exp_f32 v75, v75
    v_exp_f32 v76, v76
    v_exp_f32 v77, v77
    v_mfma_f32_32x32x8_bf16 v[54:69], v[218:219], v[34:35], v[54:69]
    v_exp_f32 v78, v78
    v_exp_f32 v79, v79
    v_exp_f32 v80, v80
    v_exp_f32 v81, v81
    v_exp_f32 v82, v82
    v_exp_f32 v83, v83
    v_exp_f32 v84, v84
    v_exp_f32 v85, v85
    v_smfmac_f32_32x32x32_bf16 v[134:149], v[220:223], v[70:77], v0
    v_exp_f32 v54, v54
    v_exp_f32 v55, v55
    v_smfmac_f32_32x32x32_bf16 v[134:149], v[224:227], v[78:85], v0
    v_exp_f32 v56, v56
    v_exp_f32 v57, v57
    v_mfma_f32_32x32x16_bf16 v[70:85], v[214:217], v[36:39], 0
    v_exp_f32 v58, v58
    v_exp_f32 v59, v59
    v_exp_f32 v60, v60
    v_exp_f32 v61, v61
    v_mfma_f32_32x32x8_bf16 v[70:85], v[218:219], v[40:41], v[70:85]
    v_exp_f32 v62, v62
    v_exp_f32 v63, v63
    v_exp_f32 v64, v64
    v_exp_f32 v65, v65
    v_exp_f32 v66, v66
    v_exp_f32 v67, v67
    v_exp_f32 v68, v68
    v_exp_f32 v69, v69
    v_smfmac_f32_32x32x32_bf16 v[150:165], v[220:223], v[54:61], v0
    v_exp_f32 v70, v70
    v_exp_f32 v71, v71
    v_smfmac_f32_32x32x32_bf16 v[150:165], v[224:227], v[62:69], v0
    v_exp_f32 v72, v72
    v_exp_f32 v73, v73
    v_mfma_f32_32x32x16_bf16 v[54:69], v[214:217], v[42:45], 0
    v_exp_f32 v74, v74
    v_exp_f32 v75, v75
    v_exp_f32 v76, v76
    v_exp_f32 v77, v77
    v_mfma_f32_32x32x8_bf16 v[54:69], v[218:219], v[46:47], v[54:69]
    v_exp_f32 v78, v78
    v_exp_f32 v79, v79
    v_exp_f32 v80, v80
    v_exp_f32 v81, v81
    v_exp_f32 v82, v82
    v_exp_f32 v83, v83
    v_exp_f32 v84, v84
    v_exp_f32 v85, v85
    v_smfmac_f32_32x32x32_bf16 v[166:181], v[220:223], v[70:77], v0
    v_exp_f32 v54, v54
    v_exp_f32 v55, v55
    v_smfmac_f32_32x32x32_bf16 v[166:181], v[224:227], v[78:85], v0
    v_exp_f32 v56, v56
    v_exp_f32 v57, v57
    v_mfma_f32_32x32x16_bf16 v[70:85], v[214:217], v[48:51], 0
    v_exp_f32 v58, v58
    v_exp_f32 v59, v59
    v_exp_f32 v60, v60
    v_exp_f32 v61, v61
    v_mfma_f32_32x32x8_bf16 v[70:85], v[218:219], v[52:53], v[70:85]
    v_exp_f32 v62, v62
    v_exp_f32 v63, v63
    v_exp_f32 v64, v64
    v_exp_f32 v65, v65
    v_exp_f32 v66, v66
    v_exp_f32 v67, v67
    v_exp_f32 v68, v68
    v_exp_f32 v69, v69
    v_smfmac_f32_32x32x32_bf16 v[182:197], v[220:223], v[54:61], v0
    v_exp_f32 v70, v70
    v_exp_f32 v71, v71
    v_smfmac_f32_32x32x32_bf16 v[182:197], v[224:227], v[62:69], v0
    v_exp_f32_e64 v72, v72
    v_exp_f32 v73, v73
    s_waitcnt vmcnt(4)
    v_mfma_f32_32x32x16_bf16 v[54:69], v[228:231], v[6:9], 0
    v_exp_f32 v74, v74
    v_exp_f32 v75, v75
    v_exp_f32 v76, v76
    v_exp_f32 v77, v77
    v_mfma_f32_32x32x8_bf16 v[54:69], v[232:233], v[10:11], v[54:69]
    v_exp_f32 v78, v78
    v_exp_f32 v79, v79
    v_exp_f32 v80, v80
    v_exp_f32 v81, v81
    v_exp_f32 v82, v82
    v_exp_f32 v83, v83
    v_exp_f32 v84, v84
    v_exp_f32 v85, v85
    v_smfmac_f32_32x32x32_bf16 v[198:213], v[220:223], v[70:77], v0
    v_exp_f32 v54, v54
    v_exp_f32 v55, v55
    v_smfmac_f32_32x32x32_bf16 v[198:213], v[224:227], v[78:85], v0
    buffer_load_dwordx4 v[214:217], v1, s[32:35], s13 offen sc1
    buffer_load_dwordx2 v[218:219], v2, s[32:35], s13 offen offset:1024 sc1
    buffer_load_dwordx4 v[220:223], v3, s[32:35], s13 offen offset:1280 sc1
    buffer_load_dwordx4 v[224:227], v3, s[32:35], s13 offen offset:1952 sc1
    v_exp_f32 v56, v56
    v_exp_f32 v57, v57
    v_mfma_f32_32x32x16_bf16 v[70:85], v[228:231], v[12:15], 0
    v_exp_f32 v58, v58
    v_exp_f32 v59, v59
    v_exp_f32 v60, v60
    v_exp_f32 v61, v61
    v_mfma_f32_32x32x8_bf16 v[70:85], v[232:233], v[16:17], v[70:85]
    v_exp_f32 v62, v62
    v_exp_f32 v63, v63
    v_exp_f32 v64, v64
    v_exp_f32 v65, v65
    v_exp_f32 v66, v66
    v_exp_f32 v67, v67
    v_exp_f32 v68, v68
    v_exp_f32 v69, v69
    v_smfmac_f32_32x32x32_bf16 v[86:101], v[234:237], v[54:61], v0
    v_exp_f32 v70, v70
    v_exp_f32 v71, v71
    v_smfmac_f32_32x32x32_bf16 v[86:101], v[238:241], v[62:69], v0
    v_exp_f32 v72, v72
    v_exp_f32 v73, v73
    v_mfma_f32_32x32x16_bf16 v[54:69], v[228:231], v[18:21], 0
    v_exp_f32 v74, v74
    v_exp_f32 v75, v75
    v_exp_f32 v76, v76
    v_exp_f32 v77, v77
    v_mfma_f32_32x32x8_bf16 v[54:69], v[232:233], v[22:23], v[54:69]
    v_exp_f32 v78, v78
    v_exp_f32 v79, v79
    v_exp_f32 v80, v80
    v_exp_f32 v81, v81
    v_exp_f32 v82, v82
    v_exp_f32 v83, v83
    v_exp_f32 v84, v84
    v_exp_f32 v85, v85
    v_smfmac_f32_32x32x32_bf16 v[102:117], v[234:237], v[70:77], v0
    v_exp_f32 v54, v54
    v_exp_f32 v55, v55
    v_smfmac_f32_32x32x32_bf16 v[102:117], v[238:241], v[78:85], v0
    v_exp_f32 v56, v56
    v_exp_f32 v57, v57
    v_mfma_f32_32x32x16_bf16 v[70:85], v[228:231], v[24:27], 0
    v_exp_f32 v58, v58
    v_exp_f32 v59, v59
    v_exp_f32 v60, v60
    v_exp_f32 v61, v61
    v_mfma_f32_32x32x8_bf16 v[70:85], v[232:233], v[28:29], v[70:85]
    v_exp_f32 v62, v62
    v_exp_f32 v63, v63
    v_exp_f32 v64, v64
    v_exp_f32 v65, v65
    v_exp_f32 v66, v66
    v_exp_f32 v67, v67
    v_exp_f32 v68, v68
    v_exp_f32 v69, v69
    v_smfmac_f32_32x32x32_bf16 v[118:133], v[234:237], v[54:61], v0
    v_exp_f32 v70, v70
    v_exp_f32 v71, v71
    v_smfmac_f32_32x32x32_bf16 v[118:133], v[238:241], v[62:69], v0
    v_exp_f32 v72, v72
    v_exp_f32 v73, v73
    v_mfma_f32_32x32x16_bf16 v[54:69], v[228:231], v[30:33], 0
    v_exp_f32 v74, v74
    v_exp_f32 v75, v75
    v_exp_f32 v76, v76
    v_exp_f32 v77, v77
    v_mfma_f32_32x32x8_bf16 v[54:69], v[232:233], v[34:35], v[54:69]
    v_exp_f32 v78, v78
    v_exp_f32 v79, v79
    v_exp_f32 v80, v80
    v_exp_f32 v81, v81
    v_exp_f32 v82, v82
    v_exp_f32 v83, v83
    v_exp_f32 v84, v84
    v_exp_f32 v85, v85
    v_smfmac_f32_32x32x32_bf16 v[134:149], v[234:237], v[70:77], v0
    v_exp_f32 v54, v54
    v_exp_f32 v55, v55
    v_smfmac_f32_32x32x32_bf16 v[134:149], v[238:241], v[78:85], v0
    v_exp_f32 v56, v56
    v_exp_f32 v57, v57
    v_mfma_f32_32x32x16_bf16 v[70:85], v[228:231], v[36:39], 0
    v_exp_f32 v58, v58
    v_exp_f32 v59, v59
    v_exp_f32 v60, v60
    v_exp_f32 v61, v61
    v_mfma_f32_32x32x8_bf16 v[70:85], v[232:233], v[40:41], v[70:85]
    v_exp_f32 v62, v62
    v_exp_f32 v63, v63
    v_exp_f32 v64, v64
    v_exp_f32 v65, v65
    v_exp_f32 v66, v66
    v_exp_f32 v67, v67
    v_exp_f32 v68, v68
    v_exp_f32 v69, v69
    v_smfmac_f32_32x32x32_bf16 v[150:165], v[234:237], v[54:61], v0
    v_exp_f32 v70, v70
    v_exp_f32 v71, v71
    v_smfmac_f32_32x32x32_bf16 v[150:165], v[238:241], v[62:69], v0
    v_exp_f32 v72, v72
    v_exp_f32 v73, v73
    v_mfma_f32_32x32x16_bf16 v[54:69], v[228:231], v[42:45], 0
    v_exp_f32 v74, v74
    v_exp_f32 v75, v75
    v_exp_f32 v76, v76
    v_exp_f32 v77, v77
    v_mfma_f32_32x32x8_bf16 v[54:69], v[232:233], v[46:47], v[54:69]
    v_exp_f32 v78, v78
    v_exp_f32 v79, v79
    v_exp_f32 v80, v80
    v_exp_f32 v81, v81
    v_exp_f32 v82, v82
    v_exp_f32 v83, v83
    v_exp_f32 v84, v84
    v_exp_f32 v85, v85
    v_smfmac_f32_32x32x32_bf16 v[166:181], v[234:237], v[70:77], v0
    v_exp_f32 v54, v54
    v_exp_f32 v55, v55
    v_smfmac_f32_32x32x32_bf16 v[166:181], v[238:241], v[78:85], v0
    v_exp_f32 v56, v56
    v_exp_f32 v57, v57
    v_mfma_f32_32x32x16_bf16 v[70:85], v[228:231], v[48:51], 0
    v_exp_f32 v58, v58
    v_exp_f32 v59, v59
    v_exp_f32 v60, v60
    v_exp_f32 v61, v61
    v_mfma_f32_32x32x8_bf16 v[70:85], v[232:233], v[52:53], v[70:85]
    v_exp_f32 v62, v62
    v_exp_f32 v63, v63
    v_exp_f32 v64, v64
    v_exp_f32 v65, v65
    v_exp_f32 v66, v66
    v_exp_f32 v67, v67
    v_exp_f32 v68, v68
    v_exp_f32 v69, v69
    v_smfmac_f32_32x32x32_bf16 v[182:197], v[234:237], v[54:61], v0
    v_exp_f32 v70, v70
    v_exp_f32 v71, v71
    v_smfmac_f32_32x32x32_bf16 v[182:197], v[238:241], v[62:69], v0
    v_exp_f32_e64 v72, v72
    v_exp_f32 v73, v73
    s_waitcnt vmcnt(4)
    v_mfma_f32_32x32x16_bf16 v[54:69], v[242:245], v[6:9], 0
    v_exp_f32 v74, v74
    v_exp_f32 v75, v75
    v_exp_f32 v76, v76
    v_exp_f32 v77, v77
    v_mfma_f32_32x32x8_bf16 v[54:69], v[246:247], v[10:11], v[54:69]
    v_exp_f32 v78, v78
    v_exp_f32 v79, v79
    v_exp_f32 v80, v80
    v_exp_f32 v81, v81
    v_exp_f32 v82, v82
    v_exp_f32 v83, v83
    v_exp_f32 v84, v84
    v_exp_f32 v85, v85
    v_smfmac_f32_32x32x32_bf16 v[198:213], v[234:237], v[70:77], v0
    v_exp_f32 v54, v54
    v_exp_f32 v55, v55
    v_smfmac_f32_32x32x32_bf16 v[198:213], v[238:241], v[78:85], v0
    buffer_load_dwordx4 v[228:231], v1, s[32:35], s14 offen sc1
    buffer_load_dwordx2 v[232:233], v2, s[32:35], s14 offen offset:1024 sc1
    buffer_load_dwordx4 v[234:237], v3, s[32:35], s14 offen offset:1280 sc1
    buffer_load_dwordx4 v[238:241], v3, s[32:35], s14 offen offset:1952 sc1
    v_exp_f32 v56, v56
    v_exp_f32 v57, v57
    v_mfma_f32_32x32x16_bf16 v[70:85], v[242:245], v[12:15], 0
    v_exp_f32 v58, v58
    v_exp_f32 v59, v59
    v_exp_f32 v60, v60
    v_exp_f32 v61, v61
    v_mfma_f32_32x32x8_bf16 v[70:85], v[246:247], v[16:17], v[70:85]
    v_exp_f32 v62, v62
    v_exp_f32 v63, v63
    v_exp_f32 v64, v64
    v_exp_f32 v65, v65
    v_exp_f32 v66, v66
    v_exp_f32 v67, v67
    v_exp_f32 v68, v68
    v_exp_f32 v69, v69
    v_smfmac_f32_32x32x32_bf16 v[86:101], v[248:251], v[54:61], v0
    v_exp_f32 v70, v70
    v_exp_f32 v71, v71
    v_smfmac_f32_32x32x32_bf16 v[86:101], v[252:255], v[62:69], v0
    v_exp_f32 v72, v72
    v_exp_f32 v73, v73
    v_mfma_f32_32x32x16_bf16 v[54:69], v[242:245], v[18:21], 0
    v_exp_f32 v74, v74
    v_exp_f32 v75, v75
    v_exp_f32 v76, v76
    v_exp_f32 v77, v77
    v_mfma_f32_32x32x8_bf16 v[54:69], v[246:247], v[22:23], v[54:69]
    v_exp_f32 v78, v78
    v_exp_f32 v79, v79
    v_exp_f32 v80, v80
    v_exp_f32 v81, v81
    v_exp_f32 v82, v82
    v_exp_f32 v83, v83
    v_exp_f32 v84, v84
    v_exp_f32 v85, v85
    v_smfmac_f32_32x32x32_bf16 v[102:117], v[248:251], v[70:77], v0
    v_exp_f32 v54, v54
    v_exp_f32 v55, v55
    v_smfmac_f32_32x32x32_bf16 v[102:117], v[252:255], v[78:85], v0
    v_exp_f32 v56, v56
    v_exp_f32 v57, v57
    v_mfma_f32_32x32x16_bf16 v[70:85], v[242:245], v[24:27], 0
    v_exp_f32 v58, v58
    v_exp_f32 v59, v59
    v_exp_f32 v60, v60
    v_exp_f32 v61, v61
    v_mfma_f32_32x32x8_bf16 v[70:85], v[246:247], v[28:29], v[70:85]
    v_exp_f32 v62, v62
    v_exp_f32 v63, v63
    v_exp_f32 v64, v64
    v_exp_f32 v65, v65
    v_exp_f32 v66, v66
    v_exp_f32 v67, v67
    v_exp_f32 v68, v68
    v_exp_f32 v69, v69
    v_smfmac_f32_32x32x32_bf16 v[118:133], v[248:251], v[54:61], v0
    v_exp_f32 v70, v70
    v_exp_f32 v71, v71
    v_smfmac_f32_32x32x32_bf16 v[118:133], v[252:255], v[62:69], v0
    v_exp_f32 v72, v72
    v_exp_f32 v73, v73
    v_mfma_f32_32x32x16_bf16 v[54:69], v[242:245], v[30:33], 0
    v_exp_f32 v74, v74
    v_exp_f32 v75, v75
    v_exp_f32 v76, v76
    v_exp_f32 v77, v77
    v_mfma_f32_32x32x8_bf16 v[54:69], v[246:247], v[34:35], v[54:69]
    v_exp_f32 v78, v78
    v_exp_f32 v79, v79
    v_exp_f32 v80, v80
    v_exp_f32 v81, v81
    v_exp_f32 v82, v82
    v_exp_f32 v83, v83
    v_exp_f32 v84, v84
    v_exp_f32 v85, v85
    v_smfmac_f32_32x32x32_bf16 v[134:149], v[248:251], v[70:77], v0
    v_exp_f32 v54, v54
    v_exp_f32 v55, v55
    v_smfmac_f32_32x32x32_bf16 v[134:149], v[252:255], v[78:85], v0
    v_exp_f32 v56, v56
    v_exp_f32 v57, v57
    v_mfma_f32_32x32x16_bf16 v[70:85], v[242:245], v[36:39], 0
    v_exp_f32 v58, v58
    v_exp_f32 v59, v59
    v_exp_f32 v60, v60
    v_exp_f32 v61, v61
    v_mfma_f32_32x32x8_bf16 v[70:85], v[246:247], v[40:41], v[70:85]
    v_exp_f32 v62, v62
    v_exp_f32 v63, v63
    v_exp_f32 v64, v64
    v_exp_f32 v65, v65
    v_exp_f32 v66, v66
    v_exp_f32 v67, v67
    v_exp_f32 v68, v68
    v_exp_f32 v69, v69
    v_smfmac_f32_32x32x32_bf16 v[150:165], v[248:251], v[54:61], v0
    v_exp_f32 v70, v70
    v_exp_f32 v71, v71
    v_smfmac_f32_32x32x32_bf16 v[150:165], v[252:255], v[62:69], v0
    v_exp_f32 v72, v72
    v_exp_f32 v73, v73
    v_mfma_f32_32x32x16_bf16 v[54:69], v[242:245], v[42:45], 0
    v_exp_f32 v74, v74
    v_exp_f32 v75, v75
    v_exp_f32 v76, v76
    v_exp_f32 v77, v77
    v_mfma_f32_32x32x8_bf16 v[54:69], v[246:247], v[46:47], v[54:69]
    v_exp_f32 v78, v78
    v_exp_f32 v79, v79
    v_exp_f32 v80, v80
    v_exp_f32 v81, v81
    v_exp_f32 v82, v82
    v_exp_f32 v83, v83
    v_exp_f32 v84, v84
    v_exp_f32 v85, v85
    v_smfmac_f32_32x32x32_bf16 v[166:181], v[248:251], v[70:77], v0
    v_exp_f32 v54, v54
    v_exp_f32 v55, v55
    v_smfmac_f32_32x32x32_bf16 v[166:181], v[252:255], v[78:85], v0
    v_exp_f32 v56, v56
    v_exp_f32 v57, v57
    v_mfma_f32_32x32x16_bf16 v[70:85], v[242:245], v[48:51], 0
    v_exp_f32 v58, v58
    v_exp_f32 v59, v59
    v_exp_f32 v60, v60
    v_exp_f32 v61, v61
    v_mfma_f32_32x32x8_bf16 v[70:85], v[246:247], v[52:53], v[70:85]
    v_exp_f32 v62, v62
    v_exp_f32 v63, v63
    v_exp_f32 v64, v64
    v_exp_f32 v65, v65
    v_exp_f32 v66, v66
    v_exp_f32 v67, v67
    v_exp_f32 v68, v68
    v_exp_f32 v69, v69
    v_smfmac_f32_32x32x32_bf16 v[182:197], v[248:251], v[54:61], v0
    v_exp_f32 v70, v70
    v_exp_f32 v71, v71
    v_smfmac_f32_32x32x32_bf16 v[182:197], v[252:255], v[62:69], v0
    v_exp_f32_e64 v72, v72
    v_exp_f32 v73, v73
    s_waitcnt vmcnt(4)
    v_mfma_f32_32x32x16_bf16 v[54:69], v[214:217], v[6:9], 0
    v_exp_f32 v74, v74
    v_exp_f32 v75, v75
    v_exp_f32 v76, v76
    v_exp_f32 v77, v77
    v_mfma_f32_32x32x8_bf16 v[54:69], v[218:219], v[10:11], v[54:69]
    v_exp_f32 v78, v78
    v_exp_f32 v79, v79
    v_exp_f32 v80, v80
    v_exp_f32 v81, v81
    v_exp_f32 v82, v82
    v_exp_f32 v83, v83
    v_exp_f32 v84, v84
    v_exp_f32 v85, v85
    v_smfmac_f32_32x32x32_bf16 v[198:213], v[248:251], v[70:77], v0
    v_exp_f32 v54, v54
    v_exp_f32 v55, v55
    v_smfmac_f32_32x32x32_bf16 v[198:213], v[252:255], v[78:85], v0
    buffer_load_dwordx4 v[242:245], v1, s[32:35], s15 offen sc1
    buffer_load_dwordx2 v[246:247], v2, s[32:35], s15 offen offset:1024 sc1
    buffer_load_dwordx4 v[248:251], v3, s[32:35], s15 offen offset:1280 sc1
    buffer_load_dwordx4 v[252:255], v3, s[32:35], s15 offen offset:1952 sc1
    v_exp_f32 v56, v56
    v_exp_f32 v57, v57
    v_mfma_f32_32x32x16_bf16 v[70:85], v[214:217], v[12:15], 0
    v_exp_f32 v58, v58
    v_exp_f32 v59, v59
    v_exp_f32 v60, v60
    v_exp_f32 v61, v61
    v_mfma_f32_32x32x8_bf16 v[70:85], v[218:219], v[16:17], v[70:85]
    v_exp_f32 v62, v62
    v_exp_f32 v63, v63
    v_exp_f32 v64, v64
    v_exp_f32 v65, v65
    v_exp_f32 v66, v66
    v_exp_f32 v67, v67
    v_exp_f32 v68, v68
    v_exp_f32 v69, v69
    v_smfmac_f32_32x32x32_bf16 v[86:101], v[220:223], v[54:61], v0
    v_exp_f32 v70, v70
    v_exp_f32 v71, v71
    v_smfmac_f32_32x32x32_bf16 v[86:101], v[224:227], v[62:69], v0
    v_exp_f32 v72, v72
    v_exp_f32 v73, v73
    v_mfma_f32_32x32x16_bf16 v[54:69], v[214:217], v[18:21], 0
    v_exp_f32 v74, v74
    v_exp_f32 v75, v75
    v_exp_f32 v76, v76
    v_exp_f32 v77, v77
    v_mfma_f32_32x32x8_bf16 v[54:69], v[218:219], v[22:23], v[54:69]
    v_exp_f32 v78, v78
    v_exp_f32 v79, v79
    v_exp_f32 v80, v80
    v_exp_f32 v81, v81
    v_exp_f32 v82, v82
    v_exp_f32 v83, v83
    v_exp_f32 v84, v84
    v_exp_f32 v85, v85
    v_smfmac_f32_32x32x32_bf16 v[102:117], v[220:223], v[70:77], v0
    v_exp_f32 v54, v54
    v_exp_f32 v55, v55
    v_smfmac_f32_32x32x32_bf16 v[102:117], v[224:227], v[78:85], v0
    v_exp_f32 v56, v56
    v_exp_f32 v57, v57
    v_mfma_f32_32x32x16_bf16 v[70:85], v[214:217], v[24:27], 0
    v_exp_f32 v58, v58
    v_exp_f32 v59, v59
    v_exp_f32 v60, v60
    v_exp_f32 v61, v61
    v_mfma_f32_32x32x8_bf16 v[70:85], v[218:219], v[28:29], v[70:85]
    v_exp_f32 v62, v62
    v_exp_f32 v63, v63
    v_exp_f32 v64, v64
    v_exp_f32 v65, v65
    v_exp_f32 v66, v66
    v_exp_f32 v67, v67
    v_exp_f32 v68, v68
    v_exp_f32 v69, v69
    v_smfmac_f32_32x32x32_bf16 v[118:133], v[220:223], v[54:61], v0
    v_exp_f32 v70, v70
    v_exp_f32 v71, v71
    v_smfmac_f32_32x32x32_bf16 v[118:133], v[224:227], v[62:69], v0
    v_exp_f32 v72, v72
    v_exp_f32 v73, v73
    v_mfma_f32_32x32x16_bf16 v[54:69], v[214:217], v[30:33], 0
    v_exp_f32 v74, v74
    v_exp_f32 v75, v75
    v_exp_f32 v76, v76
    v_exp_f32 v77, v77
    v_mfma_f32_32x32x8_bf16 v[54:69], v[218:219], v[34:35], v[54:69]
    v_exp_f32 v78, v78
    v_exp_f32 v79, v79
    v_exp_f32 v80, v80
    v_exp_f32 v81, v81
    v_exp_f32 v82, v82
    v_exp_f32 v83, v83
    v_exp_f32 v84, v84
    v_exp_f32 v85, v85
    v_smfmac_f32_32x32x32_bf16 v[134:149], v[220:223], v[70:77], v0
    v_exp_f32 v54, v54
    v_exp_f32 v55, v55
    v_smfmac_f32_32x32x32_bf16 v[134:149], v[224:227], v[78:85], v0
    v_exp_f32 v56, v56
    v_exp_f32 v57, v57
    v_mfma_f32_32x32x16_bf16 v[70:85], v[214:217], v[36:39], 0
    v_exp_f32 v58, v58
    v_exp_f32 v59, v59
    v_exp_f32 v60, v60
    v_exp_f32 v61, v61
    v_mfma_f32_32x32x8_bf16 v[70:85], v[218:219], v[40:41], v[70:85]
    v_exp_f32 v62, v62
    v_exp_f32 v63, v63
    v_exp_f32 v64, v64
    v_exp_f32 v65, v65
    v_exp_f32 v66, v66
    v_exp_f32 v67, v67
    v_exp_f32 v68, v68
    v_exp_f32 v69, v69
    v_smfmac_f32_32x32x32_bf16 v[150:165], v[220:223], v[54:61], v0
    v_exp_f32 v70, v70
    v_exp_f32 v71, v71
    v_smfmac_f32_32x32x32_bf16 v[150:165], v[224:227], v[62:69], v0
    v_exp_f32 v72, v72
    v_exp_f32 v73, v73
    v_mfma_f32_32x32x16_bf16 v[54:69], v[214:217], v[42:45], 0
    v_exp_f32 v74, v74
    v_exp_f32 v75, v75
    v_exp_f32 v76, v76
    v_exp_f32 v77, v77
    v_mfma_f32_32x32x8_bf16 v[54:69], v[218:219], v[46:47], v[54:69]
    v_exp_f32 v78, v78
    v_exp_f32 v79, v79
    v_exp_f32 v80, v80
    v_exp_f32 v81, v81
    v_exp_f32 v82, v82
    v_exp_f32 v83, v83
    v_exp_f32 v84, v84
    v_exp_f32 v85, v85
    v_smfmac_f32_32x32x32_bf16 v[166:181], v[220:223], v[70:77], v0
    v_exp_f32 v54, v54
    v_exp_f32 v55, v55
    v_smfmac_f32_32x32x32_bf16 v[166:181], v[224:227], v[78:85], v0
    v_exp_f32 v56, v56
    v_exp_f32 v57, v57
    v_mfma_f32_32x32x16_bf16 v[70:85], v[214:217], v[48:51], 0
    v_exp_f32 v58, v58
    v_exp_f32 v59, v59
    v_exp_f32 v60, v60
    v_exp_f32 v61, v61
    v_mfma_f32_32x32x8_bf16 v[70:85], v[218:219], v[52:53], v[70:85]
    v_exp_f32 v62, v62
    v_exp_f32 v63, v63
    v_exp_f32 v64, v64
    v_exp_f32 v65, v65
    v_exp_f32 v66, v66
    v_exp_f32 v67, v67
    v_exp_f32 v68, v68
    v_exp_f32 v69, v69
    v_smfmac_f32_32x32x32_bf16 v[182:197], v[220:223], v[54:61], v0
    v_exp_f32 v70, v70
    v_exp_f32 v71, v71
    v_smfmac_f32_32x32x32_bf16 v[182:197], v[224:227], v[62:69], v0
    v_exp_f32_e64 v72, v72
    v_exp_f32 v73, v73
    s_waitcnt vmcnt(4)
    v_mfma_f32_32x32x16_bf16 v[54:69], v[228:231], v[6:9], 0
    v_exp_f32 v74, v74
    v_exp_f32 v75, v75
    v_exp_f32 v76, v76
    v_exp_f32 v77, v77
    v_mfma_f32_32x32x8_bf16 v[54:69], v[232:233], v[10:11], v[54:69]
    v_exp_f32 v78, v78
    v_exp_f32 v79, v79
    v_exp_f32 v80, v80
    v_exp_f32 v81, v81
    v_exp_f32 v82, v82
    v_exp_f32 v83, v83
    v_exp_f32 v84, v84
    v_exp_f32 v85, v85
    v_smfmac_f32_32x32x32_bf16 v[198:213], v[220:223], v[70:77], v0
    v_exp_f32 v54, v54
    v_exp_f32 v55, v55
    v_smfmac_f32_32x32x32_bf16 v[198:213], v[224:227], v[78:85], v0
    buffer_load_dwordx4 v[214:217], v1, s[32:35], s16 offen sc1
    buffer_load_dwordx2 v[218:219], v2, s[32:35], s16 offen offset:1024 sc1
    buffer_load_dwordx4 v[220:223], v3, s[32:35], s16 offen offset:1280 sc1
    buffer_load_dwordx4 v[224:227], v3, s[32:35], s16 offen offset:1952 sc1
    v_exp_f32 v56, v56
    v_exp_f32 v57, v57
    v_mfma_f32_32x32x16_bf16 v[70:85], v[228:231], v[12:15], 0
    v_exp_f32 v58, v58
    v_exp_f32 v59, v59
    v_exp_f32 v60, v60
    v_exp_f32 v61, v61
    v_mfma_f32_32x32x8_bf16 v[70:85], v[232:233], v[16:17], v[70:85]
    v_exp_f32 v62, v62
    v_exp_f32 v63, v63
    v_exp_f32 v64, v64
    v_exp_f32 v65, v65
    v_exp_f32 v66, v66
    v_exp_f32 v67, v67
    v_exp_f32 v68, v68
    v_exp_f32 v69, v69
    v_smfmac_f32_32x32x32_bf16 v[86:101], v[234:237], v[54:61], v0
    v_exp_f32 v70, v70
    v_exp_f32 v71, v71
    v_smfmac_f32_32x32x32_bf16 v[86:101], v[238:241], v[62:69], v0
    v_exp_f32 v72, v72
    v_exp_f32 v73, v73
    v_mfma_f32_32x32x16_bf16 v[54:69], v[228:231], v[18:21], 0
    v_exp_f32 v74, v74
    v_exp_f32 v75, v75
    v_exp_f32 v76, v76
    v_exp_f32 v77, v77
    v_mfma_f32_32x32x8_bf16 v[54:69], v[232:233], v[22:23], v[54:69]
    v_exp_f32 v78, v78
    v_exp_f32 v79, v79
    v_exp_f32 v80, v80
    v_exp_f32 v81, v81
    v_exp_f32 v82, v82
    v_exp_f32 v83, v83
    v_exp_f32 v84, v84
    v_exp_f32 v85, v85
    v_smfmac_f32_32x32x32_bf16 v[102:117], v[234:237], v[70:77], v0
    v_exp_f32 v54, v54
    v_exp_f32 v55, v55
    v_smfmac_f32_32x32x32_bf16 v[102:117], v[238:241], v[78:85], v0
    v_exp_f32 v56, v56
    v_exp_f32 v57, v57
    v_mfma_f32_32x32x16_bf16 v[70:85], v[228:231], v[24:27], 0
    v_exp_f32 v58, v58
    v_exp_f32 v59, v59
    v_exp_f32 v60, v60
    v_exp_f32 v61, v61
    v_mfma_f32_32x32x8_bf16 v[70:85], v[232:233], v[28:29], v[70:85]
    v_exp_f32 v62, v62
    v_exp_f32 v63, v63
    v_exp_f32 v64, v64
    v_exp_f32 v65, v65
    v_exp_f32 v66, v66
    v_exp_f32 v67, v67
    v_exp_f32 v68, v68
    v_exp_f32 v69, v69
    v_smfmac_f32_32x32x32_bf16 v[118:133], v[234:237], v[54:61], v0
    v_exp_f32 v70, v70
    v_exp_f32 v71, v71
    v_smfmac_f32_32x32x32_bf16 v[118:133], v[238:241], v[62:69], v0
    v_exp_f32 v72, v72
    v_exp_f32 v73, v73
    v_mfma_f32_32x32x16_bf16 v[54:69], v[228:231], v[30:33], 0
    v_exp_f32 v74, v74
    v_exp_f32 v75, v75
    v_exp_f32 v76, v76
    v_exp_f32 v77, v77
    v_mfma_f32_32x32x8_bf16 v[54:69], v[232:233], v[34:35], v[54:69]
    v_exp_f32 v78, v78
    v_exp_f32 v79, v79
    v_exp_f32 v80, v80
    v_exp_f32 v81, v81
    v_exp_f32 v82, v82
    v_exp_f32 v83, v83
    v_exp_f32 v84, v84
    v_exp_f32 v85, v85
    v_smfmac_f32_32x32x32_bf16 v[134:149], v[234:237], v[70:77], v0
    v_exp_f32 v54, v54
    v_exp_f32 v55, v55
    v_smfmac_f32_32x32x32_bf16 v[134:149], v[238:241], v[78:85], v0
    v_exp_f32 v56, v56
    v_exp_f32 v57, v57
    v_mfma_f32_32x32x16_bf16 v[70:85], v[228:231], v[36:39], 0
    v_exp_f32 v58, v58
    v_exp_f32 v59, v59
    v_exp_f32 v60, v60
    v_exp_f32 v61, v61
    v_mfma_f32_32x32x8_bf16 v[70:85], v[232:233], v[40:41], v[70:85]
    v_exp_f32 v62, v62
    v_exp_f32 v63, v63
    v_exp_f32 v64, v64
    v_exp_f32 v65, v65
    v_exp_f32 v66, v66
    v_exp_f32 v67, v67
    v_exp_f32 v68, v68
    v_exp_f32 v69, v69
    v_smfmac_f32_32x32x32_bf16 v[150:165], v[234:237], v[54:61], v0
    v_exp_f32 v70, v70
    v_exp_f32 v71, v71
    v_smfmac_f32_32x32x32_bf16 v[150:165], v[238:241], v[62:69], v0
    v_exp_f32 v72, v72
    v_exp_f32 v73, v73
    v_mfma_f32_32x32x16_bf16 v[54:69], v[228:231], v[42:45], 0
    v_exp_f32 v74, v74
    v_exp_f32 v75, v75
    v_exp_f32 v76, v76
    v_exp_f32 v77, v77
    v_mfma_f32_32x32x8_bf16 v[54:69], v[232:233], v[46:47], v[54:69]
    v_exp_f32 v78, v78
    v_exp_f32 v79, v79
    v_exp_f32 v80, v80
    v_exp_f32 v81, v81
    v_exp_f32 v82, v82
    v_exp_f32 v83, v83
    v_exp_f32 v84, v84
    v_exp_f32 v85, v85
    v_smfmac_f32_32x32x32_bf16 v[166:181], v[234:237], v[70:77], v0
    v_exp_f32 v54, v54
    v_exp_f32 v55, v55
    v_smfmac_f32_32x32x32_bf16 v[166:181], v[238:241], v[78:85], v0
    v_exp_f32 v56, v56
    v_exp_f32 v57, v57
    v_mfma_f32_32x32x16_bf16 v[70:85], v[228:231], v[48:51], 0
    v_exp_f32 v58, v58
    v_exp_f32 v59, v59
    v_exp_f32 v60, v60
    v_exp_f32 v61, v61
    v_mfma_f32_32x32x8_bf16 v[70:85], v[232:233], v[52:53], v[70:85]
    v_exp_f32 v62, v62
    v_exp_f32 v63, v63
    v_exp_f32 v64, v64
    v_exp_f32 v65, v65
    v_exp_f32 v66, v66
    v_exp_f32 v67, v67
    v_exp_f32 v68, v68
    v_exp_f32 v69, v69
    v_smfmac_f32_32x32x32_bf16 v[182:197], v[234:237], v[54:61], v0
    v_exp_f32 v70, v70
    v_exp_f32 v71, v71
    v_smfmac_f32_32x32x32_bf16 v[182:197], v[238:241], v[62:69], v0
    v_exp_f32_e64 v72, v72
    v_exp_f32 v73, v73
    s_waitcnt vmcnt(4)
    v_mfma_f32_32x32x16_bf16 v[54:69], v[242:245], v[6:9], 0
    v_exp_f32 v74, v74
    v_exp_f32 v75, v75
    v_exp_f32 v76, v76
    v_exp_f32 v77, v77
    v_mfma_f32_32x32x8_bf16 v[54:69], v[246:247], v[10:11], v[54:69]
    v_exp_f32 v78, v78
    v_exp_f32 v79, v79
    v_exp_f32 v80, v80
    v_exp_f32 v81, v81
    v_exp_f32 v82, v82
    v_exp_f32 v83, v83
    v_exp_f32 v84, v84
    v_exp_f32 v85, v85
    v_smfmac_f32_32x32x32_bf16 v[198:213], v[234:237], v[70:77], v0
    v_exp_f32 v54, v54
    v_exp_f32 v55, v55
    v_smfmac_f32_32x32x32_bf16 v[198:213], v[238:241], v[78:85], v0
    buffer_load_dwordx4 v[228:231], v1, s[32:35], s17 offen sc1
    buffer_load_dwordx2 v[232:233], v2, s[32:35], s17 offen offset:1024 sc1
    buffer_load_dwordx4 v[234:237], v3, s[32:35], s17 offen offset:1280 sc1
    buffer_load_dwordx4 v[238:241], v3, s[32:35], s17 offen offset:1952 sc1
    v_exp_f32 v56, v56
    v_exp_f32 v57, v57
    v_mfma_f32_32x32x16_bf16 v[70:85], v[242:245], v[12:15], 0
    v_exp_f32 v58, v58
    v_exp_f32 v59, v59
    v_exp_f32 v60, v60
    v_exp_f32 v61, v61
    v_mfma_f32_32x32x8_bf16 v[70:85], v[246:247], v[16:17], v[70:85]
    v_exp_f32 v62, v62
    v_exp_f32 v63, v63
    v_exp_f32 v64, v64
    v_exp_f32 v65, v65
    v_exp_f32 v66, v66
    v_exp_f32 v67, v67
    v_exp_f32 v68, v68
    v_exp_f32 v69, v69
    v_smfmac_f32_32x32x32_bf16 v[86:101], v[248:251], v[54:61], v0
    v_exp_f32 v70, v70
    v_exp_f32 v71, v71
    v_smfmac_f32_32x32x32_bf16 v[86:101], v[252:255], v[62:69], v0
    v_exp_f32 v72, v72
    v_exp_f32 v73, v73
    v_mfma_f32_32x32x16_bf16 v[54:69], v[242:245], v[18:21], 0
    v_exp_f32 v74, v74
    v_exp_f32 v75, v75
    v_exp_f32 v76, v76
    v_exp_f32 v77, v77
    v_mfma_f32_32x32x8_bf16 v[54:69], v[246:247], v[22:23], v[54:69]
    v_exp_f32 v78, v78
    v_exp_f32 v79, v79
    v_exp_f32 v80, v80
    v_exp_f32 v81, v81
    v_exp_f32 v82, v82
    v_exp_f32 v83, v83
    v_exp_f32 v84, v84
    v_exp_f32 v85, v85
    v_smfmac_f32_32x32x32_bf16 v[102:117], v[248:251], v[70:77], v0
    v_exp_f32 v54, v54
    v_exp_f32 v55, v55
    v_smfmac_f32_32x32x32_bf16 v[102:117], v[252:255], v[78:85], v0
    v_exp_f32 v56, v56
    v_exp_f32 v57, v57
    v_mfma_f32_32x32x16_bf16 v[70:85], v[242:245], v[24:27], 0
    v_exp_f32 v58, v58
    v_exp_f32 v59, v59
    v_exp_f32 v60, v60
    v_exp_f32 v61, v61
    v_mfma_f32_32x32x8_bf16 v[70:85], v[246:247], v[28:29], v[70:85]
    v_exp_f32 v62, v62
    v_exp_f32 v63, v63
    v_exp_f32 v64, v64
    v_exp_f32 v65, v65
    v_exp_f32 v66, v66
    v_exp_f32 v67, v67
    v_exp_f32 v68, v68
    v_exp_f32 v69, v69
    v_smfmac_f32_32x32x32_bf16 v[118:133], v[248:251], v[54:61], v0
    v_exp_f32 v70, v70
    v_exp_f32 v71, v71
    v_smfmac_f32_32x32x32_bf16 v[118:133], v[252:255], v[62:69], v0
    v_exp_f32 v72, v72
    v_exp_f32 v73, v73
    v_mfma_f32_32x32x16_bf16 v[54:69], v[242:245], v[30:33], 0
    v_exp_f32 v74, v74
    v_exp_f32 v75, v75
    v_exp_f32 v76, v76
    v_exp_f32 v77, v77
    v_mfma_f32_32x32x8_bf16 v[54:69], v[246:247], v[34:35], v[54:69]
    v_exp_f32 v78, v78
    v_exp_f32 v79, v79
    v_exp_f32 v80, v80
    v_exp_f32 v81, v81
    v_exp_f32 v82, v82
    v_exp_f32 v83, v83
    v_exp_f32 v84, v84
    v_exp_f32 v85, v85
    v_smfmac_f32_32x32x32_bf16 v[134:149], v[248:251], v[70:77], v0
    v_exp_f32 v54, v54
    v_exp_f32 v55, v55
    v_smfmac_f32_32x32x32_bf16 v[134:149], v[252:255], v[78:85], v0
    v_exp_f32 v56, v56
    v_exp_f32 v57, v57
    v_mfma_f32_32x32x16_bf16 v[70:85], v[242:245], v[36:39], 0
    v_exp_f32 v58, v58
    v_exp_f32 v59, v59
    v_exp_f32 v60, v60
    v_exp_f32 v61, v61
    v_mfma_f32_32x32x8_bf16 v[70:85], v[246:247], v[40:41], v[70:85]
    v_exp_f32 v62, v62
    v_exp_f32 v63, v63
    v_exp_f32 v64, v64
    v_exp_f32 v65, v65
    v_exp_f32 v66, v66
    v_exp_f32 v67, v67
    v_exp_f32 v68, v68
    v_exp_f32 v69, v69
    v_smfmac_f32_32x32x32_bf16 v[150:165], v[248:251], v[54:61], v0
    v_exp_f32 v70, v70
    v_exp_f32 v71, v71
    v_smfmac_f32_32x32x32_bf16 v[150:165], v[252:255], v[62:69], v0
    v_exp_f32 v72, v72
    v_exp_f32 v73, v73
    v_mfma_f32_32x32x16_bf16 v[54:69], v[242:245], v[42:45], 0
    v_exp_f32 v74, v74
    v_exp_f32 v75, v75
    v_exp_f32 v76, v76
    v_exp_f32 v77, v77
    v_mfma_f32_32x32x8_bf16 v[54:69], v[246:247], v[46:47], v[54:69]
    v_exp_f32 v78, v78
    v_exp_f32 v79, v79
    v_exp_f32 v80, v80
    v_exp_f32 v81, v81
    v_exp_f32 v82, v82
    v_exp_f32 v83, v83
    v_exp_f32 v84, v84
    v_exp_f32 v85, v85
    v_smfmac_f32_32x32x32_bf16 v[166:181], v[248:251], v[70:77], v0
    v_exp_f32 v54, v54
    v_exp_f32 v55, v55
    v_smfmac_f32_32x32x32_bf16 v[166:181], v[252:255], v[78:85], v0
    v_exp_f32 v56, v56
    v_exp_f32 v57, v57
    v_mfma_f32_32x32x16_bf16 v[70:85], v[242:245], v[48:51], 0
    v_exp_f32 v58, v58
    v_exp_f32 v59, v59
    v_exp_f32 v60, v60
    v_exp_f32 v61, v61
    v_mfma_f32_32x32x8_bf16 v[70:85], v[246:247], v[52:53], v[70:85]
    v_exp_f32 v62, v62
    v_exp_f32 v63, v63
    v_exp_f32 v64, v64
    v_exp_f32 v65, v65
    v_exp_f32 v66, v66
    v_exp_f32 v67, v67
    v_exp_f32 v68, v68
    v_exp_f32 v69, v69
    v_smfmac_f32_32x32x32_bf16 v[182:197], v[248:251], v[54:61], v0
    v_exp_f32 v70, v70
    v_exp_f32 v71, v71
    v_smfmac_f32_32x32x32_bf16 v[182:197], v[252:255], v[62:69], v0
    v_exp_f32_e64 v72, v72
    v_exp_f32 v73, v73
    s_waitcnt vmcnt(4)
    v_mfma_f32_32x32x16_bf16 v[54:69], v[214:217], v[6:9], 0
    v_exp_f32 v74, v74
    v_exp_f32 v75, v75
    v_exp_f32 v76, v76
    v_exp_f32 v77, v77
    v_mfma_f32_32x32x8_bf16 v[54:69], v[218:219], v[10:11], v[54:69]
    v_exp_f32 v78, v78
    v_exp_f32 v79, v79
    v_exp_f32 v80, v80
    v_exp_f32 v81, v81
    v_exp_f32 v82, v82
    v_exp_f32 v83, v83
    v_exp_f32 v84, v84
    v_exp_f32 v85, v85
    v_smfmac_f32_32x32x32_bf16 v[198:213], v[248:251], v[70:77], v0
    v_exp_f32 v54, v54
    v_exp_f32 v55, v55
    v_smfmac_f32_32x32x32_bf16 v[198:213], v[252:255], v[78:85], v0
    buffer_load_dwordx4 v[242:245], v1, s[32:35], s18 offen sc1
    buffer_load_dwordx2 v[246:247], v2, s[32:35], s18 offen offset:1024 sc1
    buffer_load_dwordx4 v[248:251], v3, s[32:35], s18 offen offset:1280 sc1
    buffer_load_dwordx4 v[252:255], v3, s[32:35], s18 offen offset:1952 sc1
    v_exp_f32 v56, v56
    v_exp_f32 v57, v57
    v_mfma_f32_32x32x16_bf16 v[70:85], v[214:217], v[12:15], 0
    v_exp_f32 v58, v58
    v_exp_f32 v59, v59
    v_exp_f32 v60, v60
    v_exp_f32 v61, v61
    v_mfma_f32_32x32x8_bf16 v[70:85], v[218:219], v[16:17], v[70:85]
    v_exp_f32 v62, v62
    v_exp_f32 v63, v63
    v_exp_f32 v64, v64
    v_exp_f32 v65, v65
    v_exp_f32 v66, v66
    v_exp_f32 v67, v67
    v_exp_f32 v68, v68
    v_exp_f32 v69, v69
    v_smfmac_f32_32x32x32_bf16 v[86:101], v[220:223], v[54:61], v0
    v_exp_f32 v70, v70
    v_exp_f32 v71, v71
    v_smfmac_f32_32x32x32_bf16 v[86:101], v[224:227], v[62:69], v0
    v_exp_f32 v72, v72
    v_exp_f32 v73, v73
    v_mfma_f32_32x32x16_bf16 v[54:69], v[214:217], v[18:21], 0
    v_exp_f32 v74, v74
    v_exp_f32 v75, v75
    v_exp_f32 v76, v76
    v_exp_f32 v77, v77
    v_mfma_f32_32x32x8_bf16 v[54:69], v[218:219], v[22:23], v[54:69]
    v_exp_f32 v78, v78
    v_exp_f32 v79, v79
    v_exp_f32 v80, v80
    v_exp_f32 v81, v81
    v_exp_f32 v82, v82
    v_exp_f32 v83, v83
    v_exp_f32 v84, v84
    v_exp_f32 v85, v85
    v_smfmac_f32_32x32x32_bf16 v[102:117], v[220:223], v[70:77], v0
    v_exp_f32 v54, v54
    v_exp_f32 v55, v55
    v_smfmac_f32_32x32x32_bf16 v[102:117], v[224:227], v[78:85], v0
    v_exp_f32 v56, v56
    v_exp_f32 v57, v57
    v_mfma_f32_32x32x16_bf16 v[70:85], v[214:217], v[24:27], 0
    v_exp_f32 v58, v58
    v_exp_f32 v59, v59
    v_exp_f32 v60, v60
    v_exp_f32 v61, v61
    v_mfma_f32_32x32x8_bf16 v[70:85], v[218:219], v[28:29], v[70:85]
    v_exp_f32 v62, v62
    v_exp_f32 v63, v63
    v_exp_f32 v64, v64
    v_exp_f32 v65, v65
    v_exp_f32 v66, v66
    v_exp_f32 v67, v67
    v_exp_f32 v68, v68
    v_exp_f32 v69, v69
    v_smfmac_f32_32x32x32_bf16 v[118:133], v[220:223], v[54:61], v0
    v_exp_f32 v70, v70
    v_exp_f32 v71, v71
    v_smfmac_f32_32x32x32_bf16 v[118:133], v[224:227], v[62:69], v0
    v_exp_f32 v72, v72
    v_exp_f32 v73, v73
    v_mfma_f32_32x32x16_bf16 v[54:69], v[214:217], v[30:33], 0
    v_exp_f32 v74, v74
    v_exp_f32 v75, v75
    v_exp_f32 v76, v76
    v_exp_f32 v77, v77
    v_mfma_f32_32x32x8_bf16 v[54:69], v[218:219], v[34:35], v[54:69]
    v_exp_f32 v78, v78
    v_exp_f32 v79, v79
    v_exp_f32 v80, v80
    v_exp_f32 v81, v81
    v_exp_f32 v82, v82
    v_exp_f32 v83, v83
    v_exp_f32 v84, v84
    v_exp_f32 v85, v85
    v_smfmac_f32_32x32x32_bf16 v[134:149], v[220:223], v[70:77], v0
    v_exp_f32 v54, v54
    v_exp_f32 v55, v55
    v_smfmac_f32_32x32x32_bf16 v[134:149], v[224:227], v[78:85], v0
    v_exp_f32 v56, v56
    v_exp_f32 v57, v57
    v_mfma_f32_32x32x16_bf16 v[70:85], v[214:217], v[36:39], 0
    v_exp_f32 v58, v58
    v_exp_f32 v59, v59
    v_exp_f32 v60, v60
    v_exp_f32 v61, v61
    v_mfma_f32_32x32x8_bf16 v[70:85], v[218:219], v[40:41], v[70:85]
    v_exp_f32 v62, v62
    v_exp_f32 v63, v63
    v_exp_f32 v64, v64
    v_exp_f32 v65, v65
    v_exp_f32 v66, v66
    v_exp_f32 v67, v67
    v_exp_f32 v68, v68
    v_exp_f32 v69, v69
    v_smfmac_f32_32x32x32_bf16 v[150:165], v[220:223], v[54:61], v0
    v_exp_f32 v70, v70
    v_exp_f32 v71, v71
    v_smfmac_f32_32x32x32_bf16 v[150:165], v[224:227], v[62:69], v0
    v_exp_f32 v72, v72
    v_exp_f32 v73, v73
    v_mfma_f32_32x32x16_bf16 v[54:69], v[214:217], v[42:45], 0
    v_exp_f32 v74, v74
    v_exp_f32 v75, v75
    v_exp_f32 v76, v76
    v_exp_f32 v77, v77
    v_mfma_f32_32x32x8_bf16 v[54:69], v[218:219], v[46:47], v[54:69]
    v_exp_f32 v78, v78
    v_exp_f32 v79, v79
    v_exp_f32 v80, v80
    v_exp_f32 v81, v81
    v_exp_f32 v82, v82
    v_exp_f32 v83, v83
    v_exp_f32 v84, v84
    v_exp_f32 v85, v85
    v_smfmac_f32_32x32x32_bf16 v[166:181], v[220:223], v[70:77], v0
    v_exp_f32 v54, v54
    v_exp_f32 v55, v55
    v_smfmac_f32_32x32x32_bf16 v[166:181], v[224:227], v[78:85], v0
    v_exp_f32 v56, v56
    v_exp_f32 v57, v57
    v_mfma_f32_32x32x16_bf16 v[70:85], v[214:217], v[48:51], 0
    v_exp_f32 v58, v58
    v_exp_f32 v59, v59
    v_exp_f32 v60, v60
    v_exp_f32 v61, v61
    v_mfma_f32_32x32x8_bf16 v[70:85], v[218:219], v[52:53], v[70:85]
    v_exp_f32 v62, v62
    v_exp_f32 v63, v63
    v_exp_f32 v64, v64
    v_exp_f32 v65, v65
    v_exp_f32 v66, v66
    v_exp_f32 v67, v67
    v_exp_f32 v68, v68
    v_exp_f32 v69, v69
    v_smfmac_f32_32x32x32_bf16 v[182:197], v[220:223], v[54:61], v0
    v_exp_f32 v70, v70
    v_exp_f32 v71, v71
    v_smfmac_f32_32x32x32_bf16 v[182:197], v[224:227], v[62:69], v0
    v_exp_f32_e64 v72, v72
    v_exp_f32 v73, v73
    s_waitcnt vmcnt(4)
    v_mfma_f32_32x32x16_bf16 v[54:69], v[228:231], v[6:9], 0
    v_exp_f32 v74, v74
    v_exp_f32 v75, v75
    v_exp_f32 v76, v76
    v_exp_f32 v77, v77
    v_mfma_f32_32x32x8_bf16 v[54:69], v[232:233], v[10:11], v[54:69]
    v_exp_f32 v78, v78
    v_exp_f32 v79, v79
    v_exp_f32 v80, v80
    v_exp_f32 v81, v81
    v_exp_f32 v82, v82
    v_exp_f32 v83, v83
    v_exp_f32 v84, v84
    v_exp_f32 v85, v85
    v_smfmac_f32_32x32x32_bf16 v[198:213], v[220:223], v[70:77], v0
    v_exp_f32 v54, v54
    v_exp_f32 v55, v55
    v_smfmac_f32_32x32x32_bf16 v[198:213], v[224:227], v[78:85], v0
    buffer_load_dwordx4 v[214:217], v1, s[32:35], s19 offen sc1
    buffer_load_dwordx2 v[218:219], v2, s[32:35], s19 offen offset:1024 sc1
    buffer_load_dwordx4 v[220:223], v3, s[32:35], s19 offen offset:1280 sc1
    buffer_load_dwordx4 v[224:227], v3, s[32:35], s19 offen offset:1952 sc1
    v_exp_f32 v56, v56
    v_exp_f32 v57, v57
    v_mfma_f32_32x32x16_bf16 v[70:85], v[228:231], v[12:15], 0
    v_exp_f32 v58, v58
    v_exp_f32 v59, v59
    v_exp_f32 v60, v60
    v_exp_f32 v61, v61
    v_mfma_f32_32x32x8_bf16 v[70:85], v[232:233], v[16:17], v[70:85]
    v_exp_f32 v62, v62
    v_exp_f32 v63, v63
    v_exp_f32 v64, v64
    v_exp_f32 v65, v65
    v_exp_f32 v66, v66
    v_exp_f32 v67, v67
    v_exp_f32 v68, v68
    v_exp_f32 v69, v69
    v_smfmac_f32_32x32x32_bf16 v[86:101], v[234:237], v[54:61], v0
    v_exp_f32 v70, v70
    v_exp_f32 v71, v71
    v_smfmac_f32_32x32x32_bf16 v[86:101], v[238:241], v[62:69], v0
    v_exp_f32 v72, v72
    v_exp_f32 v73, v73
    v_mfma_f32_32x32x16_bf16 v[54:69], v[228:231], v[18:21], 0
    v_exp_f32 v74, v74
    v_exp_f32 v75, v75
    v_exp_f32 v76, v76
    v_exp_f32 v77, v77
    v_mfma_f32_32x32x8_bf16 v[54:69], v[232:233], v[22:23], v[54:69]
    v_exp_f32 v78, v78
    v_exp_f32 v79, v79
    v_exp_f32 v80, v80
    v_exp_f32 v81, v81
    v_exp_f32 v82, v82
    v_exp_f32 v83, v83
    v_exp_f32 v84, v84
    v_exp_f32 v85, v85
    v_smfmac_f32_32x32x32_bf16 v[102:117], v[234:237], v[70:77], v0
    v_exp_f32 v54, v54
    v_exp_f32 v55, v55
    v_smfmac_f32_32x32x32_bf16 v[102:117], v[238:241], v[78:85], v0
    v_exp_f32 v56, v56
    v_exp_f32 v57, v57
    v_mfma_f32_32x32x16_bf16 v[70:85], v[228:231], v[24:27], 0
    v_exp_f32 v58, v58
    v_exp_f32 v59, v59
    v_exp_f32 v60, v60
    v_exp_f32 v61, v61
    v_mfma_f32_32x32x8_bf16 v[70:85], v[232:233], v[28:29], v[70:85]
    v_exp_f32 v62, v62
    v_exp_f32 v63, v63
    v_exp_f32 v64, v64
    v_exp_f32 v65, v65
    v_exp_f32 v66, v66
    v_exp_f32 v67, v67
    v_exp_f32 v68, v68
    v_exp_f32 v69, v69
    v_smfmac_f32_32x32x32_bf16 v[118:133], v[234:237], v[54:61], v0
    v_exp_f32 v70, v70
    v_exp_f32 v71, v71
    v_smfmac_f32_32x32x32_bf16 v[118:133], v[238:241], v[62:69], v0
    v_exp_f32 v72, v72
    v_exp_f32 v73, v73
    v_mfma_f32_32x32x16_bf16 v[54:69], v[228:231], v[30:33], 0
    v_exp_f32 v74, v74
    v_exp_f32 v75, v75
    v_exp_f32 v76, v76
    v_exp_f32 v77, v77
    v_mfma_f32_32x32x8_bf16 v[54:69], v[232:233], v[34:35], v[54:69]
    v_exp_f32 v78, v78
    v_exp_f32 v79, v79
    v_exp_f32 v80, v80
    v_exp_f32 v81, v81
    v_exp_f32 v82, v82
    v_exp_f32 v83, v83
    v_exp_f32 v84, v84
    v_exp_f32 v85, v85
    v_smfmac_f32_32x32x32_bf16 v[134:149], v[234:237], v[70:77], v0
    v_exp_f32 v54, v54
    v_exp_f32 v55, v55
    v_smfmac_f32_32x32x32_bf16 v[134:149], v[238:241], v[78:85], v0
    v_exp_f32 v56, v56
    v_exp_f32 v57, v57
    v_mfma_f32_32x32x16_bf16 v[70:85], v[228:231], v[36:39], 0
    v_exp_f32 v58, v58
    v_exp_f32 v59, v59
    v_exp_f32 v60, v60
    v_exp_f32 v61, v61
    v_mfma_f32_32x32x8_bf16 v[70:85], v[232:233], v[40:41], v[70:85]
    v_exp_f32 v62, v62
    v_exp_f32 v63, v63
    v_exp_f32 v64, v64
    v_exp_f32 v65, v65
    v_exp_f32 v66, v66
    v_exp_f32 v67, v67
    v_exp_f32 v68, v68
    v_exp_f32 v69, v69
    v_smfmac_f32_32x32x32_bf16 v[150:165], v[234:237], v[54:61], v0
    v_exp_f32 v70, v70
    v_exp_f32 v71, v71
    v_smfmac_f32_32x32x32_bf16 v[150:165], v[238:241], v[62:69], v0
    v_exp_f32 v72, v72
    v_exp_f32 v73, v73
    v_mfma_f32_32x32x16_bf16 v[54:69], v[228:231], v[42:45], 0
    v_exp_f32 v74, v74
    v_exp_f32 v75, v75
    v_exp_f32 v76, v76
    v_exp_f32 v77, v77
    v_mfma_f32_32x32x8_bf16 v[54:69], v[232:233], v[46:47], v[54:69]
    v_exp_f32 v78, v78
    v_exp_f32 v79, v79
    v_exp_f32 v80, v80
    v_exp_f32 v81, v81
    v_exp_f32 v82, v82
    v_exp_f32 v83, v83
    v_exp_f32 v84, v84
    v_exp_f32 v85, v85
    v_smfmac_f32_32x32x32_bf16 v[166:181], v[234:237], v[70:77], v0
    v_exp_f32 v54, v54
    v_exp_f32 v55, v55
    v_smfmac_f32_32x32x32_bf16 v[166:181], v[238:241], v[78:85], v0
    v_exp_f32 v56, v56
    v_exp_f32 v57, v57
    v_mfma_f32_32x32x16_bf16 v[70:85], v[228:231], v[48:51], 0
    v_exp_f32 v58, v58
    v_exp_f32 v59, v59
    v_exp_f32 v60, v60
    v_exp_f32 v61, v61
    v_mfma_f32_32x32x8_bf16 v[70:85], v[232:233], v[52:53], v[70:85]
    v_exp_f32 v62, v62
    v_exp_f32 v63, v63
    v_exp_f32 v64, v64
    v_exp_f32 v65, v65
    v_exp_f32 v66, v66
    v_exp_f32 v67, v67
    v_exp_f32 v68, v68
    v_exp_f32 v69, v69
    v_smfmac_f32_32x32x32_bf16 v[182:197], v[234:237], v[54:61], v0
    v_exp_f32 v70, v70
    v_exp_f32 v71, v71
    v_smfmac_f32_32x32x32_bf16 v[182:197], v[238:241], v[62:69], v0
    v_exp_f32_e64 v72, v72
    v_exp_f32 v73, v73
    s_waitcnt vmcnt(4)
    v_mfma_f32_32x32x16_bf16 v[54:69], v[242:245], v[6:9], 0
    v_exp_f32 v74, v74
    v_exp_f32 v75, v75
    v_exp_f32 v76, v76
    v_exp_f32 v77, v77
    v_mfma_f32_32x32x8_bf16 v[54:69], v[246:247], v[10:11], v[54:69]
    v_exp_f32 v78, v78
    v_exp_f32 v79, v79
    v_exp_f32 v80, v80
    v_exp_f32 v81, v81
    v_exp_f32 v82, v82
    v_exp_f32 v83, v83
    v_exp_f32 v84, v84
    v_exp_f32 v85, v85
    v_smfmac_f32_32x32x32_bf16 v[198:213], v[234:237], v[70:77], v0
    v_exp_f32 v54, v54
    v_exp_f32 v55, v55
    v_smfmac_f32_32x32x32_bf16 v[198:213], v[238:241], v[78:85], v0
    v_exp_f32 v56, v56
    v_exp_f32 v57, v57
    v_mfma_f32_32x32x16_bf16 v[70:85], v[242:245], v[12:15], 0
    v_exp_f32 v58, v58
    v_exp_f32 v59, v59
    v_exp_f32 v60, v60
    v_exp_f32 v61, v61
    v_mfma_f32_32x32x8_bf16 v[70:85], v[246:247], v[16:17], v[70:85]
    v_exp_f32 v62, v62
    v_exp_f32 v63, v63
    v_exp_f32 v64, v64
    v_exp_f32 v65, v65
    v_exp_f32 v66, v66
    v_exp_f32 v67, v67
    v_exp_f32 v68, v68
    v_exp_f32 v69, v69
    v_smfmac_f32_32x32x32_bf16 v[86:101], v[248:251], v[54:61], v0
    v_exp_f32 v70, v70
    v_exp_f32 v71, v71
    v_smfmac_f32_32x32x32_bf16 v[86:101], v[252:255], v[62:69], v0
    v_exp_f32 v72, v72
    v_exp_f32 v73, v73
    v_mfma_f32_32x32x16_bf16 v[54:69], v[242:245], v[18:21], 0
    v_exp_f32 v74, v74
    v_exp_f32 v75, v75
    v_exp_f32 v76, v76
    v_exp_f32 v77, v77
    v_mfma_f32_32x32x8_bf16 v[54:69], v[246:247], v[22:23], v[54:69]
    v_exp_f32 v78, v78
    v_exp_f32 v79, v79
    v_exp_f32 v80, v80
    v_exp_f32 v81, v81
    v_exp_f32 v82, v82
    v_exp_f32 v83, v83
    v_exp_f32 v84, v84
    v_exp_f32 v85, v85
    v_smfmac_f32_32x32x32_bf16 v[102:117], v[248:251], v[70:77], v0
    v_exp_f32 v54, v54
    v_exp_f32 v55, v55
    v_smfmac_f32_32x32x32_bf16 v[102:117], v[252:255], v[78:85], v0
    v_exp_f32 v56, v56
    v_exp_f32 v57, v57
    v_mfma_f32_32x32x16_bf16 v[70:85], v[242:245], v[24:27], 0
    v_exp_f32 v58, v58
    v_exp_f32 v59, v59
    v_exp_f32 v60, v60
    v_exp_f32 v61, v61
    v_mfma_f32_32x32x8_bf16 v[70:85], v[246:247], v[28:29], v[70:85]
    v_exp_f32 v62, v62
    v_exp_f32 v63, v63
    v_exp_f32 v64, v64
    v_exp_f32 v65, v65
    v_exp_f32 v66, v66
    v_exp_f32 v67, v67
    v_exp_f32 v68, v68
    v_exp_f32 v69, v69
    v_smfmac_f32_32x32x32_bf16 v[118:133], v[248:251], v[54:61], v0
    v_exp_f32 v70, v70
    v_exp_f32 v71, v71
    v_smfmac_f32_32x32x32_bf16 v[118:133], v[252:255], v[62:69], v0
    v_exp_f32 v72, v72
    v_exp_f32 v73, v73
    v_mfma_f32_32x32x16_bf16 v[54:69], v[242:245], v[30:33], 0
    v_exp_f32 v74, v74
    v_exp_f32 v75, v75
    v_exp_f32 v76, v76
    v_exp_f32 v77, v77
    v_mfma_f32_32x32x8_bf16 v[54:69], v[246:247], v[34:35], v[54:69]
    v_exp_f32 v78, v78
    v_exp_f32 v79, v79
    v_exp_f32 v80, v80
    v_exp_f32 v81, v81
    v_exp_f32 v82, v82
    v_exp_f32 v83, v83
    v_exp_f32 v84, v84
    v_exp_f32 v85, v85
    v_smfmac_f32_32x32x32_bf16 v[134:149], v[248:251], v[70:77], v0
    v_exp_f32 v54, v54
    v_exp_f32 v55, v55
    v_smfmac_f32_32x32x32_bf16 v[134:149], v[252:255], v[78:85], v0
    v_exp_f32 v56, v56
    v_exp_f32 v57, v57
    v_mfma_f32_32x32x16_bf16 v[70:85], v[242:245], v[36:39], 0
    v_exp_f32 v58, v58
    v_exp_f32 v59, v59
    v_exp_f32 v60, v60
    v_exp_f32 v61, v61
    v_mfma_f32_32x32x8_bf16 v[70:85], v[246:247], v[40:41], v[70:85]
    v_exp_f32 v62, v62
    v_exp_f32 v63, v63
    v_exp_f32 v64, v64
    v_exp_f32 v65, v65
    v_exp_f32 v66, v66
    v_exp_f32 v67, v67
    v_exp_f32 v68, v68
    v_exp_f32 v69, v69
    v_smfmac_f32_32x32x32_bf16 v[150:165], v[248:251], v[54:61], v0
    v_exp_f32 v70, v70
    v_exp_f32 v71, v71
    v_smfmac_f32_32x32x32_bf16 v[150:165], v[252:255], v[62:69], v0
    v_exp_f32 v72, v72
    v_exp_f32 v73, v73
    v_mfma_f32_32x32x16_bf16 v[54:69], v[242:245], v[42:45], 0
    v_exp_f32 v74, v74
    v_exp_f32 v75, v75
    v_exp_f32 v76, v76
    v_exp_f32 v77, v77
    v_mfma_f32_32x32x8_bf16 v[54:69], v[246:247], v[46:47], v[54:69]
    v_exp_f32 v78, v78
    v_exp_f32 v79, v79
    v_exp_f32 v80, v80
    v_exp_f32 v81, v81
    v_exp_f32 v82, v82
    v_exp_f32 v83, v83
    v_exp_f32 v84, v84
    v_exp_f32 v85, v85
    v_smfmac_f32_32x32x32_bf16 v[166:181], v[248:251], v[70:77], v0
    v_exp_f32 v54, v54
    v_exp_f32 v55, v55
    v_smfmac_f32_32x32x32_bf16 v[166:181], v[252:255], v[78:85], v0
    ds_read_b32 v5, v4 offset:72
    v_exp_f32 v56, v56
    v_exp_f32 v57, v57
    v_mfma_f32_32x32x16_bf16 v[70:85], v[242:245], v[48:51], 0
    v_exp_f32 v58, v58
    v_exp_f32 v59, v59
    v_exp_f32 v60, v60
    v_exp_f32 v61, v61
    v_mfma_f32_32x32x8_bf16 v[70:85], v[246:247], v[52:53], v[70:85]
    v_exp_f32 v62, v62
    v_exp_f32 v63, v63
    v_exp_f32 v64, v64
    v_exp_f32 v65, v65
    v_exp_f32 v66, v66
    v_exp_f32 v67, v67
    v_exp_f32 v68, v68
    v_exp_f32 v69, v69
    v_smfmac_f32_32x32x32_bf16 v[182:197], v[248:251], v[54:61], v0
    v_exp_f32 v70, v70
    v_exp_f32 v71, v71
    v_smfmac_f32_32x32x32_bf16 v[182:197], v[252:255], v[62:69], v0
    v_exp_f32_e64 v72, v72
    v_exp_f32 v73, v73
    s_waitcnt vmcnt(0)
    v_mfma_f32_32x32x16_bf16 v[54:69], v[214:217], v[6:9], 0
    v_exp_f32 v74, v74
    v_exp_f32 v75, v75
    v_exp_f32 v76, v76
    v_exp_f32 v77, v77
    v_mfma_f32_32x32x8_bf16 v[54:69], v[218:219], v[10:11], v[54:69]
    v_exp_f32 v78, v78
    v_exp_f32 v79, v79
    v_exp_f32 v80, v80
    v_exp_f32 v81, v81
    v_exp_f32 v82, v82
    v_exp_f32 v83, v83
    v_exp_f32 v84, v84
    v_exp_f32 v85, v85
    v_smfmac_f32_32x32x32_bf16 v[198:213], v[248:251], v[70:77], v0
    s_waitcnt lgkmcnt(0)
    v_readfirstlane_b32 s96, v5
    s_cmp_lg_u32 s96, 1
    s_cbranch_scc1 L_verdict
L_alast:
    v_add_u32 v3, s38, v1
    v_add_u32 v2, s37, v1
    v_add_u32 v1, s36, v1
    v_mov_b32 v5, 0
    v_writelane_b32 v5, 1, 0
    v_exp_f32 v54, v54
    v_exp_f32 v55, v55
    v_smfmac_f32_32x32x32_bf16 v[198:213], v[252:255], v[78:85], v0
    v_exp_f32 v56, v56
    v_exp_f32 v57, v57
    v_mfma_f32_32x32x16_bf16 v[70:85], v[214:217], v[12:15], 0
    v_exp_f32 v58, v58
    v_exp_f32 v59, v59
    v_exp_f32 v60, v60
    v_exp_f32 v61, v61
    v_mfma_f32_32x32x8_bf16 v[70:85], v[218:219], v[16:17], v[70:85]
    v_exp_f32 v62, v62
    v_exp_f32 v63, v63
    v_exp_f32 v64, v64
    v_exp_f32 v65, v65
    v_exp_f32 v66, v66
    v_exp_f32 v67, v67
    v_exp_f32 v68, v68
    v_exp_f32 v69, v69
    v_smfmac_f32_32x32x32_bf16 v[86:101], v[220:223], v[54:61], v0
    v_exp_f32 v70, v70
    v_exp_f32 v71, v71
    v_smfmac_f32_32x32x32_bf16 v[86:101], v[224:227], v[62:69], v0
    v_exp_f32 v72, v72
    v_exp_f32 v73, v73
    v_mfma_f32_32x32x16_bf16 v[54:69], v[214:217], v[18:21], 0
    v_exp_f32 v74, v74
    v_exp_f32 v75, v75
    v_exp_f32 v76, v76
    v_exp_f32 v77, v77
    v_mfma_f32_32x32x8_bf16 v[54:69], v[218:219], v[22:23], v[54:69]
    v_exp_f32 v78, v78
    v_exp_f32 v79, v79
    v_exp_f32 v80, v80
    v_exp_f32 v81, v81
    v_exp_f32 v82, v82
    v_exp_f32 v83, v83
    v_exp_f32 v84, v84
    v_exp_f32 v85, v85
    v_smfmac_f32_32x32x32_bf16 v[102:117], v[220:223], v[70:77], v0
    v_exp_f32 v54, v54
    v_exp_f32 v55, v55
    v_smfmac_f32_32x32x32_bf16 v[102:117], v[224:227], v[78:85], v0
    ds_write_b128 v1, v[86:89] offset:0
    ds_write_b128 v1, v[90:93] offset:1024
    ds_write_b128 v1, v[94:97] offset:2048
    v_exp_f32 v56, v56
    v_exp_f32 v57, v57
    v_mfma_f32_32x32x16_bf16 v[70:85], v[214:217], v[24:27], 0
    v_exp_f32 v58, v58
    v_exp_f32 v59, v59
    v_exp_f32 v60, v60
    v_exp_f32 v61, v61
    v_mfma_f32_32x32x8_bf16 v[70:85], v[218:219], v[28:29], v[70:85]
    v_exp_f32 v62, v62
    v_exp_f32 v63, v63
    v_exp_f32 v64, v64
    v_exp_f32 v65, v65
    v_exp_f32 v66, v66
    v_exp_f32 v67, v67
    v_exp_f32 v68, v68
    v_exp_f32 v69, v69
    v_smfmac_f32_32x32x32_bf16 v[118:133], v[220:223], v[54:61], v0
    v_exp_f32 v70, v70
    v_exp_f32 v71, v71
    v_smfmac_f32_32x32x32_bf16 v[118:133], v[224:227], v[62:69], v0
    ds_write_b128 v1, v[102:105] offset:3072
    ds_write_b128 v1, v[106:109] offset:4096
    ds_write_b128 v1, v[110:113] offset:5120
    v_exp_f32 v72, v72
    v_exp_f32 v73, v73
    v_mfma_f32_32x32x16_bf16 v[54:69], v[214:217], v[30:33], 0
    v_exp_f32 v74, v74
    v_exp_f32 v75, v75
    v_exp_f32 v76, v76
    v_exp_f32 v77, v77
    v_mfma_f32_32x32x8_bf16 v[54:69], v[218:219], v[34:35], v[54:69]
    v_exp_f32 v78, v78
    v_exp_f32 v79, v79
    v_exp_f32 v80, v80
    v_exp_f32 v81, v81
    v_exp_f32 v82, v82
    v_exp_f32 v83, v83
    v_exp_f32 v84, v84
    v_exp_f32 v85, v85
    v_smfmac_f32_32x32x32_bf16 v[134:149], v[220:223], v[70:77], v0
    v_exp_f32 v54, v54
    v_exp_f32 v55, v55
    v_smfmac_f32_32x32x32_bf16 v[134:149], v[224:227], v[78:85], v0
    ds_write_b128 v2, v[118:121] offset:0
    ds_write_b128 v2, v[122:125] offset:1024
    ds_write_b128 v2, v[126:129] offset:2048
    v_exp_f32 v56, v56
    v_exp_f32 v57, v57
    v_mfma_f32_32x32x16_bf16 v[70:85], v[214:217], v[36:39], 0
    v_exp_f32 v58, v58
    v_exp_f32 v59, v59
    v_exp_f32 v60, v60
    v_exp_f32 v61, v61
    v_mfma_f32_32x32x8_bf16 v[70:85], v[218:219], v[40:41], v[70:85]
    v_exp_f32 v62, v62
    v_exp_f32 v63, v63
    v_exp_f32 v64, v64
    v_exp_f32 v65, v65
    v_exp_f32 v66, v66
    v_exp_f32 v67, v67
    v_exp_f32 v68, v68
    v_exp_f32 v69, v69
    v_smfmac_f32_32x32x32_bf16 v[150:165], v[220:223], v[54:61], v0
    v_exp_f32 v70, v70
    v_exp_f32 v71, v71
    v_smfmac_f32_32x32x32_bf16 v[150:165], v[224:227], v[62:69], v0
    ds_write_b128 v2, v[134:137] offset:3072
    ds_write_b128 v2, v[138:141] offset:4096
    ds_write_b128 v2, v[142:145] offset:5120
    v_exp_f32 v72, v72
    v_exp_f32 v73, v73
    v_mfma_f32_32x32x16_bf16 v[54:69], v[214:217], v[42:45], 0
    v_exp_f32 v74, v74
    v_exp_f32 v75, v75
    v_exp_f32 v76, v76
    v_exp_f32 v77, v77
    v_mfma_f32_32x32x8_bf16 v[54:69], v[218:219], v[46:47], v[54:69]
    v_exp_f32 v78, v78
    v_exp_f32 v79, v79
    v_exp_f32 v80, v80
    v_exp_f32 v81, v81
    v_exp_f32 v82, v82
    v_exp_f32 v83, v83
    v_exp_f32 v84, v84
    v_exp_f32 v85, v85
    v_smfmac_f32_32x32x32_bf16 v[166:181], v[220:223], v[70:77], v0
    v_exp_f32 v54, v54
    v_exp_f32 v55, v55
    v_smfmac_f32_32x32x32_bf16 v[166:181], v[224:227], v[78:85], v0
    ds_write_b128 v3, v[150:153] offset:0
    ds_write_b128 v3, v[154:157] offset:1024
    ds_write_b128 v3, v[158:161] offset:2048
    v_exp_f32 v56, v56
    v_exp_f32 v57, v57
    v_mfma_f32_32x32x16_bf16 v[70:85], v[214:217], v[48:51], 0
    v_exp_f32 v58, v58
    v_exp_f32 v59, v59
    v_exp_f32 v60, v60
    v_exp_f32 v61, v61
    v_mfma_f32_32x32x8_bf16 v[70:85], v[218:219], v[52:53], v[70:85]
    v_exp_f32 v62, v62
    v_exp_f32 v63, v63
    v_exp_f32 v64, v64
    v_exp_f32 v65, v65
    v_exp_f32 v66, v66
    v_exp_f32 v67, v67
    v_exp_f32 v68, v68
    v_exp_f32 v69, v69
    v_smfmac_f32_32x32x32_bf16 v[182:197], v[220:223], v[54:61], v0
    v_exp_f32 v70, v70
    v_exp_f32 v71, v71
    v_smfmac_f32_32x32x32_bf16 v[182:197], v[224:227], v[62:69], v0
    ds_write_b128 v3, v[166:169] offset:3072
    ds_write_b128 v3, v[170:173] offset:4096
    ds_write_b128 v3, v[174:177] offset:5120
    ds_add_u32 v4, v5 offset:28
    ds_read_b32 v27, v4 offset:28
    v_exp_f32 v72, v72
    v_exp_f32 v73, v73
    v_exp_f32 v74, v74
    v_exp_f32 v75, v75
    v_mbcnt_lo_u32_b32 v24, -1, 0
    v_mbcnt_hi_u32_b32 v24, -1, v24
    v_lshlrev_b32 v25, 4, v24
    v_add_u32 v25, s39, v25
    v_exp_f32 v76, v76
    v_exp_f32 v77, v77
    v_exp_f32 v78, v78
    v_exp_f32 v79, v79
    v_smfmac_f32_32x32x32_bf16 v[198:213], v[220:223], v[70:77], v0
    s_waitcnt lgkmcnt(0)
    v_readfirstlane_b32 s96, v27
    s_cmp_ge_u32 s96, 5
    s_cbranch_scc1 L_dok
L_wc_17:
    ds_read_b32 v27, v4 offset:28
    s_waitcnt lgkmcnt(0)
    v_readfirstlane_b32 s96, v27
    s_cmp_ge_u32 s96, 5
    s_cbranch_scc1 L_wd_18
    s_add_u32 s97, s97, 1
    s_cmp_lt_u32 s97, 1048576
    s_cbranch_scc1 L_wc_17
L_wd_18:
L_dok:
    ds_read_b128 v[86:89], v25 offset:0
    ds_read_b128 v[90:93], v25 offset:1024
    ds_read_b128 v[94:97], v25 offset:2048
    ds_read_b128 v[98:101], v25 offset:6144
    ds_read_b128 v[102:105], v25 offset:7168
    ds_read_b128 v[106:109], v25 offset:8192
    ds_read_b128 v[110:113], v25 offset:12288
    ds_read_b128 v[114:117], v25 offset:13312
    ds_read_b128 v[118:121], v25 offset:14336
    v_and_b32 v26, 0xffffff7f, v4
    ds_read2_b32 v[6:7], v26 offset0:32 offset1:64
    v_exp_f32 v80, v80
    v_exp_f32 v81, v81
    v_exp_f32 v82, v82
    v_exp_f32 v83, v83
    v_exp_f32 v84, v84
    v_exp_f32 v85, v85
    ds_read_b128 v[122:125], v25 offset:3072
    ds_read_b128 v[126:129], v25 offset:4096
    ds_read_b128 v[130:133], v25 offset:5120
    ds_read_b128 v[134:137], v25 offset:9216
    ds_read_b128 v[138:141], v25 offset:10240
    ds_read_b128 v[142:145], v25 offset:11264
    ds_read_b128 v[146:149], v25 offset:15360
    ds_read_b128 v[150:153], v25 offset:16384
    ds_read_b128 v[154:157], v25 offset:17408
    v_smfmac_f32_32x32x32_bf16 v[198:213], v[224:227], v[78:85], v0
    s_waitcnt lgkmcnt(0)
    v_add_f32 v94, v94, v106
    v_add_f32 v95, v95, v107
    v_add_f32 v130, v130, v142
    v_add_f32 v131, v131, v143
    v_bfe_u32 v2, v24, 4, 1
    v_and_b32 v3, 15, v24
    v_lshlrev_b32 v2, 10, v2
    v_add_f32 v94, v94, v118
    v_add_f32 v95, v95, v119
    v_add_f32 v130, v130, v154
    v_add_f32 v131, v131, v155
    v_add_f32 v190, v190, v94
    v_add_f32 v191, v191, v95
    v_mov_b32 v8, v190
    v_mov_b32 v9, v190
    v_add_f32 v206, v206, v130
    v_add_f32 v207, v207, v131
    v_mov_b32 v10, v206
    v_mov_b32 v11, v206
    v_permlane32_swap_b32 v8, v9
    v_lshl_add_u32 v2, v3, 4, v2
    v_permlane32_swap_b32 v10, v11
    v_rcp_f32 v8, v9
    v_rcp_f32 v10, v11
    v_lshrrev_b32 v1, 5, v24
    v_lshl_add_u32 v2, v1, 8, v2
    v_lshrrev_b32 v1, 4, v24
    v_lshlrev_b32 v1, 10, v1
    v_lshl_add_u32 v3, v3, 3, v1
    v_mul_f32 v8, v8, v6
    v_mul_f32 v10, v10, v7
    v_pk_add_f32 v[182:183], v[182:183], v[86:87]
    v_pk_add_f32 v[184:185], v[184:185], v[88:89]
    v_pk_add_f32 v[186:187], v[186:187], v[90:91]
    v_pk_add_f32 v[188:189], v[188:189], v[92:93]
    v_pk_add_f32 v[192:193], v[192:193], v[96:97]
    v_pk_add_f32 v[198:199], v[198:199], v[122:123]
    v_pk_add_f32 v[200:201], v[200:201], v[124:125]
    v_pk_add_f32 v[202:203], v[202:203], v[126:127]
    v_pk_add_f32 v[204:205], v[204:205], v[128:129]
    v_pk_add_f32 v[208:209], v[208:209], v[132:133]
    v_pk_add_f32 v[182:183], v[182:183], v[98:99]
    v_pk_add_f32 v[184:185], v[184:185], v[100:101]
    v_pk_add_f32 v[186:187], v[186:187], v[102:103]
    v_pk_add_f32 v[188:189], v[188:189], v[104:105]
    v_pk_add_f32 v[192:193], v[192:193], v[108:109]
    v_pk_add_f32 v[198:199], v[198:199], v[134:135]
    v_pk_add_f32 v[200:201], v[200:201], v[136:137]
    v_pk_add_f32 v[202:203], v[202:203], v[138:139]
    v_pk_add_f32 v[204:205], v[204:205], v[140:141]
    v_pk_add_f32 v[208:209], v[208:209], v[144:145]
    v_pk_add_f32 v[182:183], v[182:183], v[110:111]
    v_pk_add_f32 v[184:185], v[184:185], v[112:113]
    v_pk_add_f32 v[186:187], v[186:187], v[114:115]
    v_pk_add_f32 v[188:189], v[188:189], v[116:117]
    v_pk_add_f32 v[192:193], v[192:193], v[120:121]
    v_pk_add_f32 v[198:199], v[198:199], v[146:147]
    v_pk_add_f32 v[200:201], v[200:201], v[148:149]
    v_pk_add_f32 v[202:203], v[202:203], v[150:151]
    v_pk_add_f32 v[204:205], v[204:205], v[152:153]
    v_pk_add_f32 v[208:209], v[208:209], v[156:157]
    v_pk_mul_f32 v[182:183], v[182:183], v[8:9] op_sel_hi:[1,0]
    v_pk_mul_f32 v[184:185], v[184:185], v[8:9] op_sel_hi:[1,0]
    v_pk_mul_f32 v[186:187], v[186:187], v[8:9] op_sel_hi:[1,0]
    v_pk_mul_f32 v[188:189], v[188:189], v[8:9] op_sel_hi:[1,0]
    v_pk_mul_f32 v[190:191], v[190:191], v[8:9] op_sel_hi:[1,0]
    v_pk_mul_f32 v[192:193], v[192:193], v[8:9] op_sel_hi:[1,0]
    v_pk_mul_f32 v[198:199], v[198:199], v[10:11] op_sel_hi:[1,0]
    v_pk_mul_f32 v[200:201], v[200:201], v[10:11] op_sel_hi:[1,0]
    v_pk_mul_f32 v[202:203], v[202:203], v[10:11] op_sel_hi:[1,0]
    v_pk_mul_f32 v[204:205], v[204:205], v[10:11] op_sel_hi:[1,0]
    v_pk_mul_f32 v[206:207], v[206:207], v[10:11] op_sel_hi:[1,0]
    v_pk_mul_f32 v[208:209], v[208:209], v[10:11] op_sel_hi:[1,0]
    v_cvt_pk_bf16_f32 v12, v182, v183
    v_cvt_pk_bf16_f32 v13, v184, v185
    v_cvt_pk_bf16_f32 v14, v186, v187
    v_cvt_pk_bf16_f32 v15, v188, v189
    v_cvt_pk_bf16_f32 v16, v190, v191
    v_cvt_pk_bf16_f32 v17, v192, v193
    v_cvt_pk_bf16_f32 v18, v198, v199
    v_cvt_pk_bf16_f32 v19, v200, v201
    v_cvt_pk_bf16_f32 v20, v202, v203
    v_cvt_pk_bf16_f32 v21, v204, v205
    v_cvt_pk_bf16_f32 v22, v206, v207
    v_cvt_pk_bf16_f32 v23, v208, v209
    buffer_store_dwordx4 v[12:15], v2, s[32:35], s40 offen offset:0 sc1
    buffer_store_dwordx4 v[18:21], v2, s[32:35], s40 offen offset:2048 sc1
    v_permlane32_swap_b32 v16, v22
    v_permlane32_swap_b32 v17, v23
    buffer_store_dwordx2 v[16:17], v3, s[32:35], s41 offen sc1
    s_waitcnt vmcnt(0)
    ds_add_rtn_u32 v27, v4, v5 offset:40
    s_mov_b64 exec, 1
    s_waitcnt lgkmcnt(0)
    v_readfirstlane_b32 s96, v27
    v_mov_b32 v27, s52
    s_cmp_lg_u32 s96, 3
    s_cbranch_scc1 L_nf_19
    buffer_store_dword v27, v24, s[32:35], s42 offen sc1
L_nf_19:
    s_mov_b64 exec, -1
    s_endpgm
L_gemm:
    s_add_u32 s98, s3, 256
    s_cmpk_eq_u32 s98, 1280
    s_cselect_b32 s98, 0, s98
    s_add_u32 s99, s98, 256
    s_cmpk_eq_u32 s99, 1280
    s_cselect_b32 s99, 0, s99
    s_add_u32 s100, s99, 256
    s_cmpk_eq_u32 s100, 1280
    s_cselect_b32 s100, 0, s100
    s_add_u32 s101, s100, 256
    s_cmpk_eq_u32 s101, 1280
    s_cselect_b32 s101, 0, s101
    s_setprio 1
    v_lshlrev_b32 v3, 2, v0
    v_add_u32 v255, 163328, v3
    v_mov_b32 v29, 0
    ds_write_b32 v255, v29
    v_mov_b32 v30, 0
    v_writelane_b32 v30, 1, 0
    s_mov_b32 s97, 0
    s_lshr_b32 s55, s50, 3
    s_sub_u32 s53, s50, s55
    s_cmp_ge_u32 s2, 224
    s_cselect_b32 s53, 99, s53
    s_sub_u32 s48, s48, 4
    v_lshrrev_b32 v1, 4, v0
    v_and_b32 v4, 15, v0
    v_xor_b32 v4, v4, v1
    v_mul_u32_u24 v1, 1280, v1
    s_lshl_b32 s54, s48, 2
    v_xor_b32 v4, s54, v4
    v_lshl_add_u32 v21, v4, 4, v1
    v_lshlrev_b32 v1, 4, v0
    s_mul_i32 s58, s48, 16640
    s_add_u32 s58, s58, 92672
    s_mul_i32 s54, s49, 160
    s_movk_i32 s55, 1280
    s_movk_i32 s56, 5120
    s_movk_i32 s57, 25600
    v_add_u32 v32, 0, v0
    v_mul_u32_u24 v33, 6554, v32
    v_lshrrev_b32 v33, 16, v33
    v_mul_u32_u24 v36, 10, v33
    v_sub_u32 v32, v32, v36
    v_lshl_add_u32 v32, v32, 4, s54
    v_bfe_u32 v36, v33, 2, 2
    v_lshrrev_b32 v37, 4, v33
    v_and_b32 v33, 3, v33
    v_mad_u32_u24 v32, v33, s55, v32
    v_lshl_add_u32 v33, v36, 1, v37
    v_mad_u32_u24 v16, v33, s56, v32
    v_add_u32 v32, 64, v0
    v_mul_u32_u24 v33, 6554, v32
    v_lshrrev_b32 v33, 16, v33
    v_mul_u32_u24 v36, 10, v33
    v_sub_u32 v32, v32, v36
    v_lshl_add_u32 v32, v32, 4, s54
    v_bfe_u32 v36, v33, 2, 2
    v_lshrrev_b32 v37, 4, v33
    v_and_b32 v33, 3, v33
    v_mad_u32_u24 v32, v33, s55, v32
    v_subrev_u32 v32, 1024, v32
    v_lshl_add_u32 v33, v36, 1, v37
    v_mad_u32_u24 v17, v33, s56, v32
    v_add_u32 v32, 128, v0
    v_mul_u32_u24 v33, 6554, v32
    v_lshrrev_b32 v33, 16, v33
    v_mul_u32_u24 v36, 10, v33
    v_sub_u32 v32, v32, v36
    v_lshl_add_u32 v32, v32, 4, s54
    v_bfe_u32 v36, v33, 2, 2
    v_lshrrev_b32 v37, 4, v33
    v_and_b32_e64 v33, 3, v33
    v_mad_u32_u24 v32, v33, s55, v32
    v_subrev_u32 v32, 2048, v32
    v_lshl_add_u32 v33, v36, 1, v37
    v_mad_u32_u24 v18, v33, s56, v32
    v_add_u32 v32, 192, v0
    v_mul_u32_u24 v33, 6554, v32
    v_lshrrev_b32 v33, 16, v33
    v_mul_u32_u24 v36, 10, v33
    v_sub_u32 v32, v32, v36
    v_lshl_add_u32 v32, v32, 4, s54
    v_bfe_u32 v36, v33, 2, 2
    v_lshrrev_b32 v37, 4, v33
    v_and_b32_e64 v33, 3, v33
    v_mad_u32_u24 v32, v33, s55, v32
    v_subrev_u32 v32, 3072, v32
    v_lshl_add_u32 v33, v36, 1, v37
    v_mad_u32_u24 v19, v33, s56, v32
    v_add_u32 v32, 256, v0
    v_mul_u32_u24 v33, 6554, v32
    v_lshrrev_b32 v33, 16, v33
    v_mul_u32_u24 v36, 10, v33
    v_sub_u32 v32, v32, v36
    v_lshl_add_u32 v32, v32, 4, s54
    v_bfe_u32 v36, v33, 2, 2
    v_lshrrev_b32 v37, 4, v33
    v_and_b32 v33, 3, v33
    v_mad_u32_u24 v32, v33, s55, v32
    v_lshl_add_u32 v33, v36, 1, v37
    v_mad_u32_u24 v20, v33, s56, v32
    s_mul_i32 s59, s48, 40960
    s_mul_i32 s54, s50, 81920
    s_lshr_b32 s60, s49, 1
    s_xor_b32 s61, s60, 3
    s_lshl_b32 s61, s61, 2
    s_add_u32 s61, s61, s48
    s_mul_i32 s44, s61, 5120
    s_add_u32 s44, s44, s54
    s_lshl_b32 s61, s61, 10
    s_xor_b32 s62, s60, 2
    s_lshl_b32 s62, s62, 2
    s_add_u32 s62, s62, s48
    s_mul_i32 s45, s62, 5120
    s_add_u32 s45, s45, s54
    s_lshl_b32 s62, s62, 10
    s_xor_b32 s63, s60, 1
    s_lshl_b32 s63, s63, 2
    s_add_u32 s63, s63, s48
    s_mul_i32 s46, s63, 5120
    s_add_u32 s46, s46, s54
    s_lshl_b32 s63, s63, 10
    v_lshrrev_b32 v3, 4, v0
    v_and_b32 v4, 15, v0
    v_bfe_u32 v5, v0, 2, 2
    v_and_b32 v6, 3, v0
    s_lshl_b32 s54, s48, 2
    v_add_u32 v7, s54, v3
    v_xor_b32 v7, v7, v4
    v_lshlrev_b32 v7, 4, v7
    v_lshl_add_u32 v8, v4, 8, v7
    s_xor_b32 s54, s48, 0
    s_lshl_b32 s54, s54, 12
    v_add_u32 v228, s54, v8
    v_add_u32 v232, 0x10000, v228
    s_xor_b32 s54, s48, 1
    s_lshl_b32 s54, s54, 12
    v_add_u32 v229, s54, v8
    v_add_u32 v233, 0x10000, v229
    s_xor_b32 s54, s48, 2
    s_lshl_b32 s54, s54, 12
    v_add_u32 v230, s54, v8
    v_add_u32 v234, 0x10000, v230
    s_xor_b32 s54, s48, 3
    s_lshl_b32 s54, s54, 12
    v_add_u32 v231, s54, v8
    v_add_u32 v235, 0x10000, v231
    v_lshl_add_u32 v7, v3, 2, v5
    v_mul_u32_u24 v7, 160, v7
    v_lshl_add_u32 v7, v6, 3, v7
    v_add_u32 v14, s58, v7
    s_waitcnt lgkmcnt(0)
    s_load_dword s52, s[30:31], 0
    s_mov_b64 s[36:37], s[4:5]
    s_mov_b32 s38, 2621440
    s_mov_b32 s39, 0x00020000
    s_mov_b64 s[40:41], s[6:7]
    s_mov_b32 s42, 819200
    s_mov_b32 s43, 0x00020000
    s_mov_b64 s[32:33], s[30:31]
    s_mov_b32 s34, 12582912
    s_mov_b32 s35, 0x00020000
    s_barrier
    s_add_u32 m0, s61, 0
    s_add_u32 s54, s44, s3
    buffer_load_dwordx4 v21, s[36:39], s54 offen lds
    s_add_u32 m0, s62, 0
    s_add_u32 s54, s45, s3
    buffer_load_dwordx4 v21, s[36:39], s54 offen lds
    s_add_u32 m0, s63, 0
    s_add_u32 s54, s46, s3
    buffer_load_dwordx4 v21, s[36:39], s54 offen lds
    s_add_u32 m0, s61, 16384
    s_add_u32 s54, s44, s98
    buffer_load_dwordx4 v21, s[36:39], s54 offen lds
    s_add_u32 m0, s62, 16384
    s_add_u32 s54, s45, s98
    buffer_load_dwordx4 v21, s[36:39], s54 offen lds
    s_add_u32 m0, s63, 16384
    s_add_u32 s54, s46, s98
    buffer_load_dwordx4 v21, s[36:39], s54 offen lds
    s_add_u32 m0, s61, 32768
    s_add_u32 s54, s44, s99
    buffer_load_dwordx4 v21, s[36:39], s54 offen lds
    s_add_u32 m0, s62, 32768
    s_add_u32 s54, s45, s99
    buffer_load_dwordx4 v21, s[36:39], s54 offen lds
    s_add_u32 m0, s63, 32768
    s_add_u32 s54, s46, s99
    buffer_load_dwordx4 v21, s[36:39], s54 offen lds
    s_add_u32 m0, s61, 49152
    s_add_u32 s54, s44, s100
    buffer_load_dwordx4 v21, s[36:39], s54 offen lds
    s_add_u32 m0, s62, 49152
    s_add_u32 s54, s45, s100
    buffer_load_dwordx4 v21, s[36:39], s54 offen lds
    s_add_u32 m0, s63, 49152
    s_add_u32 s54, s46, s100
    buffer_load_dwordx4 v21, s[36:39], s54 offen lds
    s_add_u32 m0, s61, 65536
    s_add_u32 s54, s44, s101
    buffer_load_dwordx4 v21, s[36:39], s54 offen lds
    s_add_u32 m0, s62, 65536
    s_add_u32 s54, s45, s101
    buffer_load_dwordx4 v21, s[36:39], s54 offen lds
    s_add_u32 m0, s63, 65536
    s_add_u32 s54, s46, s101
    buffer_load_dwordx4 v21, s[36:39], s54 offen lds
    s_mul_i32 s60, s3, 640
    s_add_u32 s60, s60, s59
    s_add_u32 m0, s58, 6400
    s_nop 0
    buffer_load_dwordx4 v16, s[40:43], s60 offen offset:0 lds
    buffer_load_dwordx4 v17, s[40:43], s60 offen offset:1024 lds
    buffer_load_dwordx4 v18, s[40:43], s60 offen offset:2048 lds
    buffer_load_dwordx4 v19, s[40:43], s60 offen offset:3072 lds
    s_add_u32 m0, s58, 10496
    s_nop 0
    buffer_load_dwordx4 v20, s[40:43], s60 offen lds
    s_mul_i32 s60, s98, 640
    s_add_u32 s60, s60, s59
    s_add_u32 m0, s58, 11520
    s_nop 0
    buffer_load_dwordx4 v16, s[40:43], s60 offen offset:0 lds
    buffer_load_dwordx4 v17, s[40:43], s60 offen offset:1024 lds
    buffer_load_dwordx4 v18, s[40:43], s60 offen offset:2048 lds
    buffer_load_dwordx4 v19, s[40:43], s60 offen offset:3072 lds
    s_add_u32 m0, s58, 15616
    s_nop 0
    buffer_load_dwordx4 v20, s[40:43], s60 offen lds
    s_and_b32 s54, s48, 1
    s_lshl_b32 s54, s54, 4
    v_add_u32 v9, s54, v4
    s_lshr_b32 s54, s48, 1
    s_mul_i32 s54, s54, 1280
    s_add_u32 s54, s54, 0
    v_add_u32 v8, 0, v3
    v_mul_u32_u24 v15, 52, v8
    v_lshrrev_b32 v15, 8, v15
    v_mul_u32_u24 v31, 5, v15
    v_sub_u32 v8, v8, v31
    v_mul_u32_u24 v15, 2560, v15
    v_lshrrev_b32 v31, 1, v8
    v_lshl_add_u32 v15, v31, 9, v15
    v_and_b32 v31, 1, v8
    v_lshl_add_u32 v15, v31, 3, v15
    v_lshrrev_b32 v8, 2, v8
    v_sub_u32 v8, 4, v8
    v_lshlrev_b32 v8, v8, v9
    v_add3_u32 v160, v15, v8, s54
    v_add_u32 v8, 4, v3
    v_mul_u32_u24 v15, 52, v8
    v_lshrrev_b32 v15, 8, v15
    v_mul_u32_u24 v31, 5, v15
    v_sub_u32 v8, v8, v31
    v_mul_u32_u24 v15, 2560, v15
    v_lshrrev_b32 v31, 1, v8
    v_lshl_add_u32 v15, v31, 9, v15
    v_and_b32 v31, 1, v8
    v_lshl_add_u32 v15, v31, 3, v15
    v_lshrrev_b32 v8, 2, v8
    v_sub_u32 v8, 4, v8
    v_lshlrev_b32 v8, v8, v9
    v_add3_u32 v161, v15, v8, s54
    v_add_u32 v8, 8, v3
    v_mul_u32_u24 v15, 52, v8
    v_lshrrev_b32 v15, 8, v15
    v_mul_u32_u24 v31, 5, v15
    v_sub_u32 v8, v8, v31
    v_mul_u32_u24 v15, 2560, v15
    v_lshrrev_b32 v31, 1, v8
    v_lshl_add_u32 v15, v31, 9, v15
    v_and_b32 v31, 1, v8
    v_lshl_add_u32 v15, v31, 3, v15
    v_lshrrev_b32 v8, 2, v8
    v_sub_u32 v8, 4, v8
    v_lshlrev_b32 v8, v8, v9
    v_add3_u32 v162, v15, v8, s54
    v_add_u32 v8, 12, v3
    v_mul_u32_u24 v15, 52, v8
    v_lshrrev_b32 v15, 8, v15
    v_mul_u32_u24 v31, 5, v15
    v_sub_u32 v8, v8, v31
    v_mul_u32_u24 v15, 2560, v15
    v_lshrrev_b32 v31, 1, v8
    v_lshl_add_u32 v15, v31, 9, v15
    v_and_b32 v31, 1, v8
    v_lshl_add_u32 v15, v31, 3, v15
    v_lshrrev_b32 v8, 2, v8
    v_sub_u32 v8, 4, v8
    v_lshlrev_b32 v8, v8, v9
    v_add3_u32 v163, v15, v8, s54
    v_add_u32 v8, 16, v3
    v_mul_u32_u24 v15, 52, v8
    v_lshrrev_b32 v15, 8, v15
    v_mul_u32_u24 v31, 5, v15
    v_sub_u32 v8, v8, v31
    v_mul_u32_u24 v15, 2560, v15
    v_lshrrev_b32 v31, 1, v8
    v_lshl_add_u32 v15, v31, 9, v15
    v_and_b32 v31, 1, v8
    v_lshl_add_u32 v15, v31, 3, v15
    v_lshrrev_b32 v8, 2, v8
    v_sub_u32 v8, 4, v8
    v_lshlrev_b32_e64 v8, v8, v9
    v_add3_u32 v164, v15, v8, s54
    s_mul_i32 s57, s48, 21760
    s_add_u32 s57, s57, 76288
    v_add_u32 v12, 4096, v1
    v_lshl_add_u32 v9, v3, 2, v5
    v_bfe_u32 v15, v9, 1, 2
    v_xor_b32 v15, s48, v15
    v_lshlrev_b32 v9, 7, v9
    v_lshl_add_u32 v9, v6, 3, v9
    s_lshl_b32 s62, s48, 14
    s_add_u32 s62, s62, 10240
    v_add_u32 v13, s62, v9
    v_xor_b32 v31, 3, v15
    v_lshl_add_u32 v8, v31, 5, v13
    v_xor_b32 v31, 2, v15
    v_lshl_add_u32 v9, v31, 5, v13
    v_xor_b32 v31, 1, v15
    v_lshl_add_u32 v10, v31, 5, v13
    v_xor_b32 v31, 0, v15
    v_lshl_add_u32 v11, v31, 5, v13
    v_lshrrev_b32 v13, 3, v0
    v_bfe_u32 v31, v0, 1, 2
    v_bfe_u32 v15, v13, 1, 2
    v_xor_b32 v31, v31, v15
    v_and_b32 v15, 1, v0
    v_lshlrev_b32 v15, 4, v15
    v_lshl_add_u32 v253, v31, 5, v15
    v_lshrrev_b32 v15, 2, v13
    v_and_b32 v13, 3, v13
    v_lshl_add_u32 v252, v15, 3, v13
    v_mul_u32_u24 v13, 3456, v252
    v_add_u32 v248, v13, v253
    v_add_u32 v249, 54272, v248
    v_add_u32 v250, 11776, v248
    v_add_u32 v251, 66048, v248
    v_and_b32 v13, 31, v0
    v_lshrrev_b32 v15, 5, v0
    v_mul_u32_u24 v15, 1280, v15
    s_mul_i32 s54, s48, 2560
    s_add_u32 s54, s54, 0
    v_add_u32 v15, s54, v15
    v_lshl_add_u32 v22, v13, 4, v15
    v_lshl_add_u32 v23, v13, 3, v15
    v_lshlrev_b32 v24, 7, v0
    v_lshlrev_b32 v25, 3, v3
    v_lshrrev_b32 v13, 3, v0
    v_and_b32 v15, 7, v0
    v_lshlrev_b32 v13, 7, v13
    v_lshl_add_u32 v26, v15, 2, v13
    v_mov_b32 v27, 163328
    v_add_u32 v208, s58, v1
    v_add_u32 v2, s62, v1
    s_xor_b32 s54, s48, 1
    s_mul_i32 s55, s54, 16640
    s_add_u32 s55, s55, 92672
    v_add_u32 v209, s55, v1
    s_lshl_b32 s55, s54, 14
    s_add_u32 s55, s55, 20480
    v_add_u32 v254, s55, v1
    s_xor_b32 s54, s48, 2
    s_mul_i32 s55, s54, 16640
    s_add_u32 s55, s55, 97792
    v_add_u32 v210, s55, v1
    s_lshl_b32 s55, s54, 14
    s_add_u32 s55, s55, 15360
    v_add_u32 v6, s55, v1
    s_xor_b32 s54, s48, 3
    s_mul_i32 s55, s54, 16640
    s_add_u32 s55, s55, 102912
    v_add_u32 v211, s55, v1
    s_lshl_b32 s55, s54, 14
    s_add_u32 s55, s55, 10240
    v_add_u32 v5, s55, v1
    s_waitcnt vmcnt(10) lgkmcnt(0)
    ds_add_u32 v255, v30 offset:12
    s_mul_i32 s52, s52, 0x9E3779B1
    s_add_u32 s52, s52, 0x7F4A7C15
    s_waitcnt vmcnt(5)
    ds_read_b64_tr_b16 v[168:169], v14 offset:6400
    ds_read_b64_tr_b16 v[170:171], v14 offset:8960
    ds_read_b64_tr_b16 v[172:173], v14 offset:6432
    ds_read_b64_tr_b16 v[174:175], v14 offset:8992
    ds_read_b64_tr_b16 v[176:177], v14 offset:6464
    ds_read_b64_tr_b16 v[178:179], v14 offset:9024
    ds_read_b64_tr_b16 v[180:181], v14 offset:6496
    ds_read_b64_tr_b16 v[182:183], v14 offset:9056
    ds_read_b64_tr_b16 v[184:185], v14 offset:6528
    ds_read_b64_tr_b16 v[186:187], v14 offset:9088
    s_mul_i32 s60, s99, 640
    s_add_u32 s60, s60, s59
    s_waitcnt lgkmcnt(0)
    s_add_u32 m0, s58, 6400
    s_nop 0
    buffer_load_dwordx4 v16, s[40:43], s60 offen offset:0 lds
    buffer_load_dwordx4 v17, s[40:43], s60 offen offset:1024 lds
    buffer_load_dwordx4 v18, s[40:43], s60 offen offset:2048 lds
    buffer_load_dwordx4 v19, s[40:43], s60 offen offset:3072 lds
    s_add_u32 m0, s58, 10496
    s_nop 0
    buffer_load_dwordx4 v20, s[40:43], s60 offen lds
L_wc_20:
    ds_read_b32 v15, v255 offset:12
    s_waitcnt lgkmcnt(0)
    v_readfirstlane_b32 s96, v15
    s_cmp_ge_u32 s96, 8
    s_cbranch_scc1 L_wd_21
    s_add_u32 s97, s97, 1
    s_cmp_lt_u32 s97, 1048576
    s_cbranch_scc1 L_wc_20
L_wd_21:
    ds_read_b128 v[112:115], v228 offset:0
    ds_read_b128 v[116:119], v229 offset:0
    ds_read_b128 v[120:123], v230 offset:0
    ds_read_b128 v[124:127], v231 offset:0
    ds_read_b128 v[128:131], v228 offset:16384
    ds_read_b128 v[132:135], v229 offset:16384
    ds_read_b128 v[136:139], v230 offset:16384
    ds_read_b128 v[140:143], v231 offset:16384
    ds_read_b128 v[144:147], v228 offset:32768
    ds_read_b128 v[148:151], v229 offset:32768
    ds_read_b128 v[152:155], v230 offset:32768
    ds_read_b128 v[156:159], v231 offset:32768
    s_waitcnt lgkmcnt(8)
    v_mfma_f32_16x16x32_bf16 v[32:35], v[168:171], v[112:115], 0
    v_mfma_f32_16x16x32_bf16 v[36:39], v[168:171], v[116:119], 0
    v_mfma_f32_16x16x32_bf16 v[40:43], v[168:171], v[120:123], 0
    v_mfma_f32_16x16x32_bf16 v[44:47], v[168:171], v[124:127], 0
    v_mfma_f32_16x16x32_bf16 v[48:51], v[172:175], v[112:115], 0
    v_mfma_f32_16x16x32_bf16 v[52:55], v[172:175], v[116:119], 0
    v_mfma_f32_16x16x32_bf16 v[56:59], v[172:175], v[120:123], 0
    v_mfma_f32_16x16x32_bf16 v[60:63], v[172:175], v[124:127], 0
    v_mfma_f32_16x16x32_bf16 v[64:67], v[176:179], v[112:115], 0
    v_mfma_f32_16x16x32_bf16 v[68:71], v[176:179], v[116:119], 0
    v_mfma_f32_16x16x32_bf16 v[72:75], v[176:179], v[120:123], 0
    v_mfma_f32_16x16x32_bf16 v[76:79], v[176:179], v[124:127], 0
    v_mfma_f32_16x16x32_bf16 v[80:83], v[180:183], v[112:115], 0
    v_mfma_f32_16x16x32_bf16 v[84:87], v[180:183], v[116:119], 0
    v_mfma_f32_16x16x32_bf16 v[88:91], v[180:183], v[120:123], 0
    v_mfma_f32_16x16x32_bf16 v[92:95], v[180:183], v[124:127], 0
    v_mfma_f32_16x16x32_bf16 v[96:99], v[184:187], v[112:115], 0
    v_mfma_f32_16x16x32_bf16 v[100:103], v[184:187], v[116:119], 0
    v_mfma_f32_16x16x32_bf16 v[104:107], v[184:187], v[120:123], 0
    v_mfma_f32_16x16x32_bf16 v[108:111], v[184:187], v[124:127], 0
    s_waitcnt vmcnt(5)
    ds_read_b64_tr_b16 v[188:189], v14 offset:11520
    ds_read_b64_tr_b16 v[190:191], v14 offset:14080
    ds_read_b64_tr_b16 v[192:193], v14 offset:11552
    ds_read_b64_tr_b16 v[194:195], v14 offset:14112
    ds_read_b64_tr_b16 v[196:197], v14 offset:11584
    ds_read_b64_tr_b16 v[198:199], v14 offset:14144
    ds_read_b64_tr_b16 v[200:201], v14 offset:11616
    ds_read_b64_tr_b16 v[202:203], v14 offset:14176
    ds_read_b64_tr_b16 v[204:205], v14 offset:11648
    ds_read_b64_tr_b16 v[206:207], v14 offset:14208
    ds_read_b128 v[112:115], v228 offset:49152
    ds_read_b128 v[116:119], v229 offset:49152
    ds_read_b128 v[120:123], v230 offset:49152
    ds_read_b128 v[124:127], v231 offset:49152
    s_mul_i32 s60, s100, 640
    s_add_u32 s60, s60, s59
    s_waitcnt lgkmcnt(4)
    v_mfma_f32_16x16x32_bf16 v[32:35], v[188:191], v[128:131], v[32:35]
    s_add_u32 m0, s58, 11520
    v_mfma_f32_16x16x32_bf16 v[36:39], v[188:191], v[132:135], v[36:39]
    buffer_load_dwordx4 v16, s[40:43], s60 offen offset:0 lds
    v_mfma_f32_16x16x32_bf16 v[40:43], v[188:191], v[136:139], v[40:43]
    buffer_load_dwordx4 v17, s[40:43], s60 offen offset:1024 lds
    v_mfma_f32_16x16x32_bf16 v[44:47], v[188:191], v[140:143], v[44:47]
    buffer_load_dwordx4 v18, s[40:43], s60 offen offset:2048 lds
    v_mfma_f32_16x16x32_bf16 v[48:51], v[192:195], v[128:131], v[48:51]
    buffer_load_dwordx4 v19, s[40:43], s60 offen offset:3072 lds
    v_mfma_f32_16x16x32_bf16 v[52:55], v[192:195], v[132:135], v[52:55]
    s_add_u32 m0, s58, 15616
    v_mfma_f32_16x16x32_bf16 v[56:59], v[192:195], v[136:139], v[56:59]
    buffer_load_dwordx4 v20, s[40:43], s60 offen lds
    v_mfma_f32_16x16x32_bf16 v[60:63], v[192:195], v[140:143], v[60:63]
    v_mfma_f32_16x16x32_bf16 v[64:67], v[196:199], v[128:131], v[64:67]
    v_mfma_f32_16x16x32_bf16 v[68:71], v[196:199], v[132:135], v[68:71]
    v_mfma_f32_16x16x32_bf16 v[72:75], v[196:199], v[136:139], v[72:75]
    v_mfma_f32_16x16x32_bf16 v[76:79], v[196:199], v[140:143], v[76:79]
    v_mfma_f32_16x16x32_bf16 v[80:83], v[200:203], v[128:131], v[80:83]
    v_mfma_f32_16x16x32_bf16 v[84:87], v[200:203], v[132:135], v[84:87]
    v_mfma_f32_16x16x32_bf16 v[88:91], v[200:203], v[136:139], v[88:91]
    v_mfma_f32_16x16x32_bf16 v[92:95], v[200:203], v[140:143], v[92:95]
    v_mfma_f32_16x16x32_bf16 v[96:99], v[204:207], v[128:131], v[96:99]
    v_mfma_f32_16x16x32_bf16 v[100:103], v[204:207], v[132:135], v[100:103]
    v_mfma_f32_16x16x32_bf16 v[104:107], v[204:207], v[136:139], v[104:107]
    v_mfma_f32_16x16x32_bf16 v[108:111], v[204:207], v[140:143], v[108:111]
    s_waitcnt vmcnt(5)
    ds_read_b64_tr_b16 v[168:169], v14 offset:6400
    ds_read_b64_tr_b16 v[170:171], v14 offset:8960
    ds_read_b64_tr_b16 v[172:173], v14 offset:6432
    ds_read_b64_tr_b16 v[174:175], v14 offset:8992
    ds_read_b64_tr_b16 v[176:177], v14 offset:6464
    ds_read_b64_tr_b16 v[178:179], v14 offset:9024
    ds_read_b64_tr_b16 v[180:181], v14 offset:6496
    ds_read_b64_tr_b16 v[182:183], v14 offset:9056
    ds_read_b64_tr_b16 v[184:185], v14 offset:6528
    ds_read_b64_tr_b16 v[186:187], v14 offset:9088
    ds_read_b128 v[128:131], v232
    ds_read_b128 v[132:135], v233
    ds_read_b128 v[136:139], v234
    ds_read_b128 v[140:143], v235
    s_mul_i32 s60, s101, 640
    s_add_u32 s60, s60, s59
    s_waitcnt lgkmcnt(4)
    v_mfma_f32_16x16x32_bf16 v[32:35], v[168:171], v[144:147], v[32:35]
    s_add_u32 m0, s58, 6400
    v_mfma_f32_16x16x32_bf16 v[36:39], v[168:171], v[148:151], v[36:39]
    buffer_load_dwordx4 v16, s[40:43], s60 offen offset:0 lds
    v_mfma_f32_16x16x32_bf16 v[40:43], v[168:171], v[152:155], v[40:43]
    buffer_load_dwordx4 v17, s[40:43], s60 offen offset:1024 lds
    v_mfma_f32_16x16x32_bf16 v[44:47], v[168:171], v[156:159], v[44:47]
    buffer_load_dwordx4 v18, s[40:43], s60 offen offset:2048 lds
    v_mfma_f32_16x16x32_bf16 v[48:51], v[172:175], v[144:147], v[48:51]
    buffer_load_dwordx4 v19, s[40:43], s60 offen offset:3072 lds
    v_mfma_f32_16x16x32_bf16 v[52:55], v[172:175], v[148:151], v[52:55]
    s_add_u32 m0, s58, 10496
    v_mfma_f32_16x16x32_bf16 v[56:59], v[172:175], v[152:155], v[56:59]
    buffer_load_dwordx4 v20, s[40:43], s60 offen lds
    v_mfma_f32_16x16x32_bf16 v[60:63], v[172:175], v[156:159], v[60:63]
    v_mfma_f32_16x16x32_bf16 v[64:67], v[176:179], v[144:147], v[64:67]
    v_mfma_f32_16x16x32_bf16 v[68:71], v[176:179], v[148:151], v[68:71]
    v_mfma_f32_16x16x32_bf16 v[72:75], v[176:179], v[152:155], v[72:75]
    v_mfma_f32_16x16x32_bf16 v[76:79], v[176:179], v[156:159], v[76:79]
    v_mfma_f32_16x16x32_bf16 v[80:83], v[180:183], v[144:147], v[80:83]
    v_mfma_f32_16x16x32_bf16 v[84:87], v[180:183], v[148:151], v[84:87]
    v_mfma_f32_16x16x32_bf16 v[88:91], v[180:183], v[152:155], v[88:91]
    v_mfma_f32_16x16x32_bf16 v[92:95], v[180:183], v[156:159], v[92:95]
    v_mfma_f32_16x16x32_bf16 v[96:99], v[184:187], v[144:147], v[96:99]
    v_mfma_f32_16x16x32_bf16 v[100:103], v[184:187], v[148:151], v[100:103]
    v_mfma_f32_16x16x32_bf16 v[104:107], v[184:187], v[152:155], v[104:107]
    v_mfma_f32_16x16x32_bf16 v[108:111], v[184:187], v[156:159], v[108:111]
    s_waitcnt vmcnt(5)
    ds_read_b64_tr_b16 v[188:189], v14 offset:11520
    ds_read_b64_tr_b16 v[190:191], v14 offset:14080
    ds_read_b64_tr_b16 v[192:193], v14 offset:11552
    ds_read_b64_tr_b16 v[194:195], v14 offset:14112
    ds_read_b64_tr_b16 v[196:197], v14 offset:11584
    ds_read_b64_tr_b16 v[198:199], v14 offset:14144
    ds_read_b64_tr_b16 v[200:201], v14 offset:11616
    ds_read_b64_tr_b16 v[202:203], v14 offset:14176
    ds_read_b64_tr_b16 v[204:205], v14 offset:11648
    ds_read_b64_tr_b16 v[206:207], v14 offset:14208
    s_waitcnt lgkmcnt(0)
    v_mfma_f32_16x16x32_bf16 v[32:35], v[188:191], v[112:115], v[32:35]
    v_mfma_f32_16x16x32_bf16 v[36:39], v[188:191], v[116:119], v[36:39]
    v_mfma_f32_16x16x32_bf16 v[40:43], v[188:191], v[120:123], v[40:43]
    v_mfma_f32_16x16x32_bf16 v[44:47], v[188:191], v[124:127], v[44:47]
    v_mfma_f32_16x16x32_bf16 v[48:51], v[192:195], v[112:115], v[48:51]
    v_mfma_f32_16x16x32_bf16 v[52:55], v[192:195], v[116:119], v[52:55]
    v_mfma_f32_16x16x32_bf16 v[56:59], v[192:195], v[120:123], v[56:59]
    v_mfma_f32_16x16x32_bf16 v[60:63], v[192:195], v[124:127], v[60:63]
    v_mfma_f32_16x16x32_bf16 v[64:67], v[196:199], v[112:115], v[64:67]
    v_mfma_f32_16x16x32_bf16 v[68:71], v[196:199], v[116:119], v[68:71]
    v_mfma_f32_16x16x32_bf16 v[72:75], v[196:199], v[120:123], v[72:75]
    v_mfma_f32_16x16x32_bf16 v[76:79], v[196:199], v[124:127], v[76:79]
    v_mfma_f32_16x16x32_bf16 v[80:83], v[200:203], v[112:115], v[80:83]
    v_mfma_f32_16x16x32_bf16 v[84:87], v[200:203], v[116:119], v[84:87]
    v_mfma_f32_16x16x32_bf16 v[88:91], v[200:203], v[120:123], v[88:91]
    v_mfma_f32_16x16x32_bf16 v[92:95], v[200:203], v[124:127], v[92:95]
    v_mfma_f32_16x16x32_bf16 v[96:99], v[204:207], v[112:115], v[96:99]
    v_mfma_f32_16x16x32_bf16 v[100:103], v[204:207], v[116:119], v[100:103]
    v_mfma_f32_16x16x32_bf16 v[104:107], v[204:207], v[120:123], v[104:107]
    v_mfma_f32_16x16x32_bf16 v[108:111], v[204:207], v[124:127], v[108:111]
    s_lshl_b32 s54, s53, 7
    s_mul_i32 s61, s48, 1769472
    s_add_u32 s61, s61, s54
    s_waitcnt vmcnt(0)
    ds_read_b64_tr_b16 v[168:169], v14 offset:6400
    ds_read_b64_tr_b16 v[170:171], v14 offset:8960
    ds_read_b64_tr_b16 v[172:173], v14 offset:6432
    ds_read_b64_tr_b16 v[174:175], v14 offset:8992
    ds_read_b64_tr_b16 v[176:177], v14 offset:6464
    ds_read_b64_tr_b16 v[178:179], v14 offset:9024
    ds_read_b64_tr_b16 v[180:181], v14 offset:6496
    ds_read_b64_tr_b16 v[182:183], v14 offset:9056
    ds_read_b64_tr_b16 v[184:185], v14 offset:6528
    ds_read_b64_tr_b16 v[186:187], v14 offset:9088
    ds_add_u32 v255, v30 offset:60
    s_waitcnt lgkmcnt(0)
    s_nop 0
    v_mfma_f32_16x16x32_bf16 v[36:39], v[168:171], v[132:135], v[36:39]
    v_mfma_f32_16x16x32_bf16 v[52:55], v[172:175], v[132:135], v[52:55]
    v_mfma_f32_16x16x32_bf16 v[68:71], v[176:179], v[132:135], v[68:71]
    v_mfma_f32_16x16x32_bf16 v[84:87], v[180:183], v[132:135], v[84:87]
    v_mfma_f32_16x16x32_bf16 v[100:103], v[184:187], v[132:135], v[100:103]
    v_mfma_f32_16x16x32_bf16 v[40:43], v[168:171], v[136:139], v[40:43]
    v_mfma_f32_16x16x32_bf16 v[56:59], v[172:175], v[136:139], v[56:59]
    v_mfma_f32_16x16x32_bf16 v[72:75], v[176:179], v[136:139], v[72:75]
    v_mfma_f32_16x16x32_bf16 v[88:91], v[180:183], v[136:139], v[88:91]
    v_mfma_f32_16x16x32_bf16 v[104:107], v[184:187], v[136:139], v[104:107]
    ds_write_b128 v208, v[36:39] offset:0
    v_mfma_f32_16x16x32_bf16 v[44:47], v[168:171], v[140:143], v[44:47]
    ds_write_b128 v208, v[52:55] offset:1024
    v_mfma_f32_16x16x32_bf16 v[60:63], v[172:175], v[140:143], v[60:63]
    ds_write_b128 v208, v[68:71] offset:2048
    v_mfma_f32_16x16x32_bf16 v[76:79], v[176:179], v[140:143], v[76:79]
    ds_write_b128 v208, v[84:87] offset:3072
    v_mfma_f32_16x16x32_bf16 v[92:95], v[180:183], v[140:143], v[92:95]
    ds_write_b128 v208, v[100:103] offset:4096
    v_mfma_f32_16x16x32_bf16 v[108:111], v[184:187], v[140:143], v[108:111]
    ds_write_b128 v208, v[40:43] offset:5120
    v_mfma_f32_16x16x32_bf16 v[32:35], v[168:171], v[128:131], v[32:35]
    ds_write_b128 v208, v[56:59] offset:6144
    v_mfma_f32_16x16x32_bf16 v[48:51], v[172:175], v[128:131], v[48:51]
    ds_write_b128 v208, v[72:75] offset:7168
    v_mfma_f32_16x16x32_bf16 v[64:67], v[176:179], v[128:131], v[64:67]
    ds_write_b128 v208, v[88:91] offset:8192
    v_mfma_f32_16x16x32_bf16 v[80:83], v[180:183], v[128:131], v[80:83]
    ds_write_b128 v208, v[104:107] offset:9216
    v_mfma_f32_16x16x32_bf16 v[96:99], v[184:187], v[128:131], v[96:99]
    ds_write_b128 v208, v[44:47] offset:10240
    ds_write_b128 v208, v[60:63] offset:11264
    ds_write_b128 v208, v[76:79] offset:12288
    ds_write_b128 v208, v[92:95] offset:13312
    ds_write_b128 v208, v[108:111] offset:14336
    ds_add_u32 v255, v30 offset:16
L_wc_22:
    ds_read_b32 v15, v255 offset:16
    s_waitcnt lgkmcnt(0)
    v_readfirstlane_b32 s96, v15
    s_cmp_ge_u32 s96, 4
    s_cbranch_scc1 L_wd_23
    s_add_u32 s97, s97, 1
    s_cmp_lt_u32 s97, 1048576
    s_cbranch_scc1 L_wc_22
L_wd_23:
    ds_read_b128 v[36:39], v209 offset:0
    ds_read_b128 v[52:55], v209 offset:1024
    ds_read_b128 v[68:71], v209 offset:2048
    ds_read_b128 v[84:87], v209 offset:3072
    ds_read_b128 v[100:103], v209 offset:4096
    ds_read_b128 v[40:43], v210 offset:0
    ds_read_b128 v[56:59], v210 offset:1024
    ds_read_b128 v[72:75], v210 offset:2048
    ds_read_b128 v[88:91], v210 offset:3072
    ds_read_b128 v[104:107], v210 offset:4096
    ds_read_b128 v[44:47], v211 offset:0
    ds_read_b128 v[60:63], v211 offset:1024
    ds_read_b128 v[76:79], v211 offset:2048
    ds_read_b128 v[92:95], v211 offset:3072
    ds_read_b128 v[108:111], v211 offset:4096
    s_mov_b32 s56, 0x3ea52b5c
    s_waitcnt lgkmcnt(10)
    s_nop 0
    v_pk_add_f32 v[32:33], v[32:33], v[36:37]
    v_pk_add_f32 v[34:35], v[34:35], v[38:39]
    v_pk_add_f32 v[48:49], v[48:49], v[52:53]
    v_pk_add_f32 v[50:51], v[50:51], v[54:55]
    v_pk_add_f32 v[64:65], v[64:65], v[68:69]
    v_pk_add_f32 v[66:67], v[66:67], v[70:71]
    v_pk_add_f32 v[80:81], v[80:81], v[84:85]
    v_pk_add_f32 v[82:83], v[82:83], v[86:87]
    v_pk_add_f32 v[96:97], v[96:97], v[100:101]
    v_pk_add_f32 v[98:99], v[98:99], v[102:103]
    s_waitcnt lgkmcnt(5)
    s_nop 0
    v_pk_add_f32 v[32:33], v[32:33], v[40:41]
    v_pk_add_f32 v[34:35], v[34:35], v[42:43]
    v_pk_add_f32 v[48:49], v[48:49], v[56:57]
    v_pk_add_f32 v[50:51], v[50:51], v[58:59]
    v_pk_add_f32 v[64:65], v[64:65], v[72:73]
    v_pk_add_f32 v[66:67], v[66:67], v[74:75]
    v_pk_add_f32 v[80:81], v[80:81], v[88:89]
    v_pk_add_f32 v[82:83], v[82:83], v[90:91]
    v_pk_add_f32 v[96:97], v[96:97], v[104:105]
    v_pk_add_f32 v[98:99], v[98:99], v[106:107]
    s_waitcnt lgkmcnt(0)
    s_nop 0
    v_pk_add_f32 v[32:33], v[32:33], v[44:45]
    v_pk_add_f32 v[34:35], v[34:35], v[46:47]
    v_pk_add_f32 v[48:49], v[48:49], v[60:61]
    v_pk_add_f32 v[50:51], v[50:51], v[62:63]
    v_pk_add_f32 v[64:65], v[64:65], v[76:77]
    v_pk_add_f32 v[66:67], v[66:67], v[78:79]
    v_pk_add_f32 v[80:81], v[80:81], v[92:93]
    v_pk_add_f32 v[82:83], v[82:83], v[94:95]
    v_pk_add_f32 v[96:97], v[96:97], v[108:109]
    v_pk_add_f32 v[98:99], v[98:99], v[110:111]
    v_pk_mul_f32 v[32:33], v[32:33], s[56:57] op_sel_hi:[1,0]
    v_pk_mul_f32 v[34:35], v[34:35], s[56:57] op_sel_hi:[1,0]
    v_cvt_pk_bf16_f32 v36, v32, v33
    v_cvt_pk_bf16_f32 v37, v34, v35
    ds_write_b64 v160, v[36:37]
    v_pk_mul_f32 v[48:49], v[48:49], s[56:57] op_sel_hi:[1,0]
    v_pk_mul_f32 v[50:51], v[50:51], s[56:57] op_sel_hi:[1,0]
    v_cvt_pk_bf16_f32 v52, v48, v49
    v_cvt_pk_bf16_f32 v53, v50, v51
    ds_write_b64 v161, v[52:53]
    v_pk_mul_f32 v[64:65], v[64:65], s[56:57] op_sel_hi:[1,0]
    v_pk_mul_f32 v[66:67], v[66:67], s[56:57] op_sel_hi:[1,0]
    v_cvt_pk_bf16_f32 v68, v64, v65
    v_cvt_pk_bf16_f32 v69, v66, v67
    ds_write_b64 v162, v[68:69]
    v_pk_mul_f32 v[80:81], v[80:81], s[56:57] op_sel_hi:[1,0]
    v_pk_mul_f32 v[82:83], v[82:83], s[56:57] op_sel_hi:[1,0]
    v_cvt_pk_bf16_f32 v84, v80, v81
    v_cvt_pk_bf16_f32 v85, v82, v83
    ds_write_b64 v163, v[84:85]
    v_pk_mul_f32 v[96:97], v[96:97], s[56:57] op_sel_hi:[1,0]
    v_pk_mul_f32 v[98:99], v[98:99], s[56:57] op_sel_hi:[1,0]
    v_cvt_pk_bf16_f32 v100, v96, v97
    v_cvt_pk_bf16_f32 v101, v98, v99
    ds_write_b64 v164, v[100:101]
    ds_add_u32 v255, v30 offset:20
    ds_add_u32 v255, v30 offset:76
    s_setprio 2
    s_mov_b32 s58, s57
    v_add_u32 v14, s57, v7
    v_lshlrev_b32 v7, 3, v0
    s_mov_b64 s[36:37], s[30:31]
    s_mov_b32 s38, 12582912
    s_mov_b64 s[40:41], s[16:17]
    s_mov_b32 s42, 7077888
    s_mov_b64 s[44:45], s[18:19]
    s_mov_b32 s46, 3456
    s_mov_b32 s47, 0x00020000
    s_lshl_b32 s54, s53, 7
    s_lshl_b32 s59, s48, 5
    s_add_u32 s59, s59, s54
    s_mul_i32 s60, s48, 655360
    s_mul_i32 s54, s49, 5120
    s_add_u32 s60, s60, s54
    s_add_u32 s60, s60, 1048576
    s_lshl_b32 s63, s49, 2
    s_add_u32 s63, s63, s48
    s_lshl_b32 s3, s63, 7
    s_add_u32 s3, s3, 196608
    s_mul_i32 s63, s63, 25600
    s_add_u32 s63, s63, 9961472
    s_lshl_b32 s55, s50, 10
    s_add_u32 s55, s55, 163840
    v_mov_b32 v17, v24
L_wc_24:
    ds_read_b32 v15, v255 offset:76
    s_waitcnt lgkmcnt(0)
    v_readfirstlane_b32 s96, v15
    s_cmp_ge_u32 s96, 8
    s_cbranch_scc1 L_wd_25
    s_add_u32 s97, s97, 1
    s_cmp_lt_u32 s97, 1048576
    s_cbranch_scc1 L_wc_24
L_wd_25:
    s_setprio 0
    ds_read_b128 v[36:39], v22
    ds_read_b128 v[40:43], v22 offset:512
    ds_read_b64 v[44:45], v23 offset:1024
    s_cmp_lg_u32 s48, 1
    s_cbranch_scc1 L_nog
    buffer_load_dword v35, v26, s[32:35], s55 offen sc1
L_nog:
    s_cmp_lg_u32 s48, 2
    s_cbranch_scc1 L_nops
    s_lshr_b32 s54, s2, 6
    s_mul_i32 s54, s54, 1769472
    s_and_b32 s55, s2, 63
    s_mul_i32 s55, s55, 6912
    s_add_u32 s54, s54, s55
    s_mov_b32 exec_hi, 0x3fffff
    buffer_load_dword v31, v17, s[40:43], s54 offen
    s_mov_b32 exec_hi, -1
L_nops:
    buffer_load_dwordx2 v[240:241], v25, s[44:47], s59 offen
    s_mov_b64 s[44:45], s[20:21]
    s_mov_b32 s46, 7077888
    s_cmp_ge_u32 s53, 27
    s_cbranch_scc1 L_nopre
    s_add_u32 m0, s62, 0
    s_nop 0
    buffer_load_dwordx4 v248, s[40:43], s61 offen offset:0 lds
    buffer_load_dwordx4 v249, s[40:43], s61 offen offset:1024 lds
    buffer_load_dwordx4 v250, s[40:43], s61 offen offset:2048 lds
    buffer_load_dwordx4 v251, s[40:43], s61 offen offset:3072 lds
    s_add_u32 s61, s61, 110592
    buffer_load_dwordx4 v[112:115], v1, s[36:39], s60 offen offset:0 sc1
    buffer_load_dwordx4 v[116:119], v1, s[36:39], s60 offen offset:1024 sc1
    buffer_load_dwordx4 v[120:123], v1, s[36:39], s60 offen offset:2048 sc1
    buffer_load_dwordx4 v[124:127], v1, s[36:39], s60 offen offset:3072 sc1
    buffer_load_dwordx4 v[128:131], v12, s[36:39], s60 offen sc1
    s_add_u32 s60, s60, 40960
    s_add_u32 m0, s62, 4096
    s_nop 0
    s_nop 0
    buffer_load_dwordx4 v248, s[40:43], s61 offen offset:0 lds
    buffer_load_dwordx4 v249, s[40:43], s61 offen offset:1024 lds
    buffer_load_dwordx4 v250, s[40:43], s61 offen offset:2048 lds
    buffer_load_dwordx4 v251, s[40:43], s61 offen offset:3072 lds
    s_add_u32 s61, s61, 110592
    buffer_load_dwordx4 v[132:135], v1, s[36:39], s60 offen offset:0 sc1
    buffer_load_dwordx4 v[136:139], v1, s[36:39], s60 offen offset:1024 sc1
    buffer_load_dwordx4 v[140:143], v1, s[36:39], s60 offen offset:2048 sc1
    buffer_load_dwordx4 v[144:147], v1, s[36:39], s60 offen offset:3072 sc1
    buffer_load_dwordx4 v[148:151], v12, s[36:39], s60 offen sc1
    s_add_u32 s60, s60, 40960
    s_add_u32 m0, s62, 8192
    s_nop 0
    buffer_load_dwordx4 v248, s[40:43], s61 offen offset:0 lds
    buffer_load_dwordx4 v249, s[40:43], s61 offen offset:1024 lds
    buffer_load_dwordx4 v250, s[40:43], s61 offen offset:2048 lds
    buffer_load_dwordx4 v251, s[40:43], s61 offen offset:3072 lds
    s_add_u32 s61, s61, 110592
    s_waitcnt vmcnt(18)
    ds_read_b64_tr_b16 v[152:153], v8 offset:0
    ds_read_b64_tr_b16 v[154:155], v8 offset:2048
    ds_read_b64_tr_b16 v[156:157], v9 offset:0
    ds_read_b64_tr_b16 v[158:159], v9 offset:2048
    ds_read_b64_tr_b16 v[160:161], v10 offset:0
    ds_read_b64_tr_b16 v[162:163], v10 offset:2048
    ds_read_b64_tr_b16 v[164:165], v11 offset:0
    ds_read_b64_tr_b16 v[166:167], v11 offset:2048
    s_branch L_pred
L_nopre:
    s_waitcnt vmcnt(0)
L_pred:
    s_waitcnt lgkmcnt(0)
    s_setprio 2
    v_mov_b32 v34, 0
    v_dot2c_f32_bf16 v34, v36, v36
    v_dot2c_f32_bf16 v34, v37, v37
    v_dot2c_f32_bf16 v34, v38, v38
    v_dot2c_f32_bf16 v34, v39, v39
    v_dot2c_f32_bf16 v34, v40, v40
    v_dot2c_f32_bf16 v34, v41, v41
    v_dot2c_f32_bf16 v34, v42, v42
    v_dot2c_f32_bf16 v34, v43, v43
    v_dot2c_f32_bf16 v34, v44, v44
    v_dot2c_f32_bf16 v34, v45, v45
    v_lshlrev_b32 v244, 16, v240
    v_and_b32 v245, 0xffff0000, v240
    v_lshlrev_b32 v246, 16, v241
    v_and_b32 v247, 0xffff0000, v241
    ds_max_u32 v27, v34 offset:32
    ds_add_u32 v255, v30 offset:24
    s_cmp_lg_u32 s48, 1
    s_cbranch_scc1 L_nog2
    ds_write_b32 v255, v35 offset:128
    ds_add_u32 v255, v30 offset:28
L_nog2:
    s_cmp_ge_u32 s53, 27
    s_cbranch_scc1 L_idle
    s_waitcnt vmcnt(9) lgkmcnt(6)
    s_setprio 0
    v_mfma_f32_16x16x32_bf16 v[32:35], v[152:155], v[112:115], 0
    v_mfma_f32_16x16x32_bf16 v[48:51], v[152:155], v[116:119], 0
    v_mfma_f32_16x16x32_bf16 v[64:67], v[152:155], v[120:123], 0
    v_mfma_f32_16x16x32_bf16 v[80:83], v[152:155], v[124:127], 0
    v_mfma_f32_16x16x32_bf16 v[96:99], v[152:155], v[128:131], 0
    ds_read_b64_tr_b16 v[152:153], v8 offset:4096
    ds_read_b64_tr_b16 v[154:155], v8 offset:6144
    s_add_u32 m0, s62, 12288
    s_nop 0
    buffer_load_dwordx4 v248, s[40:43], s61 offen offset:0 lds
    s_waitcnt lgkmcnt(6)
    v_mfma_f32_16x16x32_bf16 v[36:39], v[156:159], v[112:115], 0
    v_mfma_f32_16x16x32_bf16 v[52:55], v[156:159], v[116:119], 0
    v_mfma_f32_16x16x32_bf16 v[68:71], v[156:159], v[120:123], 0
    v_mfma_f32_16x16x32_bf16 v[84:87], v[156:159], v[124:127], 0
    v_mfma_f32_16x16x32_bf16 v[100:103], v[156:159], v[128:131], 0
    ds_read_b64_tr_b16 v[156:157], v9 offset:4096
    ds_read_b64_tr_b16 v[158:159], v9 offset:6144
    buffer_load_dwordx4 v249, s[40:43], s61 offen offset:1024 lds
    buffer_load_dwordx4 v250, s[40:43], s61 offen offset:2048 lds
    s_waitcnt lgkmcnt(6)
    v_mfma_f32_16x16x32_bf16 v[40:43], v[160:163], v[112:115], 0
    v_mfma_f32_16x16x32_bf16 v[56:59], v[160:163], v[116:119], 0
    v_mfma_f32_16x16x32_bf16 v[72:75], v[160:163], v[120:123], 0
    v_mfma_f32_16x16x32_bf16 v[88:91], v[160:163], v[124:127], 0
    v_mfma_f32_16x16x32_bf16 v[104:107], v[160:163], v[128:131], 0
    ds_read_b64_tr_b16 v[160:161], v10 offset:4096
    ds_read_b64_tr_b16 v[162:163], v10 offset:6144
    buffer_load_dwordx4 v251, s[40:43], s61 offen offset:3072 lds
    s_add_u32 s61, s61, 110592
    s_waitcnt lgkmcnt(6)
    v_mfma_f32_16x16x32_bf16 v[44:47], v[164:167], v[112:115], v[244:247]
    v_mfma_f32_16x16x32_bf16 v[60:63], v[164:167], v[116:119], v[244:247]
    v_mfma_f32_16x16x32_bf16 v[76:79], v[164:167], v[120:123], v[244:247]
    v_mfma_f32_16x16x32_bf16 v[92:95], v[164:167], v[124:127], v[244:247]
    v_mfma_f32_16x16x32_bf16 v[108:111], v[164:167], v[128:131], v[244:247]
    ds_read_b64_tr_b16 v[164:165], v11 offset:4096
    ds_read_b64_tr_b16 v[166:167], v11 offset:6144
    buffer_load_dwordx4 v[112:115], v1, s[36:39], s60 offen offset:0 sc1
    buffer_load_dwordx4 v[116:119], v1, s[36:39], s60 offen offset:1024 sc1
    buffer_load_dwordx4 v[120:123], v1, s[36:39], s60 offen offset:2048 sc1
    buffer_load_dwordx4 v[124:127], v1, s[36:39], s60 offen offset:3072 sc1
    buffer_load_dwordx4 v[128:131], v12, s[36:39], s60 offen sc1
    s_add_u32 s60, s60, 40960
    s_waitcnt vmcnt(9) lgkmcnt(6)
    v_mfma_f32_16x16x32_bf16 v[32:35], v[152:155], v[132:135], v[32:35]
    v_mfma_f32_16x16x32_bf16 v[48:51], v[152:155], v[136:139], v[48:51]
    v_mfma_f32_16x16x32_bf16 v[64:67], v[152:155], v[140:143], v[64:67]
    v_mfma_f32_16x16x32_bf16 v[80:83], v[152:155], v[144:147], v[80:83]
    v_mfma_f32_16x16x32_bf16 v[96:99], v[152:155], v[148:151], v[96:99]
    ds_read_b64_tr_b16 v[152:153], v8 offset:8192
    ds_read_b64_tr_b16 v[154:155], v8 offset:10240
    s_add_u32 m0, s62, 0
    s_nop 0
    buffer_load_dwordx4 v248, s[40:43], s61 offen offset:0 lds
    s_waitcnt lgkmcnt(6)
    v_mfma_f32_16x16x32_bf16 v[36:39], v[156:159], v[132:135], v[36:39]
    v_mfma_f32_16x16x32_bf16 v[52:55], v[156:159], v[136:139], v[52:55]
    v_mfma_f32_16x16x32_bf16 v[68:71], v[156:159], v[140:143], v[68:71]
    v_mfma_f32_16x16x32_bf16 v[84:87], v[156:159], v[144:147], v[84:87]
    v_mfma_f32_16x16x32_bf16 v[100:103], v[156:159], v[148:151], v[100:103]
    ds_read_b64_tr_b16 v[156:157], v9 offset:8192
    ds_read_b64_tr_b16 v[158:159], v9 offset:10240
    buffer_load_dwordx4 v249, s[40:43], s61 offen offset:1024 lds
    buffer_load_dwordx4 v250, s[40:43], s61 offen offset:2048 lds
    s_waitcnt lgkmcnt(6)
    v_mfma_f32_16x16x32_bf16 v[40:43], v[160:163], v[132:135], v[40:43]
    v_mfma_f32_16x16x32_bf16 v[56:59], v[160:163], v[136:139], v[56:59]
    v_mfma_f32_16x16x32_bf16 v[72:75], v[160:163], v[140:143], v[72:75]
    v_mfma_f32_16x16x32_bf16 v[88:91], v[160:163], v[144:147], v[88:91]
    v_mfma_f32_16x16x32_bf16 v[104:107], v[160:163], v[148:151], v[104:107]
    ds_read_b64_tr_b16 v[160:161], v10 offset:8192
    ds_read_b64_tr_b16 v[162:163], v10 offset:10240
    buffer_load_dwordx4 v251, s[40:43], s61 offen offset:3072 lds
    s_add_u32 s61, s61, 110592
    s_waitcnt lgkmcnt(6)
    v_mfma_f32_16x16x32_bf16 v[44:47], v[164:167], v[132:135], v[44:47]
    v_mfma_f32_16x16x32_bf16 v[60:63], v[164:167], v[136:139], v[60:63]
    v_mfma_f32_16x16x32_bf16 v[76:79], v[164:167], v[140:143], v[76:79]
    v_mfma_f32_16x16x32_bf16 v[92:95], v[164:167], v[144:147], v[92:95]
    v_mfma_f32_16x16x32_bf16 v[108:111], v[164:167], v[148:151], v[108:111]
    ds_read_b64_tr_b16 v[164:165], v11 offset:8192
    ds_read_b64_tr_b16 v[166:167], v11 offset:10240
    buffer_load_dwordx4 v[132:135], v1, s[36:39], s60 offen offset:0 sc1
    buffer_load_dwordx4 v[136:139], v1, s[36:39], s60 offen offset:1024 sc1
    buffer_load_dwordx4 v[140:143], v1, s[36:39], s60 offen offset:2048 sc1
    buffer_load_dwordx4 v[144:147], v1, s[36:39], s60 offen offset:3072 sc1
    buffer_load_dwordx4 v[148:151], v12, s[36:39], s60 offen sc1
    s_add_u32 s60, s60, 40960
    s_waitcnt vmcnt(9) lgkmcnt(6)
    v_mfma_f32_16x16x32_bf16 v[32:35], v[152:155], v[112:115], v[32:35]
    v_mfma_f32_16x16x32_bf16 v[48:51], v[152:155], v[116:119], v[48:51]
    v_mfma_f32_16x16x32_bf16 v[64:67], v[152:155], v[120:123], v[64:67]
    v_mfma_f32_16x16x32_bf16 v[80:83], v[152:155], v[124:127], v[80:83]
    v_mfma_f32_16x16x32_bf16 v[96:99], v[152:155], v[128:131], v[96:99]
    ds_read_b64_tr_b16 v[152:153], v8 offset:12288
    ds_read_b64_tr_b16 v[154:155], v8 offset:14336
    s_add_u32 m0, s62, 4096
    s_nop 0
    buffer_load_dwordx4 v248, s[40:43], s61 offen offset:0 lds
    s_waitcnt lgkmcnt(6)
    v_mfma_f32_16x16x32_bf16 v[36:39], v[156:159], v[112:115], v[36:39]
    v_mfma_f32_16x16x32_bf16 v[52:55], v[156:159], v[116:119], v[52:55]
    v_mfma_f32_16x16x32_bf16 v[68:71], v[156:159], v[120:123], v[68:71]
    v_mfma_f32_16x16x32_bf16 v[84:87], v[156:159], v[124:127], v[84:87]
    v_mfma_f32_16x16x32_bf16 v[100:103], v[156:159], v[128:131], v[100:103]
    ds_read_b64_tr_b16 v[156:157], v9 offset:12288
    ds_read_b64_tr_b16 v[158:159], v9 offset:14336
    buffer_load_dwordx4 v249, s[40:43], s61 offen offset:1024 lds
    buffer_load_dwordx4 v250, s[40:43], s61 offen offset:2048 lds
    s_waitcnt lgkmcnt(6)
    v_mfma_f32_16x16x32_bf16 v[40:43], v[160:163], v[112:115], v[40:43]
    v_mfma_f32_16x16x32_bf16 v[56:59], v[160:163], v[116:119], v[56:59]
    v_mfma_f32_16x16x32_bf16 v[72:75], v[160:163], v[120:123], v[72:75]
    v_mfma_f32_16x16x32_bf16 v[88:91], v[160:163], v[124:127], v[88:91]
    v_mfma_f32_16x16x32_bf16 v[104:107], v[160:163], v[128:131], v[104:107]
    ds_read_b64_tr_b16 v[160:161], v10 offset:12288
    ds_read_b64_tr_b16 v[162:163], v10 offset:14336
    buffer_load_dwordx4 v251, s[40:43], s61 offen offset:3072 lds
    s_add_u32 s61, s61, 110592
    s_waitcnt lgkmcnt(6)
    v_mfma_f32_16x16x32_bf16 v[44:47], v[164:167], v[112:115], v[44:47]
    v_mfma_f32_16x16x32_bf16 v[60:63], v[164:167], v[116:119], v[60:63]
    v_mfma_f32_16x16x32_bf16 v[76:79], v[164:167], v[120:123], v[76:79]
    v_mfma_f32_16x16x32_bf16 v[92:95], v[164:167], v[124:127], v[92:95]
    v_mfma_f32_16x16x32_bf16 v[108:111], v[164:167], v[128:131], v[108:111]
    ds_read_b64_tr_b16 v[164:165], v11 offset:12288
    ds_read_b64_tr_b16 v[166:167], v11 offset:14336
    buffer_load_dwordx4 v[112:115], v1, s[36:39], s60 offen offset:0 sc1
    buffer_load_dwordx4 v[116:119], v1, s[36:39], s60 offen offset:1024 sc1
    buffer_load_dwordx4 v[120:123], v1, s[36:39], s60 offen offset:2048 sc1
    buffer_load_dwordx4 v[124:127], v1, s[36:39], s60 offen offset:3072 sc1
    buffer_load_dwordx4 v[128:131], v12, s[36:39], s60 offen sc1
    s_add_u32 s60, s60, 40960
    s_waitcnt vmcnt(9) lgkmcnt(6)
    v_mfma_f32_16x16x32_bf16 v[32:35], v[152:155], v[132:135], v[32:35]
    v_mfma_f32_16x16x32_bf16 v[48:51], v[152:155], v[136:139], v[48:51]
    v_mfma_f32_16x16x32_bf16 v[64:67], v[152:155], v[140:143], v[64:67]
    v_mfma_f32_16x16x32_bf16 v[80:83], v[152:155], v[144:147], v[80:83]
    v_mfma_f32_16x16x32_bf16 v[96:99], v[152:155], v[148:151], v[96:99]
    ds_read_b64_tr_b16 v[152:153], v8 offset:0
    ds_read_b64_tr_b16 v[154:155], v8 offset:2048
    s_add_u32 m0, s62, 8192
    s_nop 0
    buffer_load_dwordx4 v248, s[40:43], s61 offen offset:0 lds
    s_waitcnt lgkmcnt(6)
    v_mfma_f32_16x16x32_bf16 v[36:39], v[156:159], v[132:135], v[36:39]
    v_mfma_f32_16x16x32_bf16 v[52:55], v[156:159], v[136:139], v[52:55]
    v_mfma_f32_16x16x32_bf16 v[68:71], v[156:159], v[140:143], v[68:71]
    v_mfma_f32_16x16x32_bf16 v[84:87], v[156:159], v[144:147], v[84:87]
    v_mfma_f32_16x16x32_bf16 v[100:103], v[156:159], v[148:151], v[100:103]
    ds_read_b64_tr_b16 v[156:157], v9 offset:0
    ds_read_b64_tr_b16 v[158:159], v9 offset:2048
    buffer_load_dwordx4 v249, s[40:43], s61 offen offset:1024 lds
    buffer_load_dwordx4 v250, s[40:43], s61 offen offset:2048 lds
    s_waitcnt lgkmcnt(6)
    v_mfma_f32_16x16x32_bf16 v[40:43], v[160:163], v[132:135], v[40:43]
    v_mfma_f32_16x16x32_bf16 v[56:59], v[160:163], v[136:139], v[56:59]
    v_mfma_f32_16x16x32_bf16 v[72:75], v[160:163], v[140:143], v[72:75]
    v_mfma_f32_16x16x32_bf16 v[88:91], v[160:163], v[144:147], v[88:91]
    v_mfma_f32_16x16x32_bf16 v[104:107], v[160:163], v[148:151], v[104:107]
    ds_read_b64_tr_b16 v[160:161], v10 offset:0
    ds_read_b64_tr_b16 v[162:163], v10 offset:2048
    buffer_load_dwordx4 v251, s[40:43], s61 offen offset:3072 lds
    s_add_u32 s61, s61, 110592
    s_waitcnt lgkmcnt(6)
    v_mfma_f32_16x16x32_bf16 v[44:47], v[164:167], v[132:135], v[44:47]
    v_mfma_f32_16x16x32_bf16 v[60:63], v[164:167], v[136:139], v[60:63]
    v_mfma_f32_16x16x32_bf16 v[76:79], v[164:167], v[140:143], v[76:79]
    v_mfma_f32_16x16x32_bf16 v[92:95], v[164:167], v[144:147], v[92:95]
    v_mfma_f32_16x16x32_bf16 v[108:111], v[164:167], v[148:151], v[108:111]
    ds_read_b64_tr_b16 v[164:165], v11 offset:0
    ds_read_b64_tr_b16 v[166:167], v11 offset:2048
    buffer_load_dwordx4 v[132:135], v1, s[36:39], s60 offen offset:0 sc1
    buffer_load_dwordx4 v[136:139], v1, s[36:39], s60 offen offset:1024 sc1
    buffer_load_dwordx4 v[140:143], v1, s[36:39], s60 offen offset:2048 sc1
    buffer_load_dwordx4 v[144:147], v1, s[36:39], s60 offen offset:3072 sc1
    buffer_load_dwordx4 v[148:151], v12, s[36:39], s60 offen sc1
    s_add_u32 s60, s60, 40960
    s_waitcnt vmcnt(9) lgkmcnt(6)
    v_mfma_f32_16x16x32_bf16 v[32:35], v[152:155], v[112:115], v[32:35]
    v_mfma_f32_16x16x32_bf16 v[48:51], v[152:155], v[116:119], v[48:51]
    v_mfma_f32_16x16x32_bf16 v[64:67], v[152:155], v[120:123], v[64:67]
    v_mfma_f32_16x16x32_bf16 v[80:83], v[152:155], v[124:127], v[80:83]
    v_mfma_f32_16x16x32_bf16 v[96:99], v[152:155], v[128:131], v[96:99]
    ds_read_b64_tr_b16 v[152:153], v8 offset:4096
    ds_read_b64_tr_b16 v[154:155], v8 offset:6144
    s_add_u32 m0, s62, 12288
    s_nop 0
    buffer_load_dwordx4 v248, s[40:43], s61 offen offset:0 lds
    s_waitcnt lgkmcnt(6)
    v_mfma_f32_16x16x32_bf16 v[36:39], v[156:159], v[112:115], v[36:39]
    v_mfma_f32_16x16x32_bf16 v[52:55], v[156:159], v[116:119], v[52:55]
    v_mfma_f32_16x16x32_bf16 v[68:71], v[156:159], v[120:123], v[68:71]
    v_mfma_f32_16x16x32_bf16 v[84:87], v[156:159], v[124:127], v[84:87]
    v_mfma_f32_16x16x32_bf16 v[100:103], v[156:159], v[128:131], v[100:103]
    ds_read_b64_tr_b16 v[156:157], v9 offset:4096
    ds_read_b64_tr_b16 v[158:159], v9 offset:6144
    buffer_load_dwordx4 v249, s[40:43], s61 offen offset:1024 lds
    buffer_load_dwordx4 v250, s[40:43], s61 offen offset:2048 lds
    s_waitcnt lgkmcnt(6)
    v_mfma_f32_16x16x32_bf16 v[40:43], v[160:163], v[112:115], v[40:43]
    v_mfma_f32_16x16x32_bf16 v[56:59], v[160:163], v[116:119], v[56:59]
    v_mfma_f32_16x16x32_bf16 v[72:75], v[160:163], v[120:123], v[72:75]
    v_mfma_f32_16x16x32_bf16 v[88:91], v[160:163], v[124:127], v[88:91]
    v_mfma_f32_16x16x32_bf16 v[104:107], v[160:163], v[128:131], v[104:107]
    ds_read_b64_tr_b16 v[160:161], v10 offset:4096
    ds_read_b64_tr_b16 v[162:163], v10 offset:6144
    buffer_load_dwordx4 v251, s[40:43], s61 offen offset:3072 lds
    s_add_u32 s61, s61, 110592
    s_waitcnt lgkmcnt(6)
    v_mfma_f32_16x16x32_bf16 v[44:47], v[164:167], v[112:115], v[44:47]
    v_mfma_f32_16x16x32_bf16 v[60:63], v[164:167], v[116:119], v[60:63]
    v_mfma_f32_16x16x32_bf16 v[76:79], v[164:167], v[120:123], v[76:79]
    v_mfma_f32_16x16x32_bf16 v[92:95], v[164:167], v[124:127], v[92:95]
    v_mfma_f32_16x16x32_bf16 v[108:111], v[164:167], v[128:131], v[108:111]
    ds_read_b64_tr_b16 v[164:165], v11 offset:4096
    ds_read_b64_tr_b16 v[166:167], v11 offset:6144
    buffer_load_dwordx4 v[112:115], v1, s[36:39], s60 offen offset:0 sc1
    buffer_load_dwordx4 v[116:119], v1, s[36:39], s60 offen offset:1024 sc1
    buffer_load_dwordx4 v[120:123], v1, s[36:39], s60 offen offset:2048 sc1
    buffer_load_dwordx4 v[124:127], v1, s[36:39], s60 offen offset:3072 sc1
    buffer_load_dwordx4 v[128:131], v12, s[36:39], s60 offen sc1
    s_add_u32 s60, s60, 40960
    s_waitcnt vmcnt(9) lgkmcnt(6)
    v_mfma_f32_16x16x32_bf16 v[32:35], v[152:155], v[132:135], v[32:35]
    v_mfma_f32_16x16x32_bf16 v[48:51], v[152:155], v[136:139], v[48:51]
    v_mfma_f32_16x16x32_bf16 v[64:67], v[152:155], v[140:143], v[64:67]
    v_mfma_f32_16x16x32_bf16 v[80:83], v[152:155], v[144:147], v[80:83]
    v_mfma_f32_16x16x32_bf16 v[96:99], v[152:155], v[148:151], v[96:99]
    ds_read_b64_tr_b16 v[152:153], v8 offset:8192
    ds_read_b64_tr_b16 v[154:155], v8 offset:10240
    s_add_u32 m0, s62, 0
    s_nop 0
    buffer_load_dwordx4 v248, s[40:43], s61 offen offset:0 lds
    s_waitcnt lgkmcnt(6)
    v_mfma_f32_16x16x32_bf16 v[36:39], v[156:159], v[132:135], v[36:39]
    v_mfma_f32_16x16x32_bf16 v[52:55], v[156:159], v[136:139], v[52:55]
    v_mfma_f32_16x16x32_bf16 v[68:71], v[156:159], v[140:143], v[68:71]
    v_mfma_f32_16x16x32_bf16 v[84:87], v[156:159], v[144:147], v[84:87]
    v_mfma_f32_16x16x32_bf16 v[100:103], v[156:159], v[148:151], v[100:103]
    ds_read_b64_tr_b16 v[156:157], v9 offset:8192
    ds_read_b64_tr_b16 v[158:159], v9 offset:10240
    buffer_load_dwordx4 v249, s[40:43], s61 offen offset:1024 lds
    buffer_load_dwordx4 v250, s[40:43], s61 offen offset:2048 lds
    s_waitcnt lgkmcnt(6)
    v_mfma_f32_16x16x32_bf16 v[40:43], v[160:163], v[132:135], v[40:43]
    v_mfma_f32_16x16x32_bf16 v[56:59], v[160:163], v[136:139], v[56:59]
    v_mfma_f32_16x16x32_bf16 v[72:75], v[160:163], v[140:143], v[72:75]
    v_mfma_f32_16x16x32_bf16 v[88:91], v[160:163], v[144:147], v[88:91]
    v_mfma_f32_16x16x32_bf16 v[104:107], v[160:163], v[148:151], v[104:107]
    ds_read_b64_tr_b16 v[160:161], v10 offset:8192
    ds_read_b64_tr_b16 v[162:163], v10 offset:10240
    buffer_load_dwordx4 v251, s[40:43], s61 offen offset:3072 lds
    s_add_u32 s61, s61, 110592
    s_waitcnt lgkmcnt(6)
    v_mfma_f32_16x16x32_bf16 v[44:47], v[164:167], v[132:135], v[44:47]
    v_mfma_f32_16x16x32_bf16 v[60:63], v[164:167], v[136:139], v[60:63]
    v_mfma_f32_16x16x32_bf16 v[76:79], v[164:167], v[140:143], v[76:79]
    v_mfma_f32_16x16x32_bf16 v[92:95], v[164:167], v[144:147], v[92:95]
    v_mfma_f32_16x16x32_bf16 v[108:111], v[164:167], v[148:151], v[108:111]
    ds_read_b64_tr_b16 v[164:165], v11 offset:8192
    ds_read_b64_tr_b16 v[166:167], v11 offset:10240
    buffer_load_dwordx4 v[132:135], v1, s[36:39], s60 offen offset:0 sc1
    buffer_load_dwordx4 v[136:139], v1, s[36:39], s60 offen offset:1024 sc1
    buffer_load_dwordx4 v[140:143], v1, s[36:39], s60 offen offset:2048 sc1
    buffer_load_dwordx4 v[144:147], v1, s[36:39], s60 offen offset:3072 sc1
    buffer_load_dwordx4 v[148:151], v12, s[36:39], s60 offen sc1
    s_add_u32 s60, s60, 40960
    s_waitcnt vmcnt(9) lgkmcnt(6)
    v_mfma_f32_16x16x32_bf16 v[32:35], v[152:155], v[112:115], v[32:35]
    v_mfma_f32_16x16x32_bf16 v[48:51], v[152:155], v[116:119], v[48:51]
    v_mfma_f32_16x16x32_bf16 v[64:67], v[152:155], v[120:123], v[64:67]
    v_mfma_f32_16x16x32_bf16 v[80:83], v[152:155], v[124:127], v[80:83]
    v_mfma_f32_16x16x32_bf16 v[96:99], v[152:155], v[128:131], v[96:99]
    ds_read_b64_tr_b16 v[152:153], v8 offset:12288
    ds_read_b64_tr_b16 v[154:155], v8 offset:14336
    s_add_u32 m0, s62, 4096
    s_nop 0
    buffer_load_dwordx4 v248, s[40:43], s61 offen offset:0 lds
    s_waitcnt lgkmcnt(6)
    v_mfma_f32_16x16x32_bf16 v[36:39], v[156:159], v[112:115], v[36:39]
    v_mfma_f32_16x16x32_bf16 v[52:55], v[156:159], v[116:119], v[52:55]
    v_mfma_f32_16x16x32_bf16 v[68:71], v[156:159], v[120:123], v[68:71]
    v_mfma_f32_16x16x32_bf16 v[84:87], v[156:159], v[124:127], v[84:87]
    v_mfma_f32_16x16x32_bf16 v[100:103], v[156:159], v[128:131], v[100:103]
    ds_read_b64_tr_b16 v[156:157], v9 offset:12288
    ds_read_b64_tr_b16 v[158:159], v9 offset:14336
    buffer_load_dwordx4 v249, s[40:43], s61 offen offset:1024 lds
    buffer_load_dwordx4 v250, s[40:43], s61 offen offset:2048 lds
    s_waitcnt lgkmcnt(6)
    v_mfma_f32_16x16x32_bf16 v[40:43], v[160:163], v[112:115], v[40:43]
    v_mfma_f32_16x16x32_bf16 v[56:59], v[160:163], v[116:119], v[56:59]
    v_mfma_f32_16x16x32_bf16 v[72:75], v[160:163], v[120:123], v[72:75]
    v_mfma_f32_16x16x32_bf16 v[88:91], v[160:163], v[124:127], v[88:91]
    v_mfma_f32_16x16x32_bf16 v[104:107], v[160:163], v[128:131], v[104:107]
    ds_read_b64_tr_b16 v[160:161], v10 offset:12288
    ds_read_b64_tr_b16 v[162:163], v10 offset:14336
    buffer_load_dwordx4 v251, s[40:43], s61 offen offset:3072 lds
    s_add_u32 s61, s61, 110592
    s_waitcnt lgkmcnt(6)
    v_mfma_f32_16x16x32_bf16 v[44:47], v[164:167], v[112:115], v[44:47]
    v_mfma_f32_16x16x32_bf16 v[60:63], v[164:167], v[116:119], v[60:63]
    v_mfma_f32_16x16x32_bf16 v[76:79], v[164:167], v[120:123], v[76:79]
    v_mfma_f32_16x16x32_bf16 v[92:95], v[164:167], v[124:127], v[92:95]
    v_mfma_f32_16x16x32_bf16 v[108:111], v[164:167], v[128:131], v[108:111]
    ds_read_b64_tr_b16 v[164:165], v11 offset:12288
    ds_read_b64_tr_b16 v[166:167], v11 offset:14336
    buffer_load_dwordx4 v[112:115], v1, s[36:39], s60 offen offset:0 sc1
    buffer_load_dwordx4 v[116:119], v1, s[36:39], s60 offen offset:1024 sc1
    buffer_load_dwordx4 v[120:123], v1, s[36:39], s60 offen offset:2048 sc1
    buffer_load_dwordx4 v[124:127], v1, s[36:39], s60 offen offset:3072 sc1
    buffer_load_dwordx4 v[128:131], v12, s[36:39], s60 offen sc1
    s_add_u32 s60, s60, 40960
    s_waitcnt vmcnt(9) lgkmcnt(6)
    v_mfma_f32_16x16x32_bf16 v[32:35], v[152:155], v[132:135], v[32:35]
    v_mfma_f32_16x16x32_bf16 v[48:51], v[152:155], v[136:139], v[48:51]
    v_mfma_f32_16x16x32_bf16 v[64:67], v[152:155], v[140:143], v[64:67]
    v_mfma_f32_16x16x32_bf16 v[80:83], v[152:155], v[144:147], v[80:83]
    v_mfma_f32_16x16x32_bf16 v[96:99], v[152:155], v[148:151], v[96:99]
    ds_read_b64_tr_b16 v[152:153], v8 offset:0
    ds_read_b64_tr_b16 v[154:155], v8 offset:2048
    s_add_u32 m0, s62, 8192
    s_nop 0
    buffer_load_dwordx4 v248, s[40:43], s61 offen offset:0 lds
    s_waitcnt lgkmcnt(6)
    v_mfma_f32_16x16x32_bf16 v[36:39], v[156:159], v[132:135], v[36:39]
    v_mfma_f32_16x16x32_bf16 v[52:55], v[156:159], v[136:139], v[52:55]
    v_mfma_f32_16x16x32_bf16 v[68:71], v[156:159], v[140:143], v[68:71]
    v_mfma_f32_16x16x32_bf16 v[84:87], v[156:159], v[144:147], v[84:87]
    v_mfma_f32_16x16x32_bf16 v[100:103], v[156:159], v[148:151], v[100:103]
    ds_read_b64_tr_b16 v[156:157], v9 offset:0
    ds_read_b64_tr_b16 v[158:159], v9 offset:2048
    buffer_load_dwordx4 v249, s[40:43], s61 offen offset:1024 lds
    buffer_load_dwordx4 v250, s[40:43], s61 offen offset:2048 lds
    s_waitcnt lgkmcnt(6)
    v_mfma_f32_16x16x32_bf16 v[40:43], v[160:163], v[132:135], v[40:43]
    v_mfma_f32_16x16x32_bf16 v[56:59], v[160:163], v[136:139], v[56:59]
    v_mfma_f32_16x16x32_bf16 v[72:75], v[160:163], v[140:143], v[72:75]
    v_mfma_f32_16x16x32_bf16 v[88:91], v[160:163], v[144:147], v[88:91]
    v_mfma_f32_16x16x32_bf16 v[104:107], v[160:163], v[148:151], v[104:107]
    ds_read_b64_tr_b16 v[160:161], v10 offset:0
    ds_read_b64_tr_b16 v[162:163], v10 offset:2048
    buffer_load_dwordx4 v251, s[40:43], s61 offen offset:3072 lds
    s_add_u32 s61, s61, 110592
    s_waitcnt lgkmcnt(6)
    v_mfma_f32_16x16x32_bf16 v[44:47], v[164:167], v[132:135], v[44:47]
    v_mfma_f32_16x16x32_bf16 v[60:63], v[164:167], v[136:139], v[60:63]
    v_mfma_f32_16x16x32_bf16 v[76:79], v[164:167], v[140:143], v[76:79]
    v_mfma_f32_16x16x32_bf16 v[92:95], v[164:167], v[144:147], v[92:95]
    v_mfma_f32_16x16x32_bf16 v[108:111], v[164:167], v[148:151], v[108:111]
    ds_read_b64_tr_b16 v[164:165], v11 offset:0
    ds_read_b64_tr_b16 v[166:167], v11 offset:2048
    buffer_load_dwordx4 v[132:135], v1, s[36:39], s60 offen offset:0 sc1
    buffer_load_dwordx4 v[136:139], v1, s[36:39], s60 offen offset:1024 sc1
    buffer_load_dwordx4 v[140:143], v1, s[36:39], s60 offen offset:2048 sc1
    buffer_load_dwordx4 v[144:147], v1, s[36:39], s60 offen offset:3072 sc1
    buffer_load_dwordx4 v[148:151], v12, s[36:39], s60 offen sc1
    s_add_u32 s60, s60, 40960
    s_waitcnt vmcnt(9) lgkmcnt(6)
    v_mfma_f32_16x16x32_bf16 v[32:35], v[152:155], v[112:115], v[32:35]
    v_mfma_f32_16x16x32_bf16 v[48:51], v[152:155], v[116:119], v[48:51]
    v_mfma_f32_16x16x32_bf16 v[64:67], v[152:155], v[120:123], v[64:67]
    v_mfma_f32_16x16x32_bf16 v[80:83], v[152:155], v[124:127], v[80:83]
    v_mfma_f32_16x16x32_bf16 v[96:99], v[152:155], v[128:131], v[96:99]
    ds_read_b64_tr_b16 v[152:153], v8 offset:4096
    ds_read_b64_tr_b16 v[154:155], v8 offset:6144
    s_add_u32 m0, s62, 12288
    s_nop 0
    buffer_load_dwordx4 v248, s[40:43], s61 offen offset:0 lds
    s_waitcnt lgkmcnt(6)
    v_mfma_f32_16x16x32_bf16 v[36:39], v[156:159], v[112:115], v[36:39]
    v_mfma_f32_16x16x32_bf16 v[52:55], v[156:159], v[116:119], v[52:55]
    v_mfma_f32_16x16x32_bf16 v[68:71], v[156:159], v[120:123], v[68:71]
    v_mfma_f32_16x16x32_bf16 v[84:87], v[156:159], v[124:127], v[84:87]
    v_mfma_f32_16x16x32_bf16 v[100:103], v[156:159], v[128:131], v[100:103]
    ds_read_b64_tr_b16 v[156:157], v9 offset:4096
    ds_read_b64_tr_b16 v[158:159], v9 offset:6144
    buffer_load_dwordx4 v249, s[40:43], s61 offen offset:1024 lds
    buffer_load_dwordx4 v250, s[40:43], s61 offen offset:2048 lds
    s_waitcnt lgkmcnt(6)
    v_mfma_f32_16x16x32_bf16 v[40:43], v[160:163], v[112:115], v[40:43]
    v_mfma_f32_16x16x32_bf16 v[56:59], v[160:163], v[116:119], v[56:59]
    v_mfma_f32_16x16x32_bf16 v[72:75], v[160:163], v[120:123], v[72:75]
    v_mfma_f32_16x16x32_bf16 v[88:91], v[160:163], v[124:127], v[88:91]
    v_mfma_f32_16x16x32_bf16 v[104:107], v[160:163], v[128:131], v[104:107]
    ds_read_b64_tr_b16 v[160:161], v10 offset:4096
    ds_read_b64_tr_b16 v[162:163], v10 offset:6144
    buffer_load_dwordx4 v251, s[40:43], s61 offen offset:3072 lds
    s_add_u32 s61, s61, 110592
    s_waitcnt lgkmcnt(6)
    v_mfma_f32_16x16x32_bf16 v[44:47], v[164:167], v[112:115], v[44:47]
    v_mfma_f32_16x16x32_bf16 v[60:63], v[164:167], v[116:119], v[60:63]
    v_mfma_f32_16x16x32_bf16 v[76:79], v[164:167], v[120:123], v[76:79]
    v_mfma_f32_16x16x32_bf16 v[92:95], v[164:167], v[124:127], v[92:95]
    v_mfma_f32_16x16x32_bf16 v[108:111], v[164:167], v[128:131], v[108:111]
    ds_read_b64_tr_b16 v[164:165], v11 offset:4096
    ds_read_b64_tr_b16 v[166:167], v11 offset:6144
    buffer_load_dwordx4 v[112:115], v1, s[36:39], s60 offen offset:0 sc1
    buffer_load_dwordx4 v[116:119], v1, s[36:39], s60 offen offset:1024 sc1
    buffer_load_dwordx4 v[120:123], v1, s[36:39], s60 offen offset:2048 sc1
    buffer_load_dwordx4 v[124:127], v1, s[36:39], s60 offen offset:3072 sc1
    buffer_load_dwordx4 v[128:131], v12, s[36:39], s60 offen sc1
    s_add_u32 s60, s60, 40960
    s_waitcnt vmcnt(9) lgkmcnt(6)
    v_mfma_f32_16x16x32_bf16 v[32:35], v[152:155], v[132:135], v[32:35]
    v_mfma_f32_16x16x32_bf16 v[48:51], v[152:155], v[136:139], v[48:51]
    v_mfma_f32_16x16x32_bf16 v[64:67], v[152:155], v[140:143], v[64:67]
    v_mfma_f32_16x16x32_bf16 v[80:83], v[152:155], v[144:147], v[80:83]
    v_mfma_f32_16x16x32_bf16 v[96:99], v[152:155], v[148:151], v[96:99]
    ds_read_b64_tr_b16 v[152:153], v8 offset:8192
    ds_read_b64_tr_b16 v[154:155], v8 offset:10240
    s_add_u32 m0, s62, 0
    s_nop 0
    buffer_load_dwordx4 v248, s[40:43], s61 offen offset:0 lds
    s_waitcnt lgkmcnt(6)
    v_mfma_f32_16x16x32_bf16 v[36:39], v[156:159], v[132:135], v[36:39]
    v_mfma_f32_16x16x32_bf16 v[52:55], v[156:159], v[136:139], v[52:55]
    v_mfma_f32_16x16x32_bf16 v[68:71], v[156:159], v[140:143], v[68:71]
    v_mfma_f32_16x16x32_bf16 v[84:87], v[156:159], v[144:147], v[84:87]
    v_mfma_f32_16x16x32_bf16 v[100:103], v[156:159], v[148:151], v[100:103]
    ds_read_b64_tr_b16 v[156:157], v9 offset:8192
    ds_read_b64_tr_b16 v[158:159], v9 offset:10240
    buffer_load_dwordx4 v249, s[40:43], s61 offen offset:1024 lds
    buffer_load_dwordx4 v250, s[40:43], s61 offen offset:2048 lds
    s_waitcnt lgkmcnt(6)
    v_mfma_f32_16x16x32_bf16 v[40:43], v[160:163], v[132:135], v[40:43]
    v_mfma_f32_16x16x32_bf16 v[56:59], v[160:163], v[136:139], v[56:59]
    v_mfma_f32_16x16x32_bf16 v[72:75], v[160:163], v[140:143], v[72:75]
    v_mfma_f32_16x16x32_bf16 v[88:91], v[160:163], v[144:147], v[88:91]
    v_mfma_f32_16x16x32_bf16 v[104:107], v[160:163], v[148:151], v[104:107]
    ds_read_b64_tr_b16 v[160:161], v10 offset:8192
    ds_read_b64_tr_b16 v[162:163], v10 offset:10240
    buffer_load_dwordx4 v251, s[40:43], s61 offen offset:3072 lds
    s_add_u32 s61, s61, 110592
    s_waitcnt lgkmcnt(6)
    v_mfma_f32_16x16x32_bf16 v[44:47], v[164:167], v[132:135], v[44:47]
    v_mfma_f32_16x16x32_bf16 v[60:63], v[164:167], v[136:139], v[60:63]
    v_mfma_f32_16x16x32_bf16 v[76:79], v[164:167], v[140:143], v[76:79]
    v_mfma_f32_16x16x32_bf16 v[92:95], v[164:167], v[144:147], v[92:95]
    v_mfma_f32_16x16x32_bf16 v[108:111], v[164:167], v[148:151], v[108:111]
    ds_read_b64_tr_b16 v[164:165], v11 offset:8192
    ds_read_b64_tr_b16 v[166:167], v11 offset:10240
    buffer_load_dwordx4 v[132:135], v1, s[36:39], s60 offen offset:0 sc1
    buffer_load_dwordx4 v[136:139], v1, s[36:39], s60 offen offset:1024 sc1
    buffer_load_dwordx4 v[140:143], v1, s[36:39], s60 offen offset:2048 sc1
    buffer_load_dwordx4 v[144:147], v1, s[36:39], s60 offen offset:3072 sc1
    buffer_load_dwordx4 v[148:151], v12, s[36:39], s60 offen sc1
    s_add_u32 s60, s60, 40960
    s_waitcnt vmcnt(9) lgkmcnt(6)
    v_mfma_f32_16x16x32_bf16 v[32:35], v[152:155], v[112:115], v[32:35]
    v_mfma_f32_16x16x32_bf16 v[48:51], v[152:155], v[116:119], v[48:51]
    v_mfma_f32_16x16x32_bf16 v[64:67], v[152:155], v[120:123], v[64:67]
    v_mfma_f32_16x16x32_bf16 v[80:83], v[152:155], v[124:127], v[80:83]
    v_mfma_f32_16x16x32_bf16 v[96:99], v[152:155], v[128:131], v[96:99]
    ds_read_b64_tr_b16 v[152:153], v8 offset:12288
    ds_read_b64_tr_b16 v[154:155], v8 offset:14336
    s_add_u32 m0, s62, 4096
    s_nop 0
    buffer_load_dwordx4 v248, s[40:43], s61 offen offset:0 lds
    s_waitcnt lgkmcnt(6)
    v_mfma_f32_16x16x32_bf16 v[36:39], v[156:159], v[112:115], v[36:39]
    v_mfma_f32_16x16x32_bf16 v[52:55], v[156:159], v[116:119], v[52:55]
    v_mfma_f32_16x16x32_bf16 v[68:71], v[156:159], v[120:123], v[68:71]
    v_mfma_f32_16x16x32_bf16 v[84:87], v[156:159], v[124:127], v[84:87]
    v_mfma_f32_16x16x32_bf16 v[100:103], v[156:159], v[128:131], v[100:103]
    ds_read_b64_tr_b16 v[156:157], v9 offset:12288
    ds_read_b64_tr_b16 v[158:159], v9 offset:14336
    buffer_load_dwordx4 v249, s[40:43], s61 offen offset:1024 lds
    buffer_load_dwordx4 v250, s[40:43], s61 offen offset:2048 lds
    s_waitcnt lgkmcnt(6)
    v_mfma_f32_16x16x32_bf16 v[40:43], v[160:163], v[112:115], v[40:43]
    v_mfma_f32_16x16x32_bf16 v[56:59], v[160:163], v[116:119], v[56:59]
    v_mfma_f32_16x16x32_bf16 v[72:75], v[160:163], v[120:123], v[72:75]
    v_mfma_f32_16x16x32_bf16 v[88:91], v[160:163], v[124:127], v[88:91]
    v_mfma_f32_16x16x32_bf16 v[104:107], v[160:163], v[128:131], v[104:107]
    ds_read_b64_tr_b16 v[160:161], v10 offset:12288
    ds_read_b64_tr_b16 v[162:163], v10 offset:14336
    buffer_load_dwordx4 v251, s[40:43], s61 offen offset:3072 lds
    s_add_u32 s61, s61, 110592
    s_waitcnt lgkmcnt(6)
    v_mfma_f32_16x16x32_bf16 v[44:47], v[164:167], v[112:115], v[44:47]
    v_mfma_f32_16x16x32_bf16 v[60:63], v[164:167], v[116:119], v[60:63]
    v_mfma_f32_16x16x32_bf16 v[76:79], v[164:167], v[120:123], v[76:79]
    v_mfma_f32_16x16x32_bf16 v[92:95], v[164:167], v[124:127], v[92:95]
    v_mfma_f32_16x16x32_bf16 v[108:111], v[164:167], v[128:131], v[108:111]
    ds_read_b64_tr_b16 v[164:165], v11 offset:12288
    ds_read_b64_tr_b16 v[166:167], v11 offset:14336
    buffer_load_dwordx4 v[112:115], v1, s[36:39], s60 offen offset:0 sc1
    buffer_load_dwordx4 v[116:119], v1, s[36:39], s60 offen offset:1024 sc1
    buffer_load_dwordx4 v[120:123], v1, s[36:39], s60 offen offset:2048 sc1
    buffer_load_dwordx4 v[124:127], v1, s[36:39], s60 offen offset:3072 sc1
    buffer_load_dwordx4 v[128:131], v12, s[36:39], s60 offen sc1
    s_add_u32 s60, s60, 40960
    s_waitcnt vmcnt(9) lgkmcnt(6)
    v_mfma_f32_16x16x32_bf16 v[32:35], v[152:155], v[132:135], v[32:35]
    v_mfma_f32_16x16x32_bf16 v[48:51], v[152:155], v[136:139], v[48:51]
    v_mfma_f32_16x16x32_bf16 v[64:67], v[152:155], v[140:143], v[64:67]
    v_mfma_f32_16x16x32_bf16 v[80:83], v[152:155], v[144:147], v[80:83]
    v_mfma_f32_16x16x32_bf16 v[96:99], v[152:155], v[148:151], v[96:99]
    ds_read_b64_tr_b16 v[152:153], v8 offset:0
    ds_read_b64_tr_b16 v[154:155], v8 offset:2048
    s_add_u32 m0, s62, 8192
    s_nop 0
    buffer_load_dwordx4 v248, s[40:43], s61 offen offset:0 lds
    s_waitcnt lgkmcnt(6)
    v_mfma_f32_16x16x32_bf16 v[36:39], v[156:159], v[132:135], v[36:39]
    v_mfma_f32_16x16x32_bf16 v[52:55], v[156:159], v[136:139], v[52:55]
    v_mfma_f32_16x16x32_bf16 v[68:71], v[156:159], v[140:143], v[68:71]
    v_mfma_f32_16x16x32_bf16 v[84:87], v[156:159], v[144:147], v[84:87]
    v_mfma_f32_16x16x32_bf16 v[100:103], v[156:159], v[148:151], v[100:103]
    ds_read_b64_tr_b16 v[156:157], v9 offset:0
    ds_read_b64_tr_b16 v[158:159], v9 offset:2048
    buffer_load_dwordx4 v249, s[40:43], s61 offen offset:1024 lds
    buffer_load_dwordx4 v250, s[40:43], s61 offen offset:2048 lds
    s_waitcnt lgkmcnt(6)
    v_mfma_f32_16x16x32_bf16 v[40:43], v[160:163], v[132:135], v[40:43]
    v_mfma_f32_16x16x32_bf16 v[56:59], v[160:163], v[136:139], v[56:59]
    v_mfma_f32_16x16x32_bf16 v[72:75], v[160:163], v[140:143], v[72:75]
    v_mfma_f32_16x16x32_bf16 v[88:91], v[160:163], v[144:147], v[88:91]
    v_mfma_f32_16x16x32_bf16 v[104:107], v[160:163], v[148:151], v[104:107]
    ds_read_b64_tr_b16 v[160:161], v10 offset:0
    ds_read_b64_tr_b16 v[162:163], v10 offset:2048
    buffer_load_dwordx4 v251, s[40:43], s61 offen offset:3072 lds
    s_add_u32 s61, s61, 110592
    s_waitcnt lgkmcnt(6)
    v_mfma_f32_16x16x32_bf16 v[44:47], v[164:167], v[132:135], v[44:47]
    v_mfma_f32_16x16x32_bf16 v[60:63], v[164:167], v[136:139], v[60:63]
    v_mfma_f32_16x16x32_bf16 v[76:79], v[164:167], v[140:143], v[76:79]
    v_mfma_f32_16x16x32_bf16 v[92:95], v[164:167], v[144:147], v[92:95]
    v_mfma_f32_16x16x32_bf16 v[108:111], v[164:167], v[148:151], v[108:111]
    ds_read_b64_tr_b16 v[164:165], v11 offset:0
    ds_read_b64_tr_b16 v[166:167], v11 offset:2048
    buffer_load_dwordx4 v[132:135], v1, s[36:39], s60 offen offset:0 sc1
    buffer_load_dwordx4 v[136:139], v1, s[36:39], s60 offen offset:1024 sc1
    buffer_load_dwordx4 v[140:143], v1, s[36:39], s60 offen offset:2048 sc1
    buffer_load_dwordx4 v[144:147], v1, s[36:39], s60 offen offset:3072 sc1
    buffer_load_dwordx4 v[148:151], v12, s[36:39], s60 offen sc1
    s_add_u32 s60, s60, 40960
    s_waitcnt vmcnt(9) lgkmcnt(6)
    s_setprio 2
    v_mfma_f32_16x16x32_bf16 v[32:35], v[152:155], v[112:115], v[32:35]
    s_add_u32 m0, s62, 12288
    v_mfma_f32_16x16x32_bf16 v[48:51], v[152:155], v[116:119], v[48:51]
    s_setprio 0
    buffer_load_dwordx4 v248, s[40:43], s61 offen offset:0 lds
    s_setprio 2
    v_mfma_f32_16x16x32_bf16 v[64:67], v[152:155], v[120:123], v[64:67]
    s_setprio 0
    buffer_load_dwordx4 v249, s[40:43], s61 offen offset:1024 lds
    s_setprio 2
    v_mfma_f32_16x16x32_bf16 v[80:83], v[152:155], v[124:127], v[80:83]
    s_setprio 0
    buffer_load_dwordx4 v250, s[40:43], s61 offen offset:2048 lds
    s_setprio 2
    v_mfma_f32_16x16x32_bf16 v[96:99], v[152:155], v[128:131], v[96:99]
    s_setprio 0
    buffer_load_dwordx4 v251, s[40:43], s61 offen offset:3072 lds
    ds_read_b64_tr_b16 v[152:153], v8 offset:4096
    ds_read_b64_tr_b16 v[154:155], v8 offset:6144
    s_waitcnt lgkmcnt(6)
    s_setprio 2
    v_mfma_f32_16x16x32_bf16 v[36:39], v[156:159], v[112:115], v[36:39]
    s_add_u32 s61, s61, 110592
    v_mfma_f32_16x16x32_bf16 v[52:55], v[156:159], v[116:119], v[52:55]
    v_mfma_f32_16x16x32_bf16 v[68:71], v[156:159], v[120:123], v[68:71]
    v_mfma_f32_16x16x32_bf16 v[84:87], v[156:159], v[124:127], v[84:87]
    v_mfma_f32_16x16x32_bf16 v[100:103], v[156:159], v[128:131], v[100:103]
    ds_read_b64_tr_b16 v[156:157], v9 offset:4096
    ds_read_b64_tr_b16 v[158:159], v9 offset:6144
    s_waitcnt lgkmcnt(6)
    v_mfma_f32_16x16x32_bf16 v[40:43], v[160:163], v[112:115], v[40:43]
    v_mfma_f32_16x16x32_bf16 v[56:59], v[160:163], v[116:119], v[56:59]
    v_mfma_f32_16x16x32_bf16 v[72:75], v[160:163], v[120:123], v[72:75]
    v_mfma_f32_16x16x32_bf16 v[88:91], v[160:163], v[124:127], v[88:91]
    v_mfma_f32_16x16x32_bf16 v[104:107], v[160:163], v[128:131], v[104:107]
    ds_read_b64_tr_b16 v[160:161], v10 offset:4096
    ds_read_b64_tr_b16 v[162:163], v10 offset:6144
    s_waitcnt lgkmcnt(6)
    v_mfma_f32_16x16x32_bf16 v[44:47], v[164:167], v[112:115], v[44:47]
    s_setprio 0
    buffer_load_dwordx4 v[112:115], v1, s[36:39], s60 offen offset:0 sc1
    s_setprio 2
    v_mfma_f32_16x16x32_bf16 v[60:63], v[164:167], v[116:119], v[60:63]
    s_setprio 0
    buffer_load_dwordx4 v[116:119], v1, s[36:39], s60 offen offset:1024 sc1
    s_setprio 2
    v_mfma_f32_16x16x32_bf16 v[76:79], v[164:167], v[120:123], v[76:79]
    s_setprio 0
    buffer_load_dwordx4 v[120:123], v1, s[36:39], s60 offen offset:2048 sc1
    s_setprio 2
    v_mfma_f32_16x16x32_bf16 v[92:95], v[164:167], v[124:127], v[92:95]
    s_setprio 0
    buffer_load_dwordx4 v[124:127], v1, s[36:39], s60 offen offset:3072 sc1
    s_setprio 2
    v_mfma_f32_16x16x32_bf16 v[108:111], v[164:167], v[128:131], v[108:111]
    s_setprio 0
    buffer_load_dwordx4 v[128:131], v12, s[36:39], s60 offen sc1
    ds_read_b64_tr_b16 v[164:165], v11 offset:4096
    ds_read_b64_tr_b16 v[166:167], v11 offset:6144
    s_add_u32 s60, s60, 40960
    s_setprio 2
    v_mul_u32_u24 v13, 4096, v252
    v_add_u32 v248, v13, v253
    v_add_u32 v249, 64512, v248
    v_add_u32 v250, 14336, v248
    v_add_u32 v251, 78848, v248
    s_mov_b64 s[40:41], s[20:21]
    s_mov_b32 s42, 7077888
    s_lshl_b32 s61, s50, 7
    s_mul_i32 s54, s48, 1835008
    s_add_u32 s61, s61, s54
    s_waitcnt vmcnt(9) lgkmcnt(6)
    v_mfma_f32_16x16x32_bf16 v[32:35], v[152:155], v[132:135], v[32:35]
    v_mfma_f32_16x16x32_bf16 v[48:51], v[152:155], v[136:139], v[48:51]
    v_mfma_f32_16x16x32_bf16 v[64:67], v[152:155], v[140:143], v[64:67]
    v_mfma_f32_16x16x32_bf16 v[80:83], v[152:155], v[144:147], v[80:83]
    v_mfma_f32_16x16x32_bf16 v[96:99], v[152:155], v[148:151], v[96:99]
    ds_read_b64_tr_b16 v[152:153], v8 offset:8192
    ds_read_b64_tr_b16 v[154:155], v8 offset:10240
    s_waitcnt lgkmcnt(6)
    v_mfma_f32_16x16x32_bf16 v[36:39], v[156:159], v[132:135], v[36:39]
    v_mfma_f32_16x16x32_bf16 v[52:55], v[156:159], v[136:139], v[52:55]
    v_mfma_f32_16x16x32_bf16 v[68:71], v[156:159], v[140:143], v[68:71]
    v_mfma_f32_16x16x32_bf16 v[84:87], v[156:159], v[144:147], v[84:87]
    v_mfma_f32_16x16x32_bf16 v[100:103], v[156:159], v[148:151], v[100:103]
    ds_read_b64_tr_b16 v[156:157], v9 offset:8192
    ds_read_b64_tr_b16 v[158:159], v9 offset:10240
    s_waitcnt lgkmcnt(6)
    v_mfma_f32_16x16x32_bf16 v[40:43], v[160:163], v[132:135], v[40:43]
    v_mfma_f32_16x16x32_bf16 v[56:59], v[160:163], v[136:139], v[56:59]
    v_mfma_f32_16x16x32_bf16 v[72:75], v[160:163], v[140:143], v[72:75]
    v_mfma_f32_16x16x32_bf16 v[88:91], v[160:163], v[144:147], v[88:91]
    v_mfma_f32_16x16x32_bf16 v[104:107], v[160:163], v[148:151], v[104:107]
    ds_read_b64_tr_b16 v[160:161], v10 offset:8192
    ds_read_b64_tr_b16 v[162:163], v10 offset:10240
    s_waitcnt lgkmcnt(6)
    v_mfma_f32_16x16x32_bf16 v[44:47], v[164:167], v[132:135], v[44:47]
    s_setprio 0
    buffer_load_dwordx4 v[132:135], v1, s[36:39], s60 offen offset:0 sc1
    s_setprio 2
    v_mfma_f32_16x16x32_bf16 v[60:63], v[164:167], v[136:139], v[60:63]
    s_setprio 0
    buffer_load_dwordx4 v[136:139], v1, s[36:39], s60 offen offset:1024 sc1
    s_setprio 2
    v_mfma_f32_16x16x32_bf16 v[76:79], v[164:167], v[140:143], v[76:79]
    s_setprio 0
    buffer_load_dwordx4 v[140:143], v1, s[36:39], s60 offen offset:2048 sc1
    s_setprio 2
    v_mfma_f32_16x16x32_bf16 v[92:95], v[164:167], v[144:147], v[92:95]
    s_setprio 0
    buffer_load_dwordx4 v[144:147], v1, s[36:39], s60 offen offset:3072 sc1
    s_setprio 2
    v_mfma_f32_16x16x32_bf16 v[108:111], v[164:167], v[148:151], v[108:111]
    s_setprio 0
    buffer_load_dwordx4 v[148:151], v12, s[36:39], s60 offen sc1
    ds_read_b64_tr_b16 v[164:165], v11 offset:8192
    ds_read_b64_tr_b16 v[166:167], v11 offset:10240
    s_add_u32 s60, s60, 40960
    s_waitcnt vmcnt(5) lgkmcnt(6)
    s_setprio 2
    v_mfma_f32_16x16x32_bf16 v[32:35], v[152:155], v[112:115], v[32:35]
    s_add_u32 m0, s58, 0
    v_mfma_f32_16x16x32_bf16 v[48:51], v[152:155], v[116:119], v[48:51]
    s_setprio 0
    buffer_load_dwordx4 v248, s[40:43], s61 offen offset:0 lds
    s_setprio 2
    v_mfma_f32_16x16x32_bf16 v[64:67], v[152:155], v[120:123], v[64:67]
    s_setprio 0
    buffer_load_dwordx4 v249, s[40:43], s61 offen offset:1024 lds
    s_setprio 2
    v_mfma_f32_16x16x32_bf16 v[80:83], v[152:155], v[124:127], v[80:83]
    s_setprio 0
    buffer_load_dwordx4 v250, s[40:43], s61 offen offset:2048 lds
    s_setprio 2
    v_mfma_f32_16x16x32_bf16 v[96:99], v[152:155], v[128:131], v[96:99]
    s_setprio 0
    buffer_load_dwordx4 v251, s[40:43], s61 offen offset:3072 lds
    ds_read_b64_tr_b16 v[152:153], v8 offset:12288
    ds_read_b64_tr_b16 v[154:155], v8 offset:14336
    s_waitcnt lgkmcnt(6)
    s_setprio 2
    v_mfma_f32_16x16x32_bf16 v[36:39], v[156:159], v[112:115], v[36:39]
    s_add_u32 s61, s61, 131072
    v_mfma_f32_16x16x32_bf16 v[52:55], v[156:159], v[116:119], v[52:55]
    s_add_u32 m0, s58, 4096
    v_mfma_f32_16x16x32_bf16 v[68:71], v[156:159], v[120:123], v[68:71]
    s_setprio 0
    buffer_load_dwordx4 v248, s[40:43], s61 offen offset:0 lds
    s_setprio 2
    v_mfma_f32_16x16x32_bf16 v[84:87], v[156:159], v[124:127], v[84:87]
    s_setprio 0
    buffer_load_dwordx4 v249, s[40:43], s61 offen offset:1024 lds
    s_setprio 2
    v_mfma_f32_16x16x32_bf16 v[100:103], v[156:159], v[128:131], v[100:103]
    s_setprio 0
    buffer_load_dwordx4 v250, s[40:43], s61 offen offset:2048 lds
    ds_read_b64_tr_b16 v[156:157], v9 offset:12288
    ds_read_b64_tr_b16 v[158:159], v9 offset:14336
    s_waitcnt lgkmcnt(6)
    s_setprio 2
    v_mfma_f32_16x16x32_bf16 v[40:43], v[160:163], v[112:115], v[40:43]
    s_setprio 0
    buffer_load_dwordx4 v251, s[40:43], s61 offen offset:3072 lds
    s_setprio 2
    v_mfma_f32_16x16x32_bf16 v[56:59], v[160:163], v[116:119], v[56:59]
    s_add_u32 s61, s61, 131072
    v_mfma_f32_16x16x32_bf16 v[72:75], v[160:163], v[120:123], v[72:75]
    v_mfma_f32_16x16x32_bf16 v[88:91], v[160:163], v[124:127], v[88:91]
    v_mfma_f32_16x16x32_bf16 v[104:107], v[160:163], v[128:131], v[104:107]
    ds_read_b64_tr_b16 v[160:161], v10 offset:12288
    ds_read_b64_tr_b16 v[162:163], v10 offset:14336
    s_waitcnt lgkmcnt(6)
    v_mfma_f32_16x16x32_bf16 v[44:47], v[164:167], v[112:115], v[44:47]
    v_mfma_f32_16x16x32_bf16 v[60:63], v[164:167], v[116:119], v[60:63]
    v_mfma_f32_16x16x32_bf16 v[76:79], v[164:167], v[120:123], v[76:79]
    v_mfma_f32_16x16x32_bf16 v[92:95], v[164:167], v[124:127], v[92:95]
    v_mfma_f32_16x16x32_bf16 v[108:111], v[164:167], v[128:131], v[108:111]
    ds_read_b64_tr_b16 v[164:165], v11 offset:12288
    ds_read_b64_tr_b16 v[166:167], v11 offset:14336
    s_waitcnt vmcnt(8) lgkmcnt(6)
    v_mfma_f32_16x16x32_bf16 v[32:35], v[152:155], v[132:135], v[32:35]
    s_add_u32 m0, s58, 8192
    v_mfma_f32_16x16x32_bf16 v[48:51], v[152:155], v[136:139], v[48:51]
    s_setprio 0
    buffer_load_dwordx4 v248, s[40:43], s61 offen offset:0 lds
    s_setprio 2
    v_mfma_f32_16x16x32_bf16 v[64:67], v[152:155], v[140:143], v[64:67]
    s_setprio 0
    buffer_load_dwordx4 v249, s[40:43], s61 offen offset:1024 lds
    s_setprio 2
    v_mfma_f32_16x16x32_bf16 v[80:83], v[152:155], v[144:147], v[80:83]
    s_setprio 0
    buffer_load_dwordx4 v250, s[40:43], s61 offen offset:2048 lds
    s_setprio 2
    v_mfma_f32_16x16x32_bf16 v[96:99], v[152:155], v[148:151], v[96:99]
    s_setprio 0
    buffer_load_dwordx4 v251, s[40:43], s61 offen offset:3072 lds
    s_waitcnt lgkmcnt(0)
    s_setprio 2
    v_mfma_f32_16x16x32_bf16 v[36:39], v[156:159], v[132:135], v[36:39]
    s_add_u32 s61, s61, 131072
    v_mfma_f32_16x16x32_bf16 v[52:55], v[156:159], v[136:139], v[52:55]
    s_add_u32 m0, s58, 12288
    v_mfma_f32_16x16x32_bf16 v[68:71], v[156:159], v[140:143], v[68:71]
    s_setprio 0
    buffer_load_dwordx4 v248, s[40:43], s61 offen offset:0 lds
    s_setprio 2
    v_mfma_f32_16x16x32_bf16 v[84:87], v[156:159], v[144:147], v[84:87]
    s_setprio 0
    buffer_load_dwordx4 v249, s[40:43], s61 offen offset:1024 lds
    ds_write_b128 v2, v[32:35] offset:0
    s_setprio 2
    v_mfma_f32_16x16x32_bf16 v[100:103], v[156:159], v[148:151], v[100:103]
    s_setprio 0
    buffer_load_dwordx4 v250, s[40:43], s61 offen offset:2048 lds
    ds_write_b128 v2, v[48:51] offset:1024
    s_setprio 2
    v_mfma_f32_16x16x32_bf16 v[40:43], v[160:163], v[132:135], v[40:43]
    s_setprio 0
    buffer_load_dwordx4 v251, s[40:43], s61 offen offset:3072 lds
    ds_write_b128 v2, v[64:67] offset:2048
    s_setprio 2
    v_mfma_f32_16x16x32_bf16 v[56:59], v[160:163], v[136:139], v[56:59]
    s_add_u32 s61, s61, 131072
    ds_write_b128 v2, v[80:83] offset:3072
    v_mfma_f32_16x16x32_bf16 v[72:75], v[160:163], v[140:143], v[72:75]
    s_setprio 0
    s_mul_i32 s54, s48, 1835008
    s_mul_i32 s55, s2, 2048
    s_add_u32 s54, s54, s55
    s_add_u32 s54, s54, 1310720
    s_mov_b64 exec, 65535
    buffer_load_dword v31, v17, s[44:47], s54 offen
    s_mov_b64 exec, -1
    ds_write_b128 v2, v[96:99] offset:4096
    s_setprio 2
    v_mfma_f32_16x16x32_bf16 v[88:91], v[160:163], v[144:147], v[88:91]
    ds_write_b128 v2, v[36:39] offset:5120
    v_mfma_f32_16x16x32_bf16 v[104:107], v[160:163], v[148:151], v[104:107]
    ds_write_b128 v2, v[52:55] offset:6144
    v_mfma_f32_16x16x32_bf16 v[44:47], v[164:167], v[132:135], v[44:47]
    ds_write_b128 v2, v[68:71] offset:7168
    v_mfma_f32_16x16x32_bf16 v[60:63], v[164:167], v[136:139], v[60:63]
    ds_write_b128 v2, v[84:87] offset:8192
    v_mfma_f32_16x16x32_bf16 v[76:79], v[164:167], v[140:143], v[76:79]
    ds_write_b128 v2, v[100:103] offset:9216
    v_mfma_f32_16x16x32_bf16 v[92:95], v[164:167], v[144:147], v[92:95]
    ds_write_b128 v2, v[40:43] offset:10240
    v_mfma_f32_16x16x32_bf16 v[108:111], v[164:167], v[148:151], v[108:111]
    ds_write_b128 v2, v[56:59] offset:11264
    ds_write_b128 v2, v[72:75] offset:12288
    ds_write_b128 v2, v[88:91] offset:13312
    ds_write_b128 v2, v[104:107] offset:14336
    s_setprio 2
    ds_add_u32 v255, v30 offset:4
    s_mov_b64 exec, 1
    v_mov_b32 v21, 0
    buffer_atomic_or v21, v0, s[32:35], s3 offen sc0 sc1
    s_mov_b64 exec, -1
    s_mov_b64 s[44:45], s[22:23]
    s_mov_b32 s46, 4096
    s_lshl2_add_u32 s55, s50, s48
    s_lshl_b32 s55, s55, 5
    v_lshlrev_b32 v13, 1, v4
    buffer_load_ushort v253, v13, s[44:47], s55 offen
    s_lshl_b32 s54, s53, 1
    s_lshr_b32 s55, s48, 1
    s_add_u32 s54, s54, s55
    s_mul_i32 s54, s54, 40960
    s_mul_i32 s55, s49, 5120
    s_add_u32 s54, s54, s55
    s_add_u32 s54, s54, 4194304
    s_and_b32 s55, s48, 1
    s_lshl_b32 s55, s55, 9
    s_add_u32 s54, s54, s55
    s_add_u32 s55, s54, 4096
    s_mov_b32 s56, 0xbdd2d3e8
    v_mov_b32 v16, 0xc0135761
    v_lshrrev_b32 v18, 1, v3
    v_lshlrev_b32 v18, 8, v18
    v_lshl_add_u32 v18, v4, 4, v18
    v_and_b32 v20, 1, v3
    v_lshl_add_u32 v19, v20, 3, v18
    v_lshl_add_u32 v18, v20, 10, v18
L_wc_26:
    ds_read_b32 v15, v255 offset:4
    s_waitcnt lgkmcnt(0)
    v_readfirstlane_b32 s96, v15
    s_cmp_ge_u32 s96, 4
    s_cbranch_scc1 L_wd_27
    s_sleep 1
    s_add_u32 s97, s97, 1
    s_cmp_lt_u32 s97, 1048576
    s_cbranch_scc1 L_wc_26
L_wd_27:
    ds_read_b128 v[32:35], v5 offset:0
    ds_read_b128 v[48:51], v5 offset:1024
    ds_read_b128 v[64:67], v5 offset:2048
    ds_read_b128 v[80:83], v5 offset:3072
    ds_read_b128 v[96:99], v5 offset:4096
    ds_read_b128 v[36:39], v6 offset:0
    ds_read_b128 v[52:55], v6 offset:1024
    ds_read_b128 v[68:71], v6 offset:2048
    ds_read_b128 v[84:87], v6 offset:3072
    ds_read_b128 v[100:103], v6 offset:4096
    ds_read_b128 v[40:43], v254 offset:0
    ds_read_b128 v[56:59], v254 offset:1024
    ds_read_b128 v[72:75], v254 offset:2048
    ds_read_b128 v[88:91], v254 offset:3072
    ds_read_b128 v[104:107], v254 offset:4096
    ds_add_u32 v255, v30 offset:4
    s_waitcnt lgkmcnt(0)
    v_add_f32 v44, v44, v32
    v_add_f32 v45, v45, v33
    v_add_f32 v46, v46, v34
    v_add_f32 v47, v47, v35
    v_add_f32 v60, v60, v48
    v_add_f32 v61, v61, v49
    v_add_f32 v62, v62, v50
    v_add_f32 v63, v63, v51
    v_add_f32 v76, v76, v64
    v_add_f32_e64 v77, v77, v65
    v_pk_add_f32 v[78:79], v[78:79], v[66:67]
    v_pk_add_f32 v[92:93], v[92:93], v[80:81]
    v_pk_add_f32 v[94:95], v[94:95], v[82:83]
    v_pk_add_f32 v[108:109], v[108:109], v[96:97]
    v_pk_add_f32 v[110:111], v[110:111], v[98:99]
    v_pk_add_f32 v[44:45], v[44:45], v[36:37]
    v_pk_add_f32 v[46:47], v[46:47], v[38:39]
    v_pk_add_f32 v[60:61], v[60:61], v[52:53]
    v_pk_add_f32 v[62:63], v[62:63], v[54:55]
    v_pk_add_f32 v[76:77], v[76:77], v[68:69]
    v_pk_add_f32 v[78:79], v[78:79], v[70:71]
    v_pk_add_f32 v[92:93], v[92:93], v[84:85]
    v_pk_add_f32 v[94:95], v[94:95], v[86:87]
    v_pk_add_f32 v[108:109], v[108:109], v[100:101]
    v_pk_add_f32 v[110:111], v[110:111], v[102:103]
    v_pk_add_f32 v[44:45], v[44:45], v[40:41]
    v_pk_add_f32 v[46:47], v[46:47], v[42:43]
    v_pk_add_f32 v[60:61], v[60:61], v[56:57]
    v_pk_add_f32 v[62:63], v[62:63], v[58:59]
    v_pk_add_f32 v[76:77], v[76:77], v[72:73]
    v_pk_add_f32 v[78:79], v[78:79], v[74:75]
    v_pk_add_f32 v[92:93], v[92:93], v[88:89]
    v_pk_add_f32 v[94:95], v[94:95], v[90:91]
    v_pk_add_f32 v[108:109], v[108:109], v[104:105]
    v_pk_add_f32 v[110:111], v[110:111], v[106:107]
    v_pk_mul_f32 v[32:33], v[44:45], v[44:45]
    v_pk_mul_f32 v[34:35], v[46:47], v[46:47]
    v_pk_mul_f32 v[48:49], v[60:61], v[60:61]
    v_pk_mul_f32 v[50:51], v[62:63], v[62:63]
    v_pk_mul_f32 v[64:65], v[76:77], v[76:77]
    v_pk_mul_f32 v[66:67], v[78:79], v[78:79]
    v_pk_mul_f32 v[80:81], v[92:93], v[92:93]
    v_pk_mul_f32 v[82:83], v[94:95], v[94:95]
    v_pk_mul_f32 v[96:97], v[108:109], v[108:109]
    v_pk_mul_f32 v[98:99], v[110:111], v[110:111]
    v_pk_fma_f32 v[32:33], v[32:33], s[56:57], v[16:17] op_sel_hi:[1,0,0]
    v_pk_fma_f32 v[34:35], v[34:35], s[56:57], v[16:17] op_sel_hi:[1,0,0]
    v_pk_fma_f32 v[48:49], v[48:49], s[56:57], v[16:17] op_sel_hi:[1,0,0]
    v_pk_fma_f32 v[50:51], v[50:51], s[56:57], v[16:17] op_sel_hi:[1,0,0]
    v_pk_fma_f32 v[64:65], v[64:65], s[56:57], v[16:17] op_sel_hi:[1,0,0]
    v_pk_fma_f32 v[66:67], v[66:67], s[56:57], v[16:17] op_sel_hi:[1,0,0]
    v_pk_fma_f32 v[80:81], v[80:81], s[56:57], v[16:17] op_sel_hi:[1,0,0]
    v_pk_fma_f32 v[82:83], v[82:83], s[56:57], v[16:17] op_sel_hi:[1,0,0]
    v_pk_fma_f32 v[96:97], v[96:97], s[56:57], v[16:17] op_sel_hi:[1,0,0]
    v_pk_fma_f32 v[98:99], v[98:99], s[56:57], v[16:17] op_sel_hi:[1,0,0]
    v_pk_mul_f32 v[32:33], v[32:33], v[44:45]
    v_pk_mul_f32 v[34:35], v[34:35], v[46:47]
    v_pk_mul_f32 v[48:49], v[48:49], v[60:61]
    v_pk_mul_f32 v[50:51], v[50:51], v[62:63]
    v_pk_mul_f32 v[64:65], v[64:65], v[76:77]
    v_pk_mul_f32 v[66:67], v[66:67], v[78:79]
    v_pk_mul_f32 v[80:81], v[80:81], v[92:93]
    v_pk_mul_f32 v[82:83], v[82:83], v[94:95]
    v_pk_mul_f32 v[96:97], v[96:97], v[108:109]
    v_pk_mul_f32 v[98:99], v[98:99], v[110:111]
    v_exp_f32 v32, v32
    v_exp_f32 v33, v33
    v_exp_f32 v34, v34
    v_exp_f32 v35, v35
    v_exp_f32 v48, v48
    v_exp_f32 v49, v49
    v_exp_f32 v50, v50
    v_exp_f32 v51, v51
    v_exp_f32 v64, v64
    v_exp_f32 v65, v65
    v_exp_f32 v66, v66
    v_exp_f32 v67, v67
    v_exp_f32 v80, v80
    v_exp_f32 v81, v81
    v_exp_f32 v82, v82
    v_exp_f32 v83, v83
    v_exp_f32 v96, v96
    v_exp_f32 v97, v97
    v_exp_f32 v98, v98
    v_exp_f32 v99, v99
    v_pk_add_f32 v[32:33], v[32:33], 1.0 op_sel_hi:[1,0]
    v_pk_add_f32 v[34:35], v[34:35], 1.0 op_sel_hi:[1,0]
    v_pk_add_f32 v[48:49], v[48:49], 1.0 op_sel_hi:[1,0]
    v_pk_add_f32 v[50:51], v[50:51], 1.0 op_sel_hi:[1,0]
    v_pk_add_f32 v[64:65], v[64:65], 1.0 op_sel_hi:[1,0]
    v_pk_add_f32 v[66:67], v[66:67], 1.0 op_sel_hi:[1,0]
    v_pk_add_f32 v[80:81], v[80:81], 1.0 op_sel_hi:[1,0]
    v_pk_add_f32 v[82:83], v[82:83], 1.0 op_sel_hi:[1,0]
    v_pk_add_f32 v[96:97], v[96:97], 1.0 op_sel_hi:[1,0]
    v_pk_add_f32 v[98:99], v[98:99], 1.0 op_sel_hi:[1,0]
    v_rcp_f32 v32, v32
    v_rcp_f32 v33, v33
    v_rcp_f32 v34, v34
    v_rcp_f32 v35, v35
    v_rcp_f32 v48, v48
    v_rcp_f32 v49, v49
    v_rcp_f32 v50, v50
    v_rcp_f32 v51, v51
    v_rcp_f32 v64, v64
    v_rcp_f32 v65, v65
    v_rcp_f32 v66, v66
    v_rcp_f32 v67, v67
    v_rcp_f32 v80, v80
    v_rcp_f32 v81, v81
    v_rcp_f32 v82, v82
    v_rcp_f32 v83, v83
    v_rcp_f32 v96, v96
    v_rcp_f32 v97, v97
    v_rcp_f32 v98, v98
    v_rcp_f32 v99, v99
    v_pk_mul_f32 v[44:45], v[44:45], v[32:33]
    v_pk_mul_f32 v[46:47], v[46:47], v[34:35]
    v_pk_mul_f32 v[60:61], v[60:61], v[48:49]
    v_pk_mul_f32 v[62:63], v[62:63], v[50:51]
    v_pk_mul_f32 v[76:77], v[76:77], v[64:65]
    v_pk_mul_f32 v[78:79], v[78:79], v[66:67]
    v_pk_mul_f32 v[92:93], v[92:93], v[80:81]
    v_pk_mul_f32 v[94:95], v[94:95], v[82:83]
    v_pk_mul_f32 v[108:109], v[108:109], v[96:97]
    v_pk_mul_f32 v[110:111], v[110:111], v[98:99]
    v_cvt_pk_bf16_f32 v152, v44, v45
    v_cvt_pk_bf16_f32 v154, v60, v61
    v_cvt_pk_bf16_f32 v156, v76, v77
    v_cvt_pk_bf16_f32 v158, v92, v93
    v_cvt_pk_bf16_f32 v160, v108, v109
    v_cvt_pk_bf16_f32 v153, v46, v47
    v_cvt_pk_bf16_f32 v155, v62, v63
    v_cvt_pk_bf16_f32 v157, v78, v79
    v_cvt_pk_bf16_f32 v159, v94, v95
    v_cvt_pk_bf16_f32 v161, v110, v111
    v_permlane16_swap_b32 v152, v154
    v_permlane16_swap_b32 v153, v155
    v_permlane16_swap_b32 v156, v158
    v_permlane16_swap_b32 v157, v159
    buffer_store_dwordx4 v[152:155], v18, s[32:35], s54 offen sc1
    buffer_store_dwordx4 v[156:159], v18, s[32:35], s54 offen offset:2048 sc1
    buffer_store_dwordx2 v[160:161], v19, s[32:35], s55 offen sc1
    s_sub_u32 s62, s58, s62
    v_add_u32 v8, s62, v8
    v_add_u32 v9, s62, v9
    v_add_u32 v10, s62, v10
    v_add_u32 v11, s62, v11
    v_add_u32 v2, s62, v2
    s_xor_b32 s62, s48, 1
    s_mul_i32 s62, s62, 5376
    s_add_u32 s62, s62, 66048
    v_add_u32 v254, s62, v254
    s_xor_b32 s62, s48, 2
    s_mul_i32 s62, s62, 5376
    s_add_u32 s62, s62, 66048
    v_add_u32 v6, s62, v6
    s_xor_b32 s62, s48, 3
    s_mul_i32 s62, s62, 5376
    s_add_u32 s62, s62, 66048
    v_add_u32 v5, s62, v5
    s_mov_b64 s[36:37], s[30:31]
    s_mov_b32 s38, 6406144
    s_mul_i32 s60, s48, 573440
    s_mul_i32 s55, s49, 5120
    s_add_u32 s60, s60, s55
    s_add_u32 s60, s60, 4194304
    s_mul_i32 s55, s48, 7
    v_add_u32 v16, s55, v0
    v_min_u32 v16, 26, v16
    v_lshlrev_b32 v16, 7, v16
    s_lshl_b32 s59, s49, 12
    s_add_u32 s59, s59, 98304
    v_lshrrev_b32 v13, 2, v0
    v_mul_u32_u24 v13, 112, v13
    v_lshl_add_u32 v13, v0, 2, v13
    s_mul_i32 s62, s50, 81920
    s_mul_i32 s55, s48, 20480
    s_add_u32 s62, s62, s55
    s_add_u32 s62, s62, 7340032
    s_xor_b32 s98, s48, 3
    s_lshl_b32 s98, s98, 10
    s_add_u32 s98, s98, s62
    s_xor_b32 s99, s48, 2
    s_lshl_b32 s99, s99, 10
    s_add_u32 s99, s99, s62
    s_xor_b32 s100, s48, 1
    s_lshl_b32 s100, s100, 10
    s_add_u32 s100, s100, s62
    s_xor_b32 s101, s48, 0
    s_lshl_b32 s101, s101, 10
    s_add_u32 s101, s101, s62
    s_cmp_lg_u32 s48, 0
    s_cbranch_scc1 L_novb
L_wc_28:
    ds_read_b32 v15, v255 offset:4
    s_waitcnt lgkmcnt(0)
    v_readfirstlane_b32 s96, v15
    s_cmp_ge_u32 s96, 8
    s_cbranch_scc1 L_wd_29
    s_add_u32 s97, s97, 1
    s_cmp_lt_u32 s97, 1048576
    s_cbranch_scc1 L_wc_28
L_wd_29:
L_wc_30:
    ds_read_b32 v15, v255 offset:24
    s_waitcnt lgkmcnt(0)
    v_readfirstlane_b32 s96, v15
    s_cmp_ge_u32 s96, 8
    s_cbranch_scc1 L_wd_31
    s_sleep 1
    s_add_u32 s97, s97, 1
    s_cmp_lt_u32 s97, 1048576
    s_cbranch_scc1 L_wc_30
L_wd_31:
    ds_read_b64 v[22:23], v27 offset:32
    s_waitcnt lgkmcnt(0)
    v_mul_f32 v22, v22, v23
    v_cmp_nge_f32 vcc, 0x44c22cbd, v22
    s_cmp_eq_u64 vcc, 0
    s_cselect_b32 s57, 1, 2
    v_mov_b32 v22, s57
    ds_write_b32 v27, v22 offset:72
L_novb:
    s_lshl_b32 s54, s49, 5
    s_add_u32 s54, s54, s53
    s_lshl_b32 s54, s54, 7
    s_add_u32 s54, s54, 98304
    s_waitcnt vmcnt(0)
    ds_add_rtn_u32 v15, v255, v30 offset:8
    s_mov_b64 exec, 1
    s_waitcnt lgkmcnt(0)
    v_readfirstlane_b32 s96, v15
    v_mov_b32 v15, s52
    s_cmp_lg_u32 s96, 3
    s_cbranch_scc1 L_nf_32
    buffer_store_dword v15, v0, s[32:35], s54 offen sc1
L_nf_32:
    s_mov_b64 exec, -1
    v_readfirstlane_b32 s96, v21
    s_cmp_eq_u32 s96, s52
    s_cbranch_scc1 L_g2
    s_branch L_wpoll
L_idle:
    s_cmp_lg_u32 s48, 0
    s_cbranch_scc1 L_novi
L_wc_33:
    ds_read_b32 v15, v255 offset:24
    s_waitcnt lgkmcnt(0)
    v_readfirstlane_b32 s96, v15
    s_cmp_ge_u32 s96, 8
    s_cbranch_scc1 L_wd_34
    s_sleep 1
    s_add_u32 s97, s97, 1
    s_cmp_lt_u32 s97, 1048576
    s_cbranch_scc1 L_wc_33
L_wd_34:
    ds_read_b64 v[22:23], v27 offset:32
    s_waitcnt lgkmcnt(0)
    v_mul_f32 v22, v22, v23
    v_cmp_nge_f32 vcc, 0x44c22cbd, v22
    s_cmp_eq_u64 vcc, 0
    s_cselect_b32 s57, 1, 2
    v_mov_b32 v22, s57
    ds_write_b32 v27, v22 offset:72
L_novi:
    s_cmp_lg_u32 s53, 99
    s_cbranch_scc1 L_nopf
    s_setprio 0
    s_and_b32 s56, s2, 31
    s_mul_i32 s54, s48, 1769472
    s_mul_i32 s55, s56, 6912
    s_add_u32 s54, s54, s55
    s_add_u32 s54, s54, 221184
    s_mov_b32 exec_hi, 0x3fffff
    s_add_u32 s54, s54, 221184
    buffer_load_dword v31, v17, s[40:43], s54 offen
    s_waitcnt vmcnt(1)
    s_add_u32 s54, s54, 221184
    buffer_load_dword v31, v17, s[40:43], s54 offen
    s_waitcnt vmcnt(1)
    s_add_u32 s54, s54, 221184
    buffer_load_dword v31, v17, s[40:43], s54 offen
    s_waitcnt vmcnt(1)
    s_add_u32 s54, s54, 221184
    buffer_load_dword v31, v17, s[40:43], s54 offen
    s_waitcnt vmcnt(1)
    s_add_u32 s54, s54, 221184
    buffer_load_dword v31, v17, s[40:43], s54 offen
    s_waitcnt vmcnt(1)
    s_add_u32 s54, s54, 221184
    buffer_load_dword v31, v17, s[40:43], s54 offen
    s_waitcnt vmcnt(1)
    s_mov_b32 exec_hi, -1
    s_mov_b64 s[40:41], s[20:21]
    s_mov_b32 s42, 7077888
    s_mul_i32 s54, s48, 1835008
    s_lshl_b32 s55, s56, 13
    s_add_u32 s54, s54, s55
    buffer_load_dword v31, v17, s[40:43], s54 offen
    s_add_u32 s54, s54, 262144
    s_waitcnt vmcnt(1)
    buffer_load_dword v31, v17, s[40:43], s54 offen
    s_add_u32 s54, s54, 262144
    s_waitcnt vmcnt(1)
    buffer_load_dword v31, v17, s[40:43], s54 offen
    s_add_u32 s54, s54, 262144
    s_waitcnt vmcnt(1)
    buffer_load_dword v31, v17, s[40:43], s54 offen
    s_add_u32 s54, s54, 262144
    s_waitcnt vmcnt(1)
    buffer_load_dword v31, v17, s[40:43], s54 offen
    s_add_u32 s54, s54, 262144
    s_waitcnt vmcnt(1)
    s_setprio 2
L_nopf:
    s_cmp_lg_u32 s53, 27
    s_cbranch_scc1 L_notr
    s_mul_i32 s54, s49, 160
    s_movk_i32 s55, 1280
    s_movk_i32 s56, 5120
    s_movk_i32 s57, 25600
    v_add_u32 v32, 0, v0
    v_mul_u32_u24 v33, 6554, v32
    v_lshrrev_b32 v33, 16, v33
    v_mul_u32_u24 v36, 10, v33
    v_sub_u32 v32, v32, v36
    v_lshl_add_u32 v32, v32, 4, s54
    v_bfe_u32 v36, v33, 2, 2
    v_lshrrev_b32 v37, 4, v33
    v_and_b32 v33, 3, v33
    v_mad_u32_u24 v32, v33, s55, v32
    v_lshl_add_u32 v33, v36, 1, v37
    v_mad_u32_u24 v33, v33, s57, v32
    v_add_u32 v26, 20480, v33
    v_lshrrev_b32 v33, 1, v36
    v_mul_u32_u24 v33, 3, v33
    v_add_u32 v33, v33, v36
    v_lshl_add_u32 v33, v37, 1, v33
    v_mad_u32_u24 v21, v33, s56, v32
    v_add_u32 v32, 64, v0
    v_mul_u32_u24 v33, 6554, v32
    v_lshrrev_b32 v33, 16, v33
    v_mul_u32_u24 v36, 10, v33
    v_sub_u32 v32, v32, v36
    v_lshl_add_u32 v32, v32, 4, s54
    v_bfe_u32 v36, v33, 2, 2
    v_lshrrev_b32 v37, 4, v33
    v_and_b32 v33, 3, v33
    v_mad_u32_u24 v32, v33, s55, v32
    v_subrev_u32 v32, 1024, v32
    v_lshl_add_u32 v33, v36, 1, v37
    v_mad_u32_u24 v33, v33, s57, v32
    v_add_u32 v27, 20480, v33
    v_lshrrev_b32 v33, 1, v36
    v_mul_u32_u24 v33, 3, v33
    v_add_u32 v33, v33, v36
    v_lshl_add_u32 v33, v37, 1, v33
    v_mad_u32_u24 v22, v33, s56, v32
    v_add_u32 v32, 128, v0
    v_mul_u32_u24 v33, 6554, v32
    v_lshrrev_b32 v33, 16, v33
    v_mul_u32_u24 v36, 10, v33
    v_sub_u32 v32, v32, v36
    v_lshl_add_u32 v32, v32, 4, s54
    v_bfe_u32 v36, v33, 2, 2
    v_lshrrev_b32 v37, 4, v33
    v_and_b32 v33, 3, v33
    v_mad_u32_u24 v32, v33, s55, v32
    v_subrev_u32 v32, 2048, v32
    v_lshl_add_u32 v33, v36, 1, v37
    v_mad_u32_u24 v33, v33, s57, v32
    v_add_u32 v28, 20480, v33
    v_lshrrev_b32 v33, 1, v36
    v_mul_u32_u24 v33, 3, v33
    v_add_u32 v33, v33, v36
    v_lshl_add_u32 v33, v37, 1, v33
    v_mad_u32_u24 v23, v33, s56, v32
    v_add_u32 v32, 192, v0
    v_mul_u32_u24 v33, 6554, v32
    v_lshrrev_b32 v33, 16, v33
    v_mul_u32_u24 v36, 10, v33
    v_sub_u32 v32, v32, v36
    v_lshl_add_u32 v32, v32, 4, s54
    v_bfe_u32 v36, v33, 2, 2
    v_lshrrev_b32 v37, 4, v33
    v_and_b32 v33, 3, v33
    v_mad_u32_u24 v32, v33, s55, v32
    v_subrev_u32 v32, 3072, v32
    v_lshl_add_u32 v33, v36, 1, v37
    v_mad_u32_u24 v33, v33, s57, v32
    v_add_u32 v29, 20480, v33
    v_lshrrev_b32 v33, 1, v36
    v_mul_u32_u24 v33, 3, v33
    v_add_u32 v33, v33, v36
    v_lshl_add_u32 v33, v37, 1, v33
    v_mad_u32_u24 v24, v33, s56, v32
    v_add_u32 v32, 256, v0
    v_mul_u32_u24 v33, 6554, v32
    v_lshrrev_b32 v33, 16, v33
    v_mul_u32_u24 v36, 10, v33
    v_sub_u32 v32, v32, v36
    v_lshl_add_u32 v32, v32, 4, s54
    v_bfe_u32 v36, v33, 2, 2
    v_lshrrev_b32 v37, 4, v33
    v_and_b32 v33, 3, v33
    v_mad_u32_u24 v32, v33, s55, v32
    v_lshl_add_u32 v33, v36, 1, v37
    v_mad_u32_u24 v33, v33, s57, v32
    v_add_u32 v30, 20480, v33
    v_lshrrev_b32 v33, 1, v36
    v_mul_u32_u24 v33, 3, v33
    v_add_u32 v33, v33, v36
    v_lshl_add_u32 v33, v37, 1, v33
    v_mad_u32_u24 v25, v33, s56, v32
    s_mov_b64 s[36:37], s[12:13]
    s_mov_b32 s38, 819200
    v_mov_b32 v15, s52
    s_setprio 0
    s_mul_i32 s60, s48, 204800
    s_add_u32 m0, s58, 15360
    s_nop 0
    buffer_load_dwordx4 v26, s[36:39], s60 offen offset:0 lds
    buffer_load_dwordx4 v27, s[36:39], s60 offen offset:1024 lds
    buffer_load_dwordx4 v28, s[36:39], s60 offen offset:2048 lds
    buffer_load_dwordx4 v29, s[36:39], s60 offen offset:3072 lds
    s_add_u32 m0, s58, 19456
    s_nop 0
    buffer_load_dwordx4 v30, s[36:39], s60 offen lds
    s_add_u32 m0, s58, 0
    s_nop 0
    buffer_load_dwordx4 v21, s[36:39], s60 offen offset:0 lds
    buffer_load_dwordx4 v22, s[36:39], s60 offen offset:1024 lds
    buffer_load_dwordx4 v23, s[36:39], s60 offen offset:2048 lds
    buffer_load_dwordx4 v24, s[36:39], s60 offen offset:3072 lds
    s_add_u32 m0, s58, 4096
    s_nop 0
    buffer_load_dwordx4 v25, s[36:39], s60 offen lds
    s_add_u32 s60, s60, 51200
    s_waitcnt vmcnt(5)
    ds_read_b64_tr_b16 v[112:113], v14 offset:15360
    ds_read_b64_tr_b16 v[114:115], v14 offset:17920
    ds_read_b64_tr_b16 v[116:117], v14 offset:15392
    ds_read_b64_tr_b16 v[118:119], v14 offset:17952
    ds_read_b64_tr_b16 v[120:121], v14 offset:15424
    ds_read_b64_tr_b16 v[122:123], v14 offset:17984
    ds_read_b64_tr_b16 v[124:125], v14 offset:15456
    ds_read_b64_tr_b16 v[126:127], v14 offset:18016
    ds_read_b64_tr_b16 v[128:129], v14 offset:15488
    ds_read_b64_tr_b16 v[130:131], v14 offset:18048
    s_add_u32 m0, s58, 5120
    s_nop 0
    buffer_load_dwordx4 v21, s[36:39], s60 offen offset:0 lds
    buffer_load_dwordx4 v22, s[36:39], s60 offen offset:1024 lds
    buffer_load_dwordx4 v23, s[36:39], s60 offen offset:2048 lds
    buffer_load_dwordx4 v24, s[36:39], s60 offen offset:3072 lds
    s_add_u32 m0, s58, 9216
    s_nop 0
    buffer_load_dwordx4 v25, s[36:39], s60 offen lds
    s_add_u32 s60, s60, 51200
    s_waitcnt vmcnt(5)
    s_nop 0
    ds_read_b64_tr_b16 v[168:169], v14 offset:0
    ds_read_b64_tr_b16 v[170:171], v14 offset:2560
    ds_read_b64_tr_b16 v[172:173], v14 offset:32
    ds_read_b64_tr_b16 v[174:175], v14 offset:2592
    ds_read_b64_tr_b16 v[176:177], v14 offset:64
    ds_read_b64_tr_b16 v[178:179], v14 offset:2624
    ds_read_b64_tr_b16 v[180:181], v14 offset:96
    ds_read_b64_tr_b16 v[182:183], v14 offset:2656
    ds_read_b64_tr_b16 v[184:185], v14 offset:128
    ds_read_b64_tr_b16 v[186:187], v14 offset:2688
    s_add_u32 m0, s58, 10240
    s_nop 0
    buffer_load_dwordx4 v21, s[36:39], s60 offen offset:0 lds
    buffer_load_dwordx4 v22, s[36:39], s60 offen offset:1024 lds
    buffer_load_dwordx4 v23, s[36:39], s60 offen offset:2048 lds
    buffer_load_dwordx4 v24, s[36:39], s60 offen offset:3072 lds
    s_add_u32 m0, s58, 14336
    s_nop 0
    buffer_load_dwordx4 v25, s[36:39], s60 offen lds
    s_add_u32 s60, s60, 51200
    s_waitcnt vmcnt(5)
    s_nop 0
    ds_read_b64_tr_b16 v[188:189], v14 offset:5120
    ds_read_b64_tr_b16 v[190:191], v14 offset:7680
    ds_read_b64_tr_b16 v[192:193], v14 offset:5152
    ds_read_b64_tr_b16 v[194:195], v14 offset:7712
    ds_read_b64_tr_b16 v[196:197], v14 offset:5184
    ds_read_b64_tr_b16 v[198:199], v14 offset:7744
    ds_read_b64_tr_b16 v[200:201], v14 offset:5216
    ds_read_b64_tr_b16 v[202:203], v14 offset:7776
    ds_read_b64_tr_b16 v[204:205], v14 offset:5248
    ds_read_b64_tr_b16 v[206:207], v14 offset:7808
    s_waitcnt lgkmcnt(0)
    s_add_u32 m0, s58, 15360
    s_nop 0
    buffer_load_dwordx4 v21, s[36:39], s60 offen offset:0 lds
    buffer_load_dwordx4 v22, s[36:39], s60 offen offset:1024 lds
    buffer_load_dwordx4 v23, s[36:39], s60 offen offset:2048 lds
    buffer_load_dwordx4 v24, s[36:39], s60 offen offset:3072 lds
    s_add_u32 m0, s58, 19456
    s_nop 0
    buffer_load_dwordx4 v25, s[36:39], s60 offen lds
    s_add_u32 s60, s60, 51200
    s_waitcnt vmcnt(5)
    ds_read_b64_tr_b16 v[208:209], v14 offset:10240
    ds_read_b64_tr_b16 v[210:211], v14 offset:12800
    ds_read_b64_tr_b16 v[212:213], v14 offset:10272
    ds_read_b64_tr_b16 v[214:215], v14 offset:12832
    ds_read_b64_tr_b16 v[216:217], v14 offset:10304
    ds_read_b64_tr_b16 v[218:219], v14 offset:12864
    ds_read_b64_tr_b16 v[220:221], v14 offset:10336
    ds_read_b64_tr_b16 v[222:223], v14 offset:12896
    ds_read_b64_tr_b16 v[224:225], v14 offset:10368
    ds_read_b64_tr_b16 v[226:227], v14 offset:12928
    s_waitcnt vmcnt(0)
    s_nop 0
    ds_read_b64_tr_b16 v[228:229], v14 offset:15360
    ds_read_b64_tr_b16 v[230:231], v14 offset:17920
    ds_read_b64_tr_b16 v[232:233], v14 offset:15392
    ds_read_b64_tr_b16 v[234:235], v14 offset:17952
    ds_read_b64_tr_b16 v[236:237], v14 offset:15424
    ds_read_b64_tr_b16 v[238:239], v14 offset:17984
    ds_read_b64_tr_b16 v[240:241], v14 offset:15456
    ds_read_b64_tr_b16 v[242:243], v14 offset:18016
    ds_read_b64_tr_b16 v[244:245], v14 offset:15488
    ds_read_b64_tr_b16 v[246:247], v14 offset:18048
    s_waitcnt lgkmcnt(0)
    s_mov_b32 s60, s63
    buffer_store_dwordx4 v[168:171], v1, s[32:35], s60 offen offset:0 sc1
    buffer_store_dwordx4 v[172:175], v1, s[32:35], s60 offen offset:1024 sc1
    buffer_store_dwordx4 v[176:179], v1, s[32:35], s60 offen offset:2048 sc1
    buffer_store_dwordx4 v[180:183], v1, s[32:35], s60 offen offset:3072 sc1
    s_add_u32 s60, s60, 4096
    buffer_store_dwordx4 v[184:187], v1, s[32:35], s60 offen offset:0 sc1
    buffer_store_dwordx4 v[188:191], v1, s[32:35], s60 offen offset:1024 sc1
    buffer_store_dwordx4 v[192:195], v1, s[32:35], s60 offen offset:2048 sc1
    buffer_store_dwordx4 v[196:199], v1, s[32:35], s60 offen offset:3072 sc1
    s_add_u32 s60, s60, 4096
    buffer_store_dwordx4 v[200:203], v1, s[32:35], s60 offen offset:0 sc1
    buffer_store_dwordx4 v[204:207], v1, s[32:35], s60 offen offset:1024 sc1
    buffer_store_dwordx4 v[208:211], v1, s[32:35], s60 offen offset:2048 sc1
    buffer_store_dwordx4 v[212:215], v1, s[32:35], s60 offen offset:3072 sc1
    s_add_u32 s60, s60, 4096
    buffer_store_dwordx4 v[216:219], v1, s[32:35], s60 offen offset:0 sc1
    buffer_store_dwordx4 v[220:223], v1, s[32:35], s60 offen offset:1024 sc1
    buffer_store_dwordx4 v[224:227], v1, s[32:35], s60 offen offset:2048 sc1
    buffer_store_dwordx4 v[228:231], v1, s[32:35], s60 offen offset:3072 sc1
    s_add_u32 s60, s60, 4096
    buffer_store_dwordx4 v[232:235], v1, s[32:35], s60 offen offset:0 sc1
    buffer_store_dwordx4 v[236:239], v1, s[32:35], s60 offen offset:1024 sc1
    buffer_store_dwordx4 v[240:243], v1, s[32:35], s60 offen offset:2048 sc1
    buffer_store_dwordx4 v[244:247], v1, s[32:35], s60 offen offset:3072 sc1
    s_add_u32 s60, s60, 4096
    buffer_store_dwordx4 v[112:115], v1, s[32:35], s60 offen offset:0 sc1
    buffer_store_dwordx4 v[116:119], v1, s[32:35], s60 offen offset:1024 sc1
    buffer_store_dwordx4 v[120:123], v1, s[32:35], s60 offen offset:2048 sc1
    buffer_store_dwordx4 v[124:127], v1, s[32:35], s60 offen offset:3072 sc1
    s_add_u32 s60, s60, 4096
    buffer_store_dwordx4 v[128:131], v1, s[32:35], s60 offen offset:0 sc1
    s_mov_b64 exec, 1
    s_waitcnt vmcnt(0)
    buffer_store_dword v15, v0, s[32:35], s3 offen sc1
    s_mov_b64 exec, -1
    s_setprio 2
L_notr:
    v_mul_u32_u24 v13, 4096, v252
    v_add_u32 v248, v13, v253
    v_add_u32 v249, 64512, v248
    v_add_u32 v250, 14336, v248
    v_add_u32 v251, 78848, v248
    s_mov_b64 s[40:41], s[20:21]
    s_mov_b32 s42, 7077888
    s_lshl_b32 s61, s50, 7
    s_mul_i32 s54, s48, 1835008
    s_add_u32 s61, s61, s54
    s_mul_i32 s54, s48, 1835008
    s_mul_i32 s55, s2, 2048
    s_add_u32 s54, s54, s55
    s_add_u32 s54, s54, 1310720
    s_mov_b64 exec, 65535
    buffer_load_dword v31, v17, s[44:47], s54 offen
    s_mov_b64 exec, -1
L_wod:
    s_setprio 0
    s_add_u32 m0, s58, 0
    s_nop 0
    s_nop 0
    buffer_load_dwordx4 v248, s[40:43], s61 offen offset:0 lds
    buffer_load_dwordx4 v249, s[40:43], s61 offen offset:1024 lds
    buffer_load_dwordx4 v250, s[40:43], s61 offen offset:2048 lds
    buffer_load_dwordx4 v251, s[40:43], s61 offen offset:3072 lds
    s_add_u32 s61, s61, 131072
    s_add_u32 m0, s58, 4096
    s_nop 0
    s_nop 0
    buffer_load_dwordx4 v248, s[40:43], s61 offen offset:0 lds
    buffer_load_dwordx4 v249, s[40:43], s61 offen offset:1024 lds
    buffer_load_dwordx4 v250, s[40:43], s61 offen offset:2048 lds
    buffer_load_dwordx4 v251, s[40:43], s61 offen offset:3072 lds
    s_add_u32 s61, s61, 131072
    s_add_u32 m0, s58, 8192
    s_nop 0
    s_nop 0
    buffer_load_dwordx4 v248, s[40:43], s61 offen offset:0 lds
    buffer_load_dwordx4 v249, s[40:43], s61 offen offset:1024 lds
    buffer_load_dwordx4 v250, s[40:43], s61 offen offset:2048 lds
    buffer_load_dwordx4 v251, s[40:43], s61 offen offset:3072 lds
    s_add_u32 s61, s61, 131072
    s_add_u32 m0, s58, 12288
    s_nop 0
    buffer_load_dwordx4 v248, s[40:43], s61 offen offset:0 lds
    buffer_load_dwordx4 v249, s[40:43], s61 offen offset:1024 lds
    buffer_load_dwordx4 v250, s[40:43], s61 offen offset:2048 lds
    buffer_load_dwordx4 v251, s[40:43], s61 offen offset:3072 lds
    s_add_u32 s61, s61, 131072
    s_setprio 2
    s_mov_b64 s[44:45], s[22:23]
    s_mov_b32 s46, 4096
    s_lshl2_add_u32 s55, s50, s48
    s_lshl_b32 s55, s55, 5
    v_lshlrev_b32 v13, 1, v4
    buffer_load_ushort v253, v13, s[44:47], s55 offen
    s_sub_u32 s62, s58, s62
    v_add_u32 v8, s62, v8
    v_add_u32 v9, s62, v9
    v_add_u32 v10, s62, v10
    v_add_u32 v11, s62, v11
    v_add_u32 v2, s62, v2
    s_xor_b32 s62, s48, 1
    s_mul_i32 s62, s62, 5376
    s_add_u32 s62, s62, 66048
    v_add_u32 v254, s62, v254
    s_xor_b32 s62, s48, 2
    s_mul_i32 s62, s62, 5376
    s_add_u32 s62, s62, 66048
    v_add_u32 v6, s62, v6
    s_xor_b32 s62, s48, 3
    s_mul_i32 s62, s62, 5376
    s_add_u32 s62, s62, 66048
    v_add_u32 v5, s62, v5
    s_mov_b64 s[36:37], s[30:31]
    s_mov_b32 s38, 6406144
    s_mul_i32 s60, s48, 573440
    s_mul_i32 s55, s49, 5120
    s_add_u32 s60, s60, s55
    s_add_u32 s60, s60, 4194304
    s_mul_i32 s55, s48, 7
    v_add_u32 v16, s55, v0
    v_min_u32 v16, 26, v16
    v_lshlrev_b32 v16, 7, v16
    s_lshl_b32 s59, s49, 12
    s_add_u32 s59, s59, 98304
    v_lshrrev_b32 v13, 2, v0
    v_mul_u32_u24 v13, 112, v13
    v_lshl_add_u32 v13, v0, 2, v13
    s_mul_i32 s62, s50, 81920
    s_mul_i32 s55, s48, 20480
    s_add_u32 s62, s62, s55
    s_add_u32 s62, s62, 7340032
    s_xor_b32 s98, s48, 3
    s_lshl_b32 s98, s98, 10
    s_add_u32 s98, s98, s62
    s_xor_b32 s99, s48, 2
    s_lshl_b32 s99, s99, 10
    s_add_u32 s99, s99, s62
    s_xor_b32 s100, s48, 1
    s_lshl_b32 s100, s100, 10
    s_add_u32 s100, s100, s62
    s_xor_b32 s101, s48, 0
    s_lshl_b32 s101, s101, 10
    s_add_u32 s101, s101, s62
L_wpoll:
    s_mov_b64 exec, 1
L_pl_35:
    v_mov_b32 v15, 0
    buffer_atomic_or v15, v0, s[32:35], s3 offen sc0 sc1
    s_add_u32 s97, s97, 16
    s_waitcnt vmcnt(0)
    v_cmp_ne_u32 vcc, s52, v15
    s_cbranch_vccz L_pd_36
    s_mov_b64 exec, vcc
    s_sleep 4
    s_cmp_lt_u32 s97, 1048576
    s_cbranch_scc1 L_pl_35
L_pd_36:
    s_mov_b64 exec, -1
L_g2:
    s_setprio 0
    buffer_load_dwordx4 v[168:171], v1, s[32:35], s63 offen offset:0 sc1
    buffer_load_dwordx4 v[172:175], v1, s[32:35], s63 offen offset:1024 sc1
    buffer_load_dwordx4 v[176:179], v1, s[32:35], s63 offen offset:2048 sc1
    buffer_load_dwordx4 v[180:183], v1, s[32:35], s63 offen offset:3072 sc1
    s_add_u32 s63, s63, 4096
    buffer_load_dwordx4 v[184:187], v1, s[32:35], s63 offen offset:0 sc1
    buffer_load_dwordx4 v[188:191], v1, s[32:35], s63 offen offset:1024 sc1
    buffer_load_dwordx4 v[192:195], v1, s[32:35], s63 offen offset:2048 sc1
    buffer_load_dwordx4 v[196:199], v1, s[32:35], s63 offen offset:3072 sc1
    s_add_u32 s63, s63, 4096
    buffer_load_dwordx4 v[200:203], v1, s[32:35], s63 offen offset:0 sc1
    buffer_load_dwordx4 v[204:207], v1, s[32:35], s63 offen offset:1024 sc1
    buffer_load_dwordx4 v[208:211], v1, s[32:35], s63 offen offset:2048 sc1
    buffer_load_dwordx4 v[212:215], v1, s[32:35], s63 offen offset:3072 sc1
    s_add_u32 s63, s63, 4096
    s_setprio 2
    s_mov_b64 exec, 0x7f
L_pl_37:
    v_mov_b32 v15, 0
    buffer_atomic_or v15, v16, s[32:35], s59 offen sc0 sc1
    s_add_u32 s97, s97, 16
    s_waitcnt vmcnt(0)
    v_cmp_ne_u32 vcc, s52, v15
    s_and_b32 s96, vcc_lo, 1
    s_cbranch_scc0 L_pd_38
    s_mov_b64 exec, vcc
    s_sleep 4
    s_cmp_lt_u32 s97, 1048576
    s_cbranch_scc1 L_pl_37
L_pd_38:
    s_mov_b64 exec, -1
    s_mov_b64 s[56:57], vcc
    s_setprio 0
    s_nop 0
    buffer_load_dwordx4 v[112:115], v1, s[36:39], s60 offen offset:0 sc1
    buffer_load_dwordx4 v[116:119], v1, s[36:39], s60 offen offset:1024 sc1
    buffer_load_dwordx4 v[120:123], v1, s[36:39], s60 offen offset:2048 sc1
    buffer_load_dwordx4 v[124:127], v1, s[36:39], s60 offen offset:3072 sc1
    buffer_load_dwordx4 v[128:131], v12, s[36:39], s60 offen sc1
    s_add_u32 s60, s60, 40960
    buffer_load_dwordx4 v[132:135], v1, s[36:39], s60 offen offset:0 sc1
    buffer_load_dwordx4 v[136:139], v1, s[36:39], s60 offen offset:1024 sc1
    buffer_load_dwordx4 v[140:143], v1, s[36:39], s60 offen offset:2048 sc1
    buffer_load_dwordx4 v[144:147], v1, s[36:39], s60 offen offset:3072 sc1
    buffer_load_dwordx4 v[148:151], v12, s[36:39], s60 offen sc1
    s_add_u32 s60, s60, 40960
    s_setprio 2
    s_nop 0
    ds_read_b64_tr_b16 v[152:153], v8 offset:0
    ds_read_b64_tr_b16 v[154:155], v8 offset:2048
    ds_read_b64_tr_b16 v[156:157], v9 offset:0
    ds_read_b64_tr_b16 v[158:159], v9 offset:2048
    ds_read_b64_tr_b16 v[160:161], v10 offset:0
    ds_read_b64_tr_b16 v[162:163], v10 offset:2048
    ds_read_b64_tr_b16 v[164:165], v11 offset:0
    ds_read_b64_tr_b16 v[166:167], v11 offset:2048
    s_lshl2_add_u32 s54, s50, s48
    s_lshl_b32 s54, s54, 8
    s_add_u32 s54, s54, 131072
    s_waitcnt vmcnt(5)
    s_cmp_eq_u32 s56, 0
    s_cbranch_scc1 L_u1
    s_mov_b64 exec, s[56:57]
    v_mov_b32 v15, 0
    buffer_atomic_or v15, v16, s[32:35], s59 offen sc0 sc1
    s_mov_b64 exec, -1
L_u1:
    s_waitcnt vmcnt(63) lgkmcnt(6)
    s_setprio 0
    v_mfma_f32_16x16x32_bf16 v[32:35], v[112:115], v[152:155], 0
    v_mfma_f32_16x16x32_bf16 v[48:51], v[116:119], v[152:155], 0
    v_mfma_f32_16x16x32_bf16 v[64:67], v[120:123], v[152:155], 0
    v_mfma_f32_16x16x32_bf16 v[80:83], v[124:127], v[152:155], 0
    v_mfma_f32_16x16x32_bf16 v[96:99], v[128:131], v[152:155], 0
    ds_read_b64_tr_b16 v[152:153], v8 offset:4096
    ds_read_b64_tr_b16 v[154:155], v8 offset:6144
    buffer_load_dwordx4 v[216:219], v1, s[32:35], s63 offen offset:0 sc1
    buffer_load_dwordx4 v[220:223], v1, s[32:35], s63 offen offset:1024 sc1
    buffer_load_dwordx4 v[224:227], v1, s[32:35], s63 offen offset:2048 sc1
    buffer_load_dwordx4 v[228:231], v1, s[32:35], s63 offen offset:3072 sc1
    s_add_u32 s63, s63, 4096
    s_waitcnt lgkmcnt(2)
    v_mfma_f32_16x16x32_bf16 v[36:39], v[112:115], v[156:159], 0
    v_mfma_f32_16x16x32_bf16 v[52:55], v[116:119], v[156:159], 0
    v_mfma_f32_16x16x32_bf16 v[68:71], v[120:123], v[156:159], 0
    v_mfma_f32_16x16x32_bf16 v[84:87], v[124:127], v[156:159], 0
    v_mfma_f32_16x16x32_bf16 v[100:103], v[128:131], v[156:159], 0
    ds_read_b64_tr_b16 v[156:157], v9 offset:4096
    ds_read_b64_tr_b16 v[158:159], v9 offset:6144
    s_add_u32 m0, s58, 0
    s_nop 0
    buffer_load_dwordx4 v248, s[40:43], s61 offen offset:0 lds
    buffer_load_dwordx4 v249, s[40:43], s61 offen offset:1024 lds
    s_waitcnt lgkmcnt(6)
    v_mfma_f32_16x16x32_bf16 v[40:43], v[112:115], v[160:163], 0
    v_mfma_f32_16x16x32_bf16 v[56:59], v[116:119], v[160:163], 0
    v_mfma_f32_16x16x32_bf16 v[72:75], v[120:123], v[160:163], 0
    v_mfma_f32_16x16x32_bf16 v[88:91], v[124:127], v[160:163], 0
    v_mfma_f32_16x16x32_bf16 v[104:107], v[128:131], v[160:163], 0
    ds_read_b64_tr_b16 v[160:161], v10 offset:4096
    ds_read_b64_tr_b16 v[162:163], v10 offset:6144
    buffer_load_dwordx4 v250, s[40:43], s61 offen offset:2048 lds
    buffer_load_dwordx4 v251, s[40:43], s61 offen offset:3072 lds
    s_add_u32 s61, s61, 131072
    s_waitcnt lgkmcnt(6)
    s_cmp_eq_u32 s56, 0
    s_cbranch_scc1 L_u2
    s_waitcnt vmcnt(0)
    v_cmp_ne_u32 vcc, s52, v15
    s_and_b32 s56, s56, vcc_lo
    s_cbranch_scc0 L_u2
    s_mov_b64 exec, s[56:57]
L_pl_39:
    v_mov_b32 v15, 0
    buffer_atomic_or v15, v16, s[32:35], s59 offen sc0 sc1
    s_add_u32 s97, s97, 16
    s_waitcnt vmcnt(0)
    v_cmp_ne_u32 vcc, s52, v15
    s_cbranch_vccz L_pd_40
    s_mov_b64 exec, vcc
    s_sleep 4
    s_cmp_lt_u32 s97, 1048576
    s_cbranch_scc1 L_pl_39
L_pd_40:
    s_mov_b64 exec, -1
L_u2:
    v_mfma_f32_16x16x32_bf16 v[44:47], v[112:115], v[164:167], 0
    v_mfma_f32_16x16x32_bf16 v[60:63], v[116:119], v[164:167], 0
    v_mfma_f32_16x16x32_bf16 v[76:79], v[120:123], v[164:167], 0
    v_mfma_f32_16x16x32_bf16 v[92:95], v[124:127], v[164:167], 0
    v_mfma_f32_16x16x32_bf16 v[108:111], v[128:131], v[164:167], 0
    ds_read_b64_tr_b16 v[164:165], v11 offset:4096
    ds_read_b64_tr_b16 v[166:167], v11 offset:6144
    buffer_load_dwordx4 v[112:115], v1, s[36:39], s60 offen offset:0 sc1
    buffer_load_dwordx4 v[116:119], v1, s[36:39], s60 offen offset:1024 sc1
    buffer_load_dwordx4 v[120:123], v1, s[36:39], s60 offen offset:2048 sc1
    buffer_load_dwordx4 v[124:127], v1, s[36:39], s60 offen offset:3072 sc1
    buffer_load_dwordx4 v[128:131], v12, s[36:39], s60 offen sc1
    s_add_u32 s60, s60, 40960
    s_waitcnt vmcnt(13) lgkmcnt(6)
    v_mfma_f32_16x16x32_bf16 v[32:35], v[132:135], v[152:155], v[32:35]
    v_mfma_f32_16x16x32_bf16 v[48:51], v[136:139], v[152:155], v[48:51]
    v_mfma_f32_16x16x32_bf16 v[64:67], v[140:143], v[152:155], v[64:67]
    v_mfma_f32_16x16x32_bf16 v[80:83], v[144:147], v[152:155], v[80:83]
    v_mfma_f32_16x16x32_bf16 v[96:99], v[148:151], v[152:155], v[96:99]
    ds_read_b64_tr_b16 v[152:153], v8 offset:8192
    ds_read_b64_tr_b16 v[154:155], v8 offset:10240
    buffer_load_dwordx4 v[232:235], v1, s[32:35], s63 offen offset:0 sc1
    buffer_load_dwordx4 v[236:239], v1, s[32:35], s63 offen offset:1024 sc1
    buffer_load_dwordx4 v[240:243], v1, s[32:35], s63 offen offset:2048 sc1
    buffer_load_dwordx4 v[244:247], v1, s[32:35], s63 offen offset:3072 sc1
    s_add_u32 s63, s63, 4096
    s_waitcnt lgkmcnt(2)
    v_mfma_f32_16x16x32_bf16 v[36:39], v[132:135], v[156:159], v[36:39]
    v_mfma_f32_16x16x32_bf16 v[52:55], v[136:139], v[156:159], v[52:55]
    v_mfma_f32_16x16x32_bf16 v[68:71], v[140:143], v[156:159], v[68:71]
    v_mfma_f32_16x16x32_bf16 v[84:87], v[144:147], v[156:159], v[84:87]
    v_mfma_f32_16x16x32_bf16 v[100:103], v[148:151], v[156:159], v[100:103]
    ds_read_b64_tr_b16 v[156:157], v9 offset:8192
    ds_read_b64_tr_b16 v[158:159], v9 offset:10240
    s_add_u32 m0, s58, 4096
    s_nop 0
    buffer_load_dwordx4 v248, s[40:43], s61 offen offset:0 lds
    buffer_load_dwordx4 v249, s[40:43], s61 offen offset:1024 lds
    s_waitcnt lgkmcnt(6)
    v_mfma_f32_16x16x32_bf16 v[40:43], v[132:135], v[160:163], v[40:43]
    v_mfma_f32_16x16x32_bf16 v[56:59], v[136:139], v[160:163], v[56:59]
    v_mfma_f32_16x16x32_bf16 v[72:75], v[140:143], v[160:163], v[72:75]
    v_mfma_f32_16x16x32_bf16 v[88:91], v[144:147], v[160:163], v[88:91]
    v_mfma_f32_16x16x32_bf16 v[104:107], v[148:151], v[160:163], v[104:107]
    ds_read_b64_tr_b16 v[160:161], v10 offset:8192
    ds_read_b64_tr_b16 v[162:163], v10 offset:10240
    buffer_load_dwordx4 v250, s[40:43], s61 offen offset:2048 lds
    buffer_load_dwordx4 v251, s[40:43], s61 offen offset:3072 lds
    s_add_u32 s61, s61, 131072
    s_waitcnt lgkmcnt(6)
    v_mfma_f32_16x16x32_bf16 v[44:47], v[132:135], v[164:167], v[44:47]
    v_mfma_f32_16x16x32_bf16 v[60:63], v[136:139], v[164:167], v[60:63]
    v_mfma_f32_16x16x32_bf16 v[76:79], v[140:143], v[164:167], v[76:79]
    v_mfma_f32_16x16x32_bf16 v[92:95], v[144:147], v[164:167], v[92:95]
    v_mfma_f32_16x16x32_bf16 v[108:111], v[148:151], v[164:167], v[108:111]
    ds_read_b64_tr_b16 v[164:165], v11 offset:8192
    ds_read_b64_tr_b16 v[166:167], v11 offset:10240
    buffer_load_dwordx4 v[132:135], v1, s[36:39], s60 offen offset:0 sc1
    buffer_load_dwordx4 v[136:139], v1, s[36:39], s60 offen offset:1024 sc1
    buffer_load_dwordx4 v[140:143], v1, s[36:39], s60 offen offset:2048 sc1
    buffer_load_dwordx4 v[144:147], v1, s[36:39], s60 offen offset:3072 sc1
    buffer_load_dwordx4 v[148:151], v12, s[36:39], s60 offen sc1
    s_add_u32 s60, s60, 40960
    s_waitcnt vmcnt(13) lgkmcnt(6)
    v_mfma_f32_16x16x32_bf16 v[32:35], v[112:115], v[152:155], v[32:35]
    v_mfma_f32_16x16x32_bf16 v[48:51], v[116:119], v[152:155], v[48:51]
    v_mfma_f32_16x16x32_bf16 v[64:67], v[120:123], v[152:155], v[64:67]
    v_mfma_f32_16x16x32_bf16 v[80:83], v[124:127], v[152:155], v[80:83]
    v_mfma_f32_16x16x32_bf16 v[96:99], v[128:131], v[152:155], v[96:99]
    ds_read_b64_tr_b16 v[152:153], v8 offset:12288
    ds_read_b64_tr_b16 v[154:155], v8 offset:14336
    s_add_u32 m0, s58, 16384
    s_nop 0
    buffer_load_dwordx4 v1, s[32:35], s63 offen offset:0 sc1 lds
    buffer_load_dwordx4 v1, s[32:35], s63 offen offset:1024 sc1 lds
    buffer_load_dwordx4 v1, s[32:35], s63 offen offset:2048 sc1 lds
    buffer_load_dwordx4 v1, s[32:35], s63 offen offset:3072 sc1 lds
    s_add_u32 m0, s58, 20480
    s_nop 0
    buffer_load_dwordx4 v12, s[32:35], s63 offen sc1 lds
    s_waitcnt lgkmcnt(2)
    v_mfma_f32_16x16x32_bf16 v[36:39], v[112:115], v[156:159], v[36:39]
    v_mfma_f32_16x16x32_bf16 v[52:55], v[116:119], v[156:159], v[52:55]
    v_mfma_f32_16x16x32_bf16 v[68:71], v[120:123], v[156:159], v[68:71]
    v_mfma_f32_16x16x32_bf16 v[84:87], v[124:127], v[156:159], v[84:87]
    v_mfma_f32_16x16x32_bf16 v[100:103], v[128:131], v[156:159], v[100:103]
    ds_read_b64_tr_b16 v[156:157], v9 offset:12288
    ds_read_b64_tr_b16 v[158:159], v9 offset:14336
    s_add_u32 m0, s58, 8192
    s_nop 0
    buffer_load_dwordx4 v248, s[40:43], s61 offen offset:0 lds
    buffer_load_dwordx4 v249, s[40:43], s61 offen offset:1024 lds
    s_waitcnt lgkmcnt(6)
    v_mfma_f32_16x16x32_bf16 v[40:43], v[112:115], v[160:163], v[40:43]
    v_mfma_f32_16x16x32_bf16 v[56:59], v[116:119], v[160:163], v[56:59]
    v_mfma_f32_16x16x32_bf16 v[72:75], v[120:123], v[160:163], v[72:75]
    v_mfma_f32_16x16x32_bf16 v[88:91], v[124:127], v[160:163], v[88:91]
    v_mfma_f32_16x16x32_bf16 v[104:107], v[128:131], v[160:163], v[104:107]
    ds_read_b64_tr_b16 v[160:161], v10 offset:12288
    ds_read_b64_tr_b16 v[162:163], v10 offset:14336
    buffer_load_dwordx4 v250, s[40:43], s61 offen offset:2048 lds
    buffer_load_dwordx4 v251, s[40:43], s61 offen offset:3072 lds
    s_add_u32 s61, s61, 131072
    s_waitcnt lgkmcnt(6)
    v_mfma_f32_16x16x32_bf16 v[44:47], v[112:115], v[164:167], v[44:47]
    v_mfma_f32_16x16x32_bf16 v[60:63], v[116:119], v[164:167], v[60:63]
    v_mfma_f32_16x16x32_bf16 v[76:79], v[120:123], v[164:167], v[76:79]
    v_mfma_f32_16x16x32_bf16 v[92:95], v[124:127], v[164:167], v[92:95]
    v_mfma_f32_16x16x32_bf16 v[108:111], v[128:131], v[164:167], v[108:111]
    ds_read_b64_tr_b16 v[164:165], v11 offset:12288
    ds_read_b64_tr_b16 v[166:167], v11 offset:14336
    buffer_load_dwordx4 v[112:115], v1, s[36:39], s60 offen offset:0 sc1
    buffer_load_dwordx4 v[116:119], v1, s[36:39], s60 offen offset:1024 sc1
    buffer_load_dwordx4 v[120:123], v1, s[36:39], s60 offen offset:2048 sc1
    buffer_load_dwordx4 v[124:127], v1, s[36:39], s60 offen offset:3072 sc1
    buffer_load_dwordx4 v[128:131], v12, s[36:39], s60 offen sc1
    s_add_u32 s60, s60, 40960
    s_waitcnt vmcnt(14) lgkmcnt(6)
    v_mfma_f32_16x16x32_bf16 v[32:35], v[132:135], v[152:155], v[32:35]
    v_mfma_f32_16x16x32_bf16 v[48:51], v[136:139], v[152:155], v[48:51]
    v_mfma_f32_16x16x32_bf16 v[64:67], v[140:143], v[152:155], v[64:67]
    v_mfma_f32_16x16x32_bf16 v[80:83], v[144:147], v[152:155], v[80:83]
    v_mfma_f32_16x16x32_bf16 v[96:99], v[148:151], v[152:155], v[96:99]
    ds_read_b64_tr_b16 v[152:153], v8 offset:0
    ds_read_b64_tr_b16 v[154:155], v8 offset:2048
    s_waitcnt lgkmcnt(2)
    v_mfma_f32_16x16x32_bf16 v[36:39], v[132:135], v[156:159], v[36:39]
    v_mfma_f32_16x16x32_bf16 v[52:55], v[136:139], v[156:159], v[52:55]
    v_mfma_f32_16x16x32_bf16 v[68:71], v[140:143], v[156:159], v[68:71]
    v_mfma_f32_16x16x32_bf16 v[84:87], v[144:147], v[156:159], v[84:87]
    v_mfma_f32_16x16x32_bf16 v[100:103], v[148:151], v[156:159], v[100:103]
    ds_read_b64_tr_b16 v[156:157], v9 offset:0
    ds_read_b64_tr_b16 v[158:159], v9 offset:2048
    s_add_u32 m0, s58, 12288
    s_nop 0
    buffer_load_dwordx4 v248, s[40:43], s61 offen offset:0 lds
    buffer_load_dwordx4 v249, s[40:43], s61 offen offset:1024 lds
    s_waitcnt lgkmcnt(6)
    v_mfma_f32_16x16x32_bf16 v[40:43], v[132:135], v[160:163], v[40:43]
    v_mfma_f32_16x16x32_bf16 v[56:59], v[136:139], v[160:163], v[56:59]
    v_mfma_f32_16x16x32_bf16 v[72:75], v[140:143], v[160:163], v[72:75]
    v_mfma_f32_16x16x32_bf16 v[88:91], v[144:147], v[160:163], v[88:91]
    v_mfma_f32_16x16x32_bf16 v[104:107], v[148:151], v[160:163], v[104:107]
    ds_read_b64_tr_b16 v[160:161], v10 offset:0
    ds_read_b64_tr_b16 v[162:163], v10 offset:2048
    buffer_load_dwordx4 v250, s[40:43], s61 offen offset:2048 lds
    buffer_load_dwordx4 v251, s[40:43], s61 offen offset:3072 lds
    s_add_u32 s61, s61, 131072
    s_waitcnt lgkmcnt(6)
    v_mfma_f32_16x16x32_bf16 v[44:47], v[132:135], v[164:167], v[44:47]
    v_mfma_f32_16x16x32_bf16 v[60:63], v[136:139], v[164:167], v[60:63]
    v_mfma_f32_16x16x32_bf16 v[76:79], v[140:143], v[164:167], v[76:79]
    v_mfma_f32_16x16x32_bf16 v[92:95], v[144:147], v[164:167], v[92:95]
    v_mfma_f32_16x16x32_bf16 v[108:111], v[148:151], v[164:167], v[108:111]
    ds_read_b64_tr_b16 v[164:165], v11 offset:0
    ds_read_b64_tr_b16 v[166:167], v11 offset:2048
    buffer_load_dwordx4 v[132:135], v1, s[36:39], s60 offen offset:0 sc1
    buffer_load_dwordx4 v[136:139], v1, s[36:39], s60 offen offset:1024 sc1
    buffer_load_dwordx4 v[140:143], v1, s[36:39], s60 offen offset:2048 sc1
    buffer_load_dwordx4 v[144:147], v1, s[36:39], s60 offen offset:3072 sc1
    buffer_load_dwordx4 v[148:151], v12, s[36:39], s60 offen sc1
    s_add_u32 s60, s60, 40960
    s_waitcnt vmcnt(9) lgkmcnt(6)
    v_mfma_f32_16x16x32_bf16 v[32:35], v[112:115], v[152:155], v[32:35]
    v_mfma_f32_16x16x32_bf16 v[48:51], v[116:119], v[152:155], v[48:51]
    v_mfma_f32_16x16x32_bf16 v[64:67], v[120:123], v[152:155], v[64:67]
    v_mfma_f32_16x16x32_bf16 v[80:83], v[124:127], v[152:155], v[80:83]
    v_mfma_f32_16x16x32_bf16 v[96:99], v[128:131], v[152:155], v[96:99]
    ds_read_b64_tr_b16 v[152:153], v8 offset:4096
    ds_read_b64_tr_b16 v[154:155], v8 offset:6144
    s_waitcnt lgkmcnt(2)
    v_mfma_f32_16x16x32_bf16 v[36:39], v[112:115], v[156:159], v[36:39]
    v_mfma_f32_16x16x32_bf16 v[52:55], v[116:119], v[156:159], v[52:55]
    v_mfma_f32_16x16x32_bf16 v[68:71], v[120:123], v[156:159], v[68:71]
    v_mfma_f32_16x16x32_bf16 v[84:87], v[124:127], v[156:159], v[84:87]
    v_mfma_f32_16x16x32_bf16 v[100:103], v[128:131], v[156:159], v[100:103]
    ds_read_b64_tr_b16 v[156:157], v9 offset:4096
    ds_read_b64_tr_b16 v[158:159], v9 offset:6144
    s_add_u32 m0, s58, 0
    s_nop 0
    buffer_load_dwordx4 v248, s[40:43], s61 offen offset:0 lds
    buffer_load_dwordx4 v249, s[40:43], s61 offen offset:1024 lds
    s_waitcnt lgkmcnt(6)
    v_mfma_f32_16x16x32_bf16 v[40:43], v[112:115], v[160:163], v[40:43]
    v_mfma_f32_16x16x32_bf16 v[56:59], v[116:119], v[160:163], v[56:59]
    v_mfma_f32_16x16x32_bf16 v[72:75], v[120:123], v[160:163], v[72:75]
    v_mfma_f32_16x16x32_bf16 v[88:91], v[124:127], v[160:163], v[88:91]
    v_mfma_f32_16x16x32_bf16 v[104:107], v[128:131], v[160:163], v[104:107]
    ds_read_b64_tr_b16 v[160:161], v10 offset:4096
    ds_read_b64_tr_b16 v[162:163], v10 offset:6144
    buffer_load_dwordx4 v250, s[40:43], s61 offen offset:2048 lds
    buffer_load_dwordx4 v251, s[40:43], s61 offen offset:3072 lds
    s_add_u32 s61, s61, 131072
    s_waitcnt lgkmcnt(6)
    v_mfma_f32_16x16x32_bf16 v[44:47], v[112:115], v[164:167], v[44:47]
    v_mfma_f32_16x16x32_bf16 v[60:63], v[116:119], v[164:167], v[60:63]
    v_mfma_f32_16x16x32_bf16 v[76:79], v[120:123], v[164:167], v[76:79]
    v_mfma_f32_16x16x32_bf16 v[92:95], v[124:127], v[164:167], v[92:95]
    v_mfma_f32_16x16x32_bf16 v[108:111], v[128:131], v[164:167], v[108:111]
    ds_read_b64_tr_b16 v[164:165], v11 offset:4096
    ds_read_b64_tr_b16 v[166:167], v11 offset:6144
    buffer_load_dwordx4 v[112:115], v1, s[36:39], s60 offen offset:0 sc1
    buffer_load_dwordx4 v[116:119], v1, s[36:39], s60 offen offset:1024 sc1
    buffer_load_dwordx4 v[120:123], v1, s[36:39], s60 offen offset:2048 sc1
    buffer_load_dwordx4 v[124:127], v1, s[36:39], s60 offen offset:3072 sc1
    buffer_load_dwordx4 v[128:131], v12, s[36:39], s60 offen sc1
    s_add_u32 s60, s60, 40960
    s_waitcnt vmcnt(9) lgkmcnt(6)
    v_mfma_f32_16x16x32_bf16 v[32:35], v[132:135], v[152:155], v[32:35]
    v_mfma_f32_16x16x32_bf16 v[48:51], v[136:139], v[152:155], v[48:51]
    v_mfma_f32_16x16x32_bf16 v[64:67], v[140:143], v[152:155], v[64:67]
    v_mfma_f32_16x16x32_bf16 v[80:83], v[144:147], v[152:155], v[80:83]
    v_mfma_f32_16x16x32_bf16 v[96:99], v[148:151], v[152:155], v[96:99]
    ds_read_b64_tr_b16 v[152:153], v8 offset:8192
    ds_read_b64_tr_b16 v[154:155], v8 offset:10240
    s_waitcnt lgkmcnt(2)
    v_mfma_f32_16x16x32_bf16 v[36:39], v[132:135], v[156:159], v[36:39]
    v_mfma_f32_16x16x32_bf16 v[52:55], v[136:139], v[156:159], v[52:55]
    v_mfma_f32_16x16x32_bf16 v[68:71], v[140:143], v[156:159], v[68:71]
    v_mfma_f32_16x16x32_bf16 v[84:87], v[144:147], v[156:159], v[84:87]
    v_mfma_f32_16x16x32_bf16 v[100:103], v[148:151], v[156:159], v[100:103]
    ds_read_b64_tr_b16 v[156:157], v9 offset:8192
    ds_read_b64_tr_b16 v[158:159], v9 offset:10240
    s_add_u32 m0, s58, 4096
    s_nop 0
    buffer_load_dwordx4 v248, s[40:43], s61 offen offset:0 lds
    buffer_load_dwordx4 v249, s[40:43], s61 offen offset:1024 lds
    s_waitcnt lgkmcnt(6)
    v_mfma_f32_16x16x32_bf16 v[40:43], v[132:135], v[160:163], v[40:43]
    v_mfma_f32_16x16x32_bf16 v[56:59], v[136:139], v[160:163], v[56:59]
    v_mfma_f32_16x16x32_bf16 v[72:75], v[140:143], v[160:163], v[72:75]
    v_mfma_f32_16x16x32_bf16 v[88:91], v[144:147], v[160:163], v[88:91]
    v_mfma_f32_16x16x32_bf16 v[104:107], v[148:151], v[160:163], v[104:107]
    ds_read_b64_tr_b16 v[160:161], v10 offset:8192
    ds_read_b64_tr_b16 v[162:163], v10 offset:10240
    buffer_load_dwordx4 v250, s[40:43], s61 offen offset:2048 lds
    buffer_load_dwordx4 v251, s[40:43], s61 offen offset:3072 lds
    s_add_u32 s61, s61, 131072
    s_waitcnt lgkmcnt(6)
    v_mfma_f32_16x16x32_bf16 v[44:47], v[132:135], v[164:167], v[44:47]
    v_mfma_f32_16x16x32_bf16 v[60:63], v[136:139], v[164:167], v[60:63]
    v_mfma_f32_16x16x32_bf16 v[76:79], v[140:143], v[164:167], v[76:79]
    v_mfma_f32_16x16x32_bf16 v[92:95], v[144:147], v[164:167], v[92:95]
    v_mfma_f32_16x16x32_bf16 v[108:111], v[148:151], v[164:167], v[108:111]
    ds_read_b64_tr_b16 v[164:165], v11 offset:8192
    ds_read_b64_tr_b16 v[166:167], v11 offset:10240
    buffer_load_dwordx4 v[132:135], v1, s[36:39], s60 offen offset:0 sc1
    buffer_load_dwordx4 v[136:139], v1, s[36:39], s60 offen offset:1024 sc1
    buffer_load_dwordx4 v[140:143], v1, s[36:39], s60 offen offset:2048 sc1
    buffer_load_dwordx4 v[144:147], v1, s[36:39], s60 offen offset:3072 sc1
    buffer_load_dwordx4 v[148:151], v12, s[36:39], s60 offen sc1
    s_add_u32 s60, s60, 40960
    s_waitcnt vmcnt(9) lgkmcnt(6)
    v_mfma_f32_16x16x32_bf16 v[32:35], v[112:115], v[152:155], v[32:35]
    v_mfma_f32_16x16x32_bf16 v[48:51], v[116:119], v[152:155], v[48:51]
    v_mfma_f32_16x16x32_bf16 v[64:67], v[120:123], v[152:155], v[64:67]
    v_mfma_f32_16x16x32_bf16 v[80:83], v[124:127], v[152:155], v[80:83]
    v_mfma_f32_16x16x32_bf16 v[96:99], v[128:131], v[152:155], v[96:99]
    ds_read_b64_tr_b16 v[152:153], v8 offset:12288
    ds_read_b64_tr_b16 v[154:155], v8 offset:14336
    s_waitcnt lgkmcnt(2)
    v_mfma_f32_16x16x32_bf16 v[36:39], v[112:115], v[156:159], v[36:39]
    v_mfma_f32_16x16x32_bf16 v[52:55], v[116:119], v[156:159], v[52:55]
    v_mfma_f32_16x16x32_bf16 v[68:71], v[120:123], v[156:159], v[68:71]
    v_mfma_f32_16x16x32_bf16 v[84:87], v[124:127], v[156:159], v[84:87]
    v_mfma_f32_16x16x32_bf16 v[100:103], v[128:131], v[156:159], v[100:103]
    ds_read_b64_tr_b16 v[156:157], v9 offset:12288
    ds_read_b64_tr_b16 v[158:159], v9 offset:14336
    s_add_u32 m0, s58, 8192
    s_nop 0
    buffer_load_dwordx4 v248, s[40:43], s61 offen offset:0 lds
    buffer_load_dwordx4 v249, s[40:43], s61 offen offset:1024 lds
    s_waitcnt lgkmcnt(6)
    v_mfma_f32_16x16x32_bf16 v[40:43], v[112:115], v[160:163], v[40:43]
    v_mfma_f32_16x16x32_bf16 v[56:59], v[116:119], v[160:163], v[56:59]
    v_mfma_f32_16x16x32_bf16 v[72:75], v[120:123], v[160:163], v[72:75]
    v_mfma_f32_16x16x32_bf16 v[88:91], v[124:127], v[160:163], v[88:91]
    v_mfma_f32_16x16x32_bf16 v[104:107], v[128:131], v[160:163], v[104:107]
    ds_read_b64_tr_b16 v[160:161], v10 offset:12288
    ds_read_b64_tr_b16 v[162:163], v10 offset:14336
    buffer_load_dwordx4 v250, s[40:43], s61 offen offset:2048 lds
    buffer_load_dwordx4 v251, s[40:43], s61 offen offset:3072 lds
    s_add_u32 s61, s61, 131072
    s_waitcnt lgkmcnt(6)
    v_mfma_f32_16x16x32_bf16 v[44:47], v[112:115], v[164:167], v[44:47]
    v_mfma_f32_16x16x32_bf16 v[60:63], v[116:119], v[164:167], v[60:63]
    v_mfma_f32_16x16x32_bf16 v[76:79], v[120:123], v[164:167], v[76:79]
    v_mfma_f32_16x16x32_bf16 v[92:95], v[124:127], v[164:167], v[92:95]
    v_mfma_f32_16x16x32_bf16 v[108:111], v[128:131], v[164:167], v[108:111]
    ds_read_b64_tr_b16 v[164:165], v11 offset:12288
    ds_read_b64_tr_b16 v[166:167], v11 offset:14336
    buffer_load_dwordx4 v[112:115], v1, s[36:39], s60 offen offset:0 sc1
    buffer_load_dwordx4 v[116:119], v1, s[36:39], s60 offen offset:1024 sc1
    buffer_load_dwordx4 v[120:123], v1, s[36:39], s60 offen offset:2048 sc1
    buffer_load_dwordx4 v[124:127], v1, s[36:39], s60 offen offset:3072 sc1
    buffer_load_dwordx4 v[128:131], v12, s[36:39], s60 offen sc1
    s_add_u32 s60, s60, 40960
    s_waitcnt vmcnt(9) lgkmcnt(6)
    v_mfma_f32_16x16x32_bf16 v[32:35], v[132:135], v[152:155], v[32:35]
    v_mfma_f32_16x16x32_bf16 v[48:51], v[136:139], v[152:155], v[48:51]
    v_mfma_f32_16x16x32_bf16 v[64:67], v[140:143], v[152:155], v[64:67]
    v_mfma_f32_16x16x32_bf16 v[80:83], v[144:147], v[152:155], v[80:83]
    v_mfma_f32_16x16x32_bf16 v[96:99], v[148:151], v[152:155], v[96:99]
    ds_read_b64_tr_b16 v[152:153], v8 offset:0
    ds_read_b64_tr_b16 v[154:155], v8 offset:2048
    s_waitcnt lgkmcnt(2)
    v_mfma_f32_16x16x32_bf16 v[36:39], v[132:135], v[156:159], v[36:39]
    v_mfma_f32_16x16x32_bf16 v[52:55], v[136:139], v[156:159], v[52:55]
    v_mfma_f32_16x16x32_bf16 v[68:71], v[140:143], v[156:159], v[68:71]
    v_mfma_f32_16x16x32_bf16 v[84:87], v[144:147], v[156:159], v[84:87]
    v_mfma_f32_16x16x32_bf16 v[100:103], v[148:151], v[156:159], v[100:103]
    ds_read_b64_tr_b16 v[156:157], v9 offset:0
    ds_read_b64_tr_b16 v[158:159], v9 offset:2048
    s_add_u32 m0, s58, 12288
    s_nop 0
    buffer_load_dwordx4 v248, s[40:43], s61 offen offset:0 lds
    buffer_load_dwordx4 v249, s[40:43], s61 offen offset:1024 lds
    s_waitcnt lgkmcnt(6)
    v_mfma_f32_16x16x32_bf16 v[40:43], v[132:135], v[160:163], v[40:43]
    v_mfma_f32_16x16x32_bf16 v[56:59], v[136:139], v[160:163], v[56:59]
    v_mfma_f32_16x16x32_bf16 v[72:75], v[140:143], v[160:163], v[72:75]
    v_mfma_f32_16x16x32_bf16 v[88:91], v[144:147], v[160:163], v[88:91]
    v_mfma_f32_16x16x32_bf16 v[104:107], v[148:151], v[160:163], v[104:107]
    ds_read_b64_tr_b16 v[160:161], v10 offset:0
    ds_read_b64_tr_b16 v[162:163], v10 offset:2048
    buffer_load_dwordx4 v250, s[40:43], s61 offen offset:2048 lds
    buffer_load_dwordx4 v251, s[40:43], s61 offen offset:3072 lds
    s_add_u32 s61, s61, 131072
    s_waitcnt lgkmcnt(6)
    v_mfma_f32_16x16x32_bf16 v[44:47], v[132:135], v[164:167], v[44:47]
    v_mfma_f32_16x16x32_bf16 v[60:63], v[136:139], v[164:167], v[60:63]
    v_mfma_f32_16x16x32_bf16 v[76:79], v[140:143], v[164:167], v[76:79]
    v_mfma_f32_16x16x32_bf16 v[92:95], v[144:147], v[164:167], v[92:95]
    v_mfma_f32_16x16x32_bf16 v[108:111], v[148:151], v[164:167], v[108:111]
    ds_read_b64_tr_b16 v[164:165], v11 offset:0
    ds_read_b64_tr_b16 v[166:167], v11 offset:2048
    buffer_load_dwordx4 v[132:135], v1, s[36:39], s60 offen offset:0 sc1
    buffer_load_dwordx4 v[136:139], v1, s[36:39], s60 offen offset:1024 sc1
    buffer_load_dwordx4 v[140:143], v1, s[36:39], s60 offen offset:2048 sc1
    buffer_load_dwordx4 v[144:147], v1, s[36:39], s60 offen offset:3072 sc1
    buffer_load_dwordx4 v[148:151], v12, s[36:39], s60 offen sc1
    s_add_u32 s60, s60, 40960
    s_waitcnt vmcnt(9) lgkmcnt(6)
    v_mfma_f32_16x16x32_bf16 v[32:35], v[112:115], v[152:155], v[32:35]
    v_mfma_f32_16x16x32_bf16 v[48:51], v[116:119], v[152:155], v[48:51]
    v_mfma_f32_16x16x32_bf16 v[64:67], v[120:123], v[152:155], v[64:67]
    v_mfma_f32_16x16x32_bf16 v[80:83], v[124:127], v[152:155], v[80:83]
    v_mfma_f32_16x16x32_bf16 v[96:99], v[128:131], v[152:155], v[96:99]
    ds_read_b64_tr_b16 v[152:153], v8 offset:4096
    ds_read_b64_tr_b16 v[154:155], v8 offset:6144
    s_waitcnt lgkmcnt(2)
    v_mfma_f32_16x16x32_bf16 v[36:39], v[112:115], v[156:159], v[36:39]
    v_mfma_f32_16x16x32_bf16 v[52:55], v[116:119], v[156:159], v[52:55]
    v_mfma_f32_16x16x32_bf16 v[68:71], v[120:123], v[156:159], v[68:71]
    v_mfma_f32_16x16x32_bf16 v[84:87], v[124:127], v[156:159], v[84:87]
    v_mfma_f32_16x16x32_bf16 v[100:103], v[128:131], v[156:159], v[100:103]
    ds_read_b64_tr_b16 v[156:157], v9 offset:4096
    ds_read_b64_tr_b16 v[158:159], v9 offset:6144
    s_add_u32 m0, s58, 0
    s_waitcnt vmcnt(8)
    buffer_load_dwordx4 v248, s[40:43], s61 offen offset:0 lds
    s_waitcnt vmcnt(8)
    buffer_load_dwordx4 v249, s[40:43], s61 offen offset:1024 lds
    s_waitcnt lgkmcnt(6)
    v_mfma_f32_16x16x32_bf16 v[40:43], v[112:115], v[160:163], v[40:43]
    v_mfma_f32_16x16x32_bf16 v[56:59], v[116:119], v[160:163], v[56:59]
    v_mfma_f32_16x16x32_bf16 v[72:75], v[120:123], v[160:163], v[72:75]
    v_mfma_f32_16x16x32_bf16 v[88:91], v[124:127], v[160:163], v[88:91]
    v_mfma_f32_16x16x32_bf16 v[104:107], v[128:131], v[160:163], v[104:107]
    ds_read_b64_tr_b16 v[160:161], v10 offset:4096
    ds_read_b64_tr_b16 v[162:163], v10 offset:6144
    s_waitcnt vmcnt(8)
    buffer_load_dwordx4 v250, s[40:43], s61 offen offset:2048 lds
    s_waitcnt vmcnt(8)
    buffer_load_dwordx4 v251, s[40:43], s61 offen offset:3072 lds
    s_add_u32 s61, s61, 131072
    s_waitcnt lgkmcnt(6)
    v_mfma_f32_16x16x32_bf16 v[44:47], v[112:115], v[164:167], v[44:47]
    v_mfma_f32_16x16x32_bf16 v[60:63], v[116:119], v[164:167], v[60:63]
    v_mfma_f32_16x16x32_bf16 v[76:79], v[120:123], v[164:167], v[76:79]
    v_mfma_f32_16x16x32_bf16 v[92:95], v[124:127], v[164:167], v[92:95]
    v_mfma_f32_16x16x32_bf16 v[108:111], v[128:131], v[164:167], v[108:111]
    ds_read_b64_tr_b16 v[164:165], v11 offset:4096
    ds_read_b64_tr_b16 v[166:167], v11 offset:6144
    s_waitcnt vmcnt(8)
    buffer_load_dwordx4 v[112:115], v1, s[36:39], s60 offen offset:0 sc1
    s_waitcnt vmcnt(8)
    buffer_load_dwordx4 v[116:119], v1, s[36:39], s60 offen offset:1024 sc1
    s_waitcnt vmcnt(8)
    buffer_load_dwordx4 v[120:123], v1, s[36:39], s60 offen offset:2048 sc1
    s_waitcnt vmcnt(8)
    buffer_load_dwordx4 v[124:127], v1, s[36:39], s60 offen offset:3072 sc1
    s_waitcnt vmcnt(8)
    buffer_load_dwordx4 v[128:131], v12, s[36:39], s60 offen sc1
    s_add_u32 s60, s60, 40960
    s_waitcnt vmcnt(9) lgkmcnt(6)
    v_mfma_f32_16x16x32_bf16 v[32:35], v[132:135], v[152:155], v[32:35]
    v_mfma_f32_16x16x32_bf16 v[48:51], v[136:139], v[152:155], v[48:51]
    v_mfma_f32_16x16x32_bf16 v[64:67], v[140:143], v[152:155], v[64:67]
    v_mfma_f32_16x16x32_bf16 v[80:83], v[144:147], v[152:155], v[80:83]
    v_mfma_f32_16x16x32_bf16 v[96:99], v[148:151], v[152:155], v[96:99]
    ds_read_b64_tr_b16 v[152:153], v8 offset:8192
    ds_read_b64_tr_b16 v[154:155], v8 offset:10240
    s_waitcnt lgkmcnt(2)
    v_mfma_f32_16x16x32_bf16 v[36:39], v[132:135], v[156:159], v[36:39]
    v_mfma_f32_16x16x32_bf16 v[52:55], v[136:139], v[156:159], v[52:55]
    v_mfma_f32_16x16x32_bf16 v[68:71], v[140:143], v[156:159], v[68:71]
    v_mfma_f32_16x16x32_bf16 v[84:87], v[144:147], v[156:159], v[84:87]
    v_mfma_f32_16x16x32_bf16 v[100:103], v[148:151], v[156:159], v[100:103]
    ds_read_b64_tr_b16 v[156:157], v9 offset:8192
    ds_read_b64_tr_b16 v[158:159], v9 offset:10240
    s_add_u32 m0, s58, 4096
    s_waitcnt vmcnt(8)
    buffer_load_dwordx4 v248, s[40:43], s61 offen offset:0 lds
    s_waitcnt vmcnt(8)
    buffer_load_dwordx4 v249, s[40:43], s61 offen offset:1024 lds
    s_waitcnt lgkmcnt(6)
    v_mfma_f32_16x16x32_bf16 v[40:43], v[132:135], v[160:163], v[40:43]
    v_mfma_f32_16x16x32_bf16 v[56:59], v[136:139], v[160:163], v[56:59]
    v_mfma_f32_16x16x32_bf16 v[72:75], v[140:143], v[160:163], v[72:75]
    v_mfma_f32_16x16x32_bf16 v[88:91], v[144:147], v[160:163], v[88:91]
    v_mfma_f32_16x16x32_bf16 v[104:107], v[148:151], v[160:163], v[104:107]
    ds_read_b64_tr_b16 v[160:161], v10 offset:8192
    ds_read_b64_tr_b16 v[162:163], v10 offset:10240
    s_waitcnt vmcnt(8)
    buffer_load_dwordx4 v250, s[40:43], s61 offen offset:2048 lds
    s_waitcnt vmcnt(8)
    buffer_load_dwordx4 v251, s[40:43], s61 offen offset:3072 lds
    s_add_u32 s61, s61, 131072
    s_waitcnt lgkmcnt(6)
    v_mfma_f32_16x16x32_bf16 v[44:47], v[132:135], v[164:167], v[44:47]
    v_mfma_f32_16x16x32_bf16 v[60:63], v[136:139], v[164:167], v[60:63]
    v_mfma_f32_16x16x32_bf16 v[76:79], v[140:143], v[164:167], v[76:79]
    v_mfma_f32_16x16x32_bf16 v[92:95], v[144:147], v[164:167], v[92:95]
    v_mfma_f32_16x16x32_bf16 v[108:111], v[148:151], v[164:167], v[108:111]
    ds_read_b64_tr_b16 v[164:165], v11 offset:8192
    ds_read_b64_tr_b16 v[166:167], v11 offset:10240
    s_waitcnt vmcnt(8)
    buffer_load_dwordx4 v[132:135], v1, s[36:39], s60 offen offset:0 sc1
    s_waitcnt vmcnt(8)
    buffer_load_dwordx4 v[136:139], v1, s[36:39], s60 offen offset:1024 sc1
    s_waitcnt vmcnt(8)
    buffer_load_dwordx4 v[140:143], v1, s[36:39], s60 offen offset:2048 sc1
    s_waitcnt vmcnt(8)
    buffer_load_dwordx4 v[144:147], v1, s[36:39], s60 offen offset:3072 sc1
    s_waitcnt vmcnt(8)
    buffer_load_dwordx4 v[148:151], v12, s[36:39], s60 offen sc1
    s_add_u32 s60, s60, 40960
    s_waitcnt vmcnt(9) lgkmcnt(6)
    v_mfma_f32_16x16x32_bf16 v[32:35], v[112:115], v[152:155], v[32:35]
    v_mfma_f32_16x16x32_bf16 v[48:51], v[116:119], v[152:155], v[48:51]
    v_mfma_f32_16x16x32_bf16 v[64:67], v[120:123], v[152:155], v[64:67]
    v_mfma_f32_16x16x32_bf16 v[80:83], v[124:127], v[152:155], v[80:83]
    v_mfma_f32_16x16x32_bf16 v[96:99], v[128:131], v[152:155], v[96:99]
    ds_read_b64_tr_b16 v[152:153], v8 offset:12288
    ds_read_b64_tr_b16 v[154:155], v8 offset:14336
    s_waitcnt lgkmcnt(6)
    v_mfma_f32_16x16x32_bf16 v[36:39], v[112:115], v[156:159], v[36:39]
    v_mfma_f32_16x16x32_bf16 v[52:55], v[116:119], v[156:159], v[52:55]
    v_mfma_f32_16x16x32_bf16 v[68:71], v[120:123], v[156:159], v[68:71]
    v_mfma_f32_16x16x32_bf16 v[84:87], v[124:127], v[156:159], v[84:87]
    v_mfma_f32_16x16x32_bf16 v[100:103], v[128:131], v[156:159], v[100:103]
    ds_read_b64_tr_b16 v[156:157], v9 offset:12288
    ds_read_b64_tr_b16 v[158:159], v9 offset:14336
    s_waitcnt lgkmcnt(6)
    v_mfma_f32_16x16x32_bf16 v[40:43], v[112:115], v[160:163], v[40:43]
    v_mfma_f32_16x16x32_bf16 v[56:59], v[116:119], v[160:163], v[56:59]
    v_mfma_f32_16x16x32_bf16 v[72:75], v[120:123], v[160:163], v[72:75]
    v_mfma_f32_16x16x32_bf16 v[88:91], v[124:127], v[160:163], v[88:91]
    v_mfma_f32_16x16x32_bf16 v[104:107], v[128:131], v[160:163], v[104:107]
    ds_read_b64_tr_b16 v[160:161], v10 offset:12288
    ds_read_b64_tr_b16 v[162:163], v10 offset:14336
    s_waitcnt lgkmcnt(6)
    v_mfma_f32_16x16x32_bf16 v[44:47], v[112:115], v[164:167], v[44:47]
    v_mfma_f32_16x16x32_bf16 v[60:63], v[116:119], v[164:167], v[60:63]
    v_mfma_f32_16x16x32_bf16 v[76:79], v[120:123], v[164:167], v[76:79]
    v_mfma_f32_16x16x32_bf16 v[92:95], v[124:127], v[164:167], v[92:95]
    v_mfma_f32_16x16x32_bf16 v[108:111], v[128:131], v[164:167], v[108:111]
    ds_read_b64_tr_b16 v[164:165], v11 offset:12288
    ds_read_b64_tr_b16 v[166:167], v11 offset:14336
    s_waitcnt vmcnt(8)
    buffer_load_dwordx4 v[112:115], v1, s[36:39], s60 offen offset:0 sc1
    s_waitcnt vmcnt(8)
    buffer_load_dwordx4 v[116:119], v1, s[36:39], s60 offen offset:1024 sc1
    s_waitcnt vmcnt(8)
    buffer_load_dwordx4 v[120:123], v1, s[36:39], s60 offen offset:2048 sc1
    s_waitcnt vmcnt(8)
    buffer_load_dwordx4 v[124:127], v1, s[36:39], s60 offen offset:3072 sc1
    s_waitcnt vmcnt(8)
    buffer_load_dwordx4 v[128:131], v12, s[36:39], s60 offen sc1
    s_add_u32 s60, s60, 40960
    s_waitcnt vmcnt(5) lgkmcnt(6)
    v_mfma_f32_16x16x32_bf16 v[32:35], v[132:135], v[152:155], v[32:35]
    v_mfma_f32_16x16x32_bf16 v[48:51], v[136:139], v[152:155], v[48:51]
    v_mfma_f32_16x16x32_bf16 v[64:67], v[140:143], v[152:155], v[64:67]
    v_mfma_f32_16x16x32_bf16 v[80:83], v[144:147], v[152:155], v[80:83]
    v_mfma_f32_16x16x32_bf16 v[96:99], v[148:151], v[152:155], v[96:99]
    ds_read_b64_tr_b16 v[152:153], v8 offset:0
    ds_read_b64_tr_b16 v[154:155], v8 offset:2048
    s_waitcnt lgkmcnt(6)
    v_mfma_f32_16x16x32_bf16 v[36:39], v[132:135], v[156:159], v[36:39]
    v_mfma_f32_16x16x32_bf16 v[52:55], v[136:139], v[156:159], v[52:55]
    v_mfma_f32_16x16x32_bf16 v[68:71], v[140:143], v[156:159], v[68:71]
    v_mfma_f32_16x16x32_bf16 v[84:87], v[144:147], v[156:159], v[84:87]
    v_mfma_f32_16x16x32_bf16 v[100:103], v[148:151], v[156:159], v[100:103]
    ds_read_b64_tr_b16 v[156:157], v9 offset:0
    ds_read_b64_tr_b16 v[158:159], v9 offset:2048
    s_waitcnt lgkmcnt(6)
    v_mfma_f32_16x16x32_bf16 v[40:43], v[132:135], v[160:163], v[40:43]
    v_mfma_f32_16x16x32_bf16 v[56:59], v[136:139], v[160:163], v[56:59]
    v_mfma_f32_16x16x32_bf16 v[72:75], v[140:143], v[160:163], v[72:75]
    v_mfma_f32_16x16x32_bf16 v[88:91], v[144:147], v[160:163], v[88:91]
    v_mfma_f32_16x16x32_bf16 v[104:107], v[148:151], v[160:163], v[104:107]
    ds_read_b64_tr_b16 v[160:161], v10 offset:0
    ds_read_b64_tr_b16 v[162:163], v10 offset:2048
    s_waitcnt lgkmcnt(6)
    v_mfma_f32_16x16x32_bf16 v[44:47], v[132:135], v[164:167], v[44:47]
    v_mfma_f32_16x16x32_bf16 v[60:63], v[136:139], v[164:167], v[60:63]
    v_mfma_f32_16x16x32_bf16 v[76:79], v[140:143], v[164:167], v[76:79]
    v_mfma_f32_16x16x32_bf16 v[92:95], v[144:147], v[164:167], v[92:95]
    v_mfma_f32_16x16x32_bf16 v[108:111], v[148:151], v[164:167], v[108:111]
    ds_read_b64_tr_b16 v[164:165], v11 offset:0
    ds_read_b64_tr_b16 v[166:167], v11 offset:2048
    s_waitcnt vmcnt(8)
    buffer_load_dwordx4 v[132:135], v1, s[36:39], s60 offen offset:0 sc1
    s_waitcnt vmcnt(8)
    buffer_load_dwordx4 v[136:139], v1, s[36:39], s60 offen offset:1024 sc1
    s_waitcnt vmcnt(8)
    buffer_load_dwordx4 v[140:143], v1, s[36:39], s60 offen offset:2048 sc1
    s_waitcnt vmcnt(8)
    buffer_load_dwordx4 v[144:147], v1, s[36:39], s60 offen offset:3072 sc1
    s_waitcnt vmcnt(8)
    buffer_load_dwordx4 v[148:151], v12, s[36:39], s60 offen sc1
    s_add_u32 s60, s60, 40960
    s_waitcnt vmcnt(5)
    s_mov_b64 exec, 0x11
    v_mov_b32 v15, 0
    buffer_atomic_or v15, v13, s[32:35], s54 offen sc0 sc1
    s_mov_b64 exec, -1
    s_waitcnt vmcnt(63) lgkmcnt(6)
    v_mfma_f32_16x16x32_bf16 v[32:35], v[112:115], v[152:155], v[32:35]
    v_mfma_f32_16x16x32_bf16 v[48:51], v[116:119], v[152:155], v[48:51]
    v_mfma_f32_16x16x32_bf16 v[64:67], v[120:123], v[152:155], v[64:67]
    v_mfma_f32_16x16x32_bf16 v[80:83], v[124:127], v[152:155], v[80:83]
    v_mfma_f32_16x16x32_bf16 v[96:99], v[128:131], v[152:155], v[96:99]
    ds_read_b64_tr_b16 v[152:153], v8 offset:4096
    ds_read_b64_tr_b16 v[154:155], v8 offset:6144
    s_waitcnt lgkmcnt(6)
    v_mfma_f32_16x16x32_bf16 v[36:39], v[112:115], v[156:159], v[36:39]
    v_mfma_f32_16x16x32_bf16 v[52:55], v[116:119], v[156:159], v[52:55]
    v_mfma_f32_16x16x32_bf16 v[68:71], v[120:123], v[156:159], v[68:71]
    v_mfma_f32_16x16x32_bf16 v[84:87], v[124:127], v[156:159], v[84:87]
    v_mfma_f32_16x16x32_bf16 v[100:103], v[128:131], v[156:159], v[100:103]
    ds_read_b64_tr_b16 v[156:157], v9 offset:4096
    ds_read_b64_tr_b16 v[158:159], v9 offset:6144
    s_waitcnt lgkmcnt(6)
    v_mfma_f32_16x16x32_bf16 v[40:43], v[112:115], v[160:163], v[40:43]
    v_mfma_f32_16x16x32_bf16 v[56:59], v[116:119], v[160:163], v[56:59]
    v_mfma_f32_16x16x32_bf16 v[72:75], v[120:123], v[160:163], v[72:75]
    v_mfma_f32_16x16x32_bf16 v[88:91], v[124:127], v[160:163], v[88:91]
    v_mfma_f32_16x16x32_bf16 v[104:107], v[128:131], v[160:163], v[104:107]
    ds_read_b64_tr_b16 v[160:161], v10 offset:4096
    ds_read_b64_tr_b16 v[162:163], v10 offset:6144
    s_waitcnt lgkmcnt(6)
    s_waitcnt vmcnt(0)
    v_cmp_ne_u32 vcc, s52, v15
    s_and_b32 s55, vcc_lo, 0x11
    s_cbranch_scc0 L_oready
    s_mov_b64 exec, 0x11
L_pl_41:
    v_mov_b32 v15, 0
    buffer_atomic_or v15, v13, s[32:35], s54 offen sc0 sc1
    s_add_u32 s97, s97, 16
    s_waitcnt vmcnt(0)
    v_cmp_ne_u32 vcc, s52, v15
    s_cbranch_vccz L_pd_42
    s_mov_b64 exec, vcc
    s_sleep 1
    s_cmp_lt_u32 s97, 1048576
    s_cbranch_scc1 L_pl_41
L_pd_42:
    s_mov_b64 exec, -1
L_oready:
    s_add_u32 s55, s98, 0
    buffer_load_dwordx4 v[16:19], v1, s[32:35], s55 offen sc1
    s_add_u32 s55, s99, 0
    buffer_load_dwordx4 v[20:23], v1, s[32:35], s55 offen sc1
    s_add_u32 s55, s100, 0
    buffer_load_dwordx4 v[24:27], v1, s[32:35], s55 offen sc1
    s_add_u32 s55, s101, 0
    buffer_load_dwordx4 v[28:31], v1, s[32:35], s55 offen sc1
    v_mfma_f32_16x16x32_bf16 v[44:47], v[112:115], v[164:167], v[44:47]
    v_mfma_f32_16x16x32_bf16 v[60:63], v[116:119], v[164:167], v[60:63]
    v_mfma_f32_16x16x32_bf16 v[76:79], v[120:123], v[164:167], v[76:79]
    v_mfma_f32_16x16x32_bf16 v[92:95], v[124:127], v[164:167], v[92:95]
    v_mfma_f32_16x16x32_bf16 v[108:111], v[128:131], v[164:167], v[108:111]
    ds_read_b64_tr_b16 v[164:165], v11 offset:4096
    ds_read_b64_tr_b16 v[166:167], v11 offset:6144
    s_add_u32 s55, s98, 4096
    buffer_load_dwordx4 v[112:115], v1, s[32:35], s55 offen sc1
    s_add_u32 s55, s99, 4096
    buffer_load_dwordx4 v[116:119], v1, s[32:35], s55 offen sc1
    s_add_u32 s55, s100, 4096
    buffer_load_dwordx4 v[120:123], v1, s[32:35], s55 offen sc1
    s_add_u32 s55, s101, 4096
    buffer_load_dwordx4 v[124:127], v1, s[32:35], s55 offen sc1
    s_add_u32 s55, s98, 16384
    buffer_load_dwordx2 v[248:249], v7, s[32:35], s55 offen offset:0 sc1
    buffer_load_dwordx2 v[250:251], v7, s[32:35], s55 offen offset:512 sc1
    s_add_u32 s55, s99, 16384
    buffer_load_dwordx2 v[8:9], v7, s[32:35], s55 offen offset:0 sc1
    buffer_load_dwordx2 v[10:11], v7, s[32:35], s55 offen offset:512 sc1
    s_add_u32 s55, s100, 16384
    buffer_load_dwordx2 v[128:129], v7, s[32:35], s55 offen offset:0 sc1
    buffer_load_dwordx2 v[130:131], v7, s[32:35], s55 offen offset:512 sc1
    s_waitcnt vmcnt(63) lgkmcnt(6)
    v_mfma_f32_16x16x32_bf16 v[32:35], v[132:135], v[152:155], v[32:35]
    v_mfma_f32_16x16x32_bf16 v[48:51], v[136:139], v[152:155], v[48:51]
    v_mfma_f32_16x16x32_bf16 v[64:67], v[140:143], v[152:155], v[64:67]
    v_mfma_f32_16x16x32_bf16 v[80:83], v[144:147], v[152:155], v[80:83]
    v_mfma_f32_16x16x32_bf16 v[96:99], v[148:151], v[152:155], v[96:99]
    s_add_u32 s55, s98, 8192
    buffer_load_dwordx4 v[152:155], v1, s[32:35], s55 offen sc1
    s_waitcnt lgkmcnt(4)
    v_mfma_f32_16x16x32_bf16 v[36:39], v[132:135], v[156:159], v[36:39]
    v_mfma_f32_16x16x32_bf16 v[52:55], v[136:139], v[156:159], v[52:55]
    v_mfma_f32_16x16x32_bf16 v[68:71], v[140:143], v[156:159], v[68:71]
    v_mfma_f32_16x16x32_bf16 v[84:87], v[144:147], v[156:159], v[84:87]
    v_mfma_f32_16x16x32_bf16 v[100:103], v[148:151], v[156:159], v[100:103]
    s_add_u32 s55, s99, 8192
    buffer_load_dwordx4 v[156:159], v1, s[32:35], s55 offen sc1
    s_waitcnt lgkmcnt(2)
    v_mfma_f32_16x16x32_bf16 v[40:43], v[132:135], v[160:163], v[40:43]
    v_mfma_f32_16x16x32_bf16 v[56:59], v[136:139], v[160:163], v[56:59]
    v_mfma_f32_16x16x32_bf16 v[72:75], v[140:143], v[160:163], v[72:75]
    v_mfma_f32_16x16x32_bf16 v[88:91], v[144:147], v[160:163], v[88:91]
    v_mfma_f32_16x16x32_bf16 v[104:107], v[148:151], v[160:163], v[104:107]
    s_add_u32 s55, s100, 8192
    buffer_load_dwordx4 v[160:163], v1, s[32:35], s55 offen sc1
    s_waitcnt lgkmcnt(0)
    v_mfma_f32_16x16x32_bf16 v[44:47], v[132:135], v[164:167], v[44:47]
    s_add_u32 s55, s98, 12288
    buffer_load_dwordx4 v[132:135], v1, s[32:35], s55 offen sc1
    v_mfma_f32_16x16x32_bf16 v[60:63], v[136:139], v[164:167], v[60:63]
    s_add_u32 s55, s99, 12288
    buffer_load_dwordx4 v[136:139], v1, s[32:35], s55 offen sc1
    v_mfma_f32_16x16x32_bf16 v[76:79], v[140:143], v[164:167], v[76:79]
    s_add_u32 s55, s100, 12288
    buffer_load_dwordx4 v[140:143], v1, s[32:35], s55 offen sc1
    v_mfma_f32_16x16x32_bf16 v[92:95], v[144:147], v[164:167], v[92:95]
    s_add_u32 s55, s101, 12288
    buffer_load_dwordx4 v[144:147], v1, s[32:35], s55 offen sc1
    v_mfma_f32_16x16x32_bf16 v[108:111], v[148:151], v[164:167], v[108:111]
    s_add_u32 s55, s101, 8192
    buffer_load_dwordx4 v[164:167], v1, s[32:35], s55 offen sc1
    s_add_u32 s55, s101, 16384
    buffer_load_dwordx2 v[148:149], v7, s[32:35], s55 offen offset:0 sc1
    buffer_load_dwordx2 v[150:151], v7, s[32:35], s55 offen offset:512 sc1
    s_mov_b64 s[36:37], s[26:27]
    s_mov_b32 s38, 2621440
    s_waitcnt vmcnt(20)
    v_mfma_f32_16x16x32_bf16 v[32:35], v[168:171], v[16:19], v[32:35]
    v_mfma_f32_16x16x32_bf16 v[48:51], v[172:175], v[16:19], v[48:51]
    v_mfma_f32_16x16x32_bf16 v[64:67], v[176:179], v[16:19], v[64:67]
    v_mfma_f32_16x16x32_bf16 v[80:83], v[180:183], v[16:19], v[80:83]
    v_mfma_f32_16x16x32_bf16 v[96:99], v[184:187], v[16:19], v[96:99]
    v_mfma_f32_16x16x32_bf16 v[36:39], v[168:171], v[20:23], v[36:39]
    v_mfma_f32_16x16x32_bf16 v[52:55], v[172:175], v[20:23], v[52:55]
    v_mfma_f32_16x16x32_bf16 v[68:71], v[176:179], v[20:23], v[68:71]
    v_mfma_f32_16x16x32_bf16 v[84:87], v[180:183], v[20:23], v[84:87]
    v_mfma_f32_16x16x32_bf16 v[100:103], v[184:187], v[20:23], v[100:103]
    v_mfma_f32_16x16x32_bf16 v[40:43], v[168:171], v[24:27], v[40:43]
    v_mfma_f32_16x16x32_bf16 v[56:59], v[172:175], v[24:27], v[56:59]
    v_mfma_f32_16x16x32_bf16 v[72:75], v[176:179], v[24:27], v[72:75]
    v_mfma_f32_16x16x32_bf16 v[88:91], v[180:183], v[24:27], v[88:91]
    v_mfma_f32_16x16x32_bf16 v[104:107], v[184:187], v[24:27], v[104:107]
    v_mfma_f32_16x16x32_bf16 v[44:47], v[168:171], v[28:31], v[44:47]
    v_mfma_f32_16x16x32_bf16 v[60:63], v[172:175], v[28:31], v[60:63]
    v_mfma_f32_16x16x32_bf16 v[76:79], v[176:179], v[28:31], v[76:79]
    v_mfma_f32_16x16x32_bf16 v[92:95], v[180:183], v[28:31], v[92:95]
    v_mfma_f32_16x16x32_bf16 v[108:111], v[184:187], v[28:31], v[108:111]
    ds_read_b128 v[168:171], v2 offset:16384
    ds_read_b128 v[172:175], v2 offset:17408
    ds_read_b128 v[176:179], v2 offset:18432
    ds_read_b128 v[180:183], v2 offset:19456
    ds_read_b128 v[184:187], v2 offset:20480
    s_waitcnt vmcnt(16)
    v_mfma_f32_16x16x32_bf16 v[32:35], v[188:191], v[112:115], v[32:35]
    v_mul_u32_u24 v18, 160, v4
    v_mfma_f32_16x16x32_bf16 v[48:51], v[192:195], v[112:115], v[48:51]
    v_lshl_add_u32 v18, v3, 3, v18
    v_mfma_f32_16x16x32_bf16 v[64:67], v[196:199], v[112:115], v[64:67]
    v_add_u32 v18, s58, v18
    v_mfma_f32_16x16x32_bf16 v[80:83], v[200:203], v[112:115], v[80:83]
    s_lshl_b32 s56, s48, 6
    v_mfma_f32_16x16x32_bf16 v[96:99], v[204:207], v[112:115], v[96:99]
    s_add_u32 s56, s56, 163456
    v_mfma_f32_16x16x32_bf16 v[36:39], v[188:191], v[116:119], v[36:39]
    v_lshl_add_u32 v20, v4, 2, s56
    v_mfma_f32_16x16x32_bf16 v[52:55], v[192:195], v[116:119], v[52:55]
    v_lshlrev_b32 v253, 16, v253
    v_mfma_f32_16x16x32_bf16 v[68:71], v[196:199], v[116:119], v[68:71]
    v_mov_b32 v12, 0
    v_mfma_f32_16x16x32_bf16 v[84:87], v[200:203], v[116:119], v[84:87]
    v_writelane_b32 v12, 1, 0
    v_mfma_f32_16x16x32_bf16 v[100:103], v[204:207], v[116:119], v[100:103]
    s_lshl_b32 s54, s50, 2
    v_mfma_f32_16x16x32_bf16 v[40:43], v[188:191], v[120:123], v[40:43]
    s_add_u32 s54, s54, s48
    v_mfma_f32_16x16x32_bf16 v[56:59], v[192:195], v[120:123], v[56:59]
    s_mul_i32 s54, s54, 20480
    v_mfma_f32_16x16x32_bf16 v[72:75], v[196:199], v[120:123], v[72:75]
    s_mul_i32 s55, s49, 160
    v_mfma_f32_16x16x32_bf16 v[88:91], v[200:203], v[120:123], v[88:91]
    s_add_u32 s54, s54, s55
    v_mfma_f32_16x16x32_bf16 v[104:107], v[204:207], v[120:123], v[104:107]
    v_mfma_f32_16x16x32_bf16 v[44:47], v[188:191], v[124:127], v[44:47]
    v_mfma_f32_16x16x32_bf16 v[60:63], v[192:195], v[124:127], v[60:63]
    v_mfma_f32_16x16x32_bf16 v[76:79], v[196:199], v[124:127], v[76:79]
    v_mfma_f32_16x16x32_bf16 v[92:95], v[200:203], v[124:127], v[92:95]
    v_mfma_f32_16x16x32_bf16 v[108:111], v[204:207], v[124:127], v[108:111]
    s_waitcnt vmcnt(3)
    v_mfma_f32_16x16x32_bf16 v[32:35], v[228:231], v[132:135], v[32:35]
    v_add_u32 v22, 0, v0
    v_mfma_f32_16x16x32_bf16 v[48:51], v[232:235], v[132:135], v[48:51]
    v_mul_u32_u24 v21, 6554, v22
    v_mfma_f32_16x16x32_bf16 v[64:67], v[236:239], v[132:135], v[64:67]
    v_lshrrev_b32 v21, 16, v21
    v_mfma_f32_16x16x32_bf16 v[80:83], v[240:243], v[132:135], v[80:83]
    v_mul_u32_u24 v21, 1120, v21
    v_mfma_f32_16x16x32_bf16 v[96:99], v[244:247], v[132:135], v[96:99]
    v_lshl_add_u32 v22, v22, 4, v21
    v_mfma_f32_16x16x32_bf16 v[36:39], v[228:231], v[136:139], v[36:39]
    v_add_u32 v23, 64, v0
    v_mfma_f32_16x16x32_bf16 v[52:55], v[232:235], v[136:139], v[52:55]
    v_mul_u32_u24 v21, 6554, v23
    v_mfma_f32_16x16x32_bf16 v[68:71], v[236:239], v[136:139], v[68:71]
    v_lshrrev_b32_e64 v21, 16, v21
    v_mfma_f32_16x16x32_bf16 v[84:87], v[240:243], v[136:139], v[84:87]
    v_mul_u32_u24 v21, 1120, v21
    v_mfma_f32_16x16x32_bf16 v[100:103], v[244:247], v[136:139], v[100:103]
    v_lshl_add_u32 v23, v23, 4, v21
    v_mfma_f32_16x16x32_bf16 v[40:43], v[228:231], v[140:143], v[40:43]
    v_add_u32 v24, 128, v0
    v_mfma_f32_16x16x32_bf16 v[56:59], v[232:235], v[140:143], v[56:59]
    v_mul_u32_u24 v21, 6554, v24
    v_mfma_f32_16x16x32_bf16 v[72:75], v[236:239], v[140:143], v[72:75]
    v_lshrrev_b32_e64 v21, 16, v21
    v_mfma_f32_16x16x32_bf16 v[88:91], v[240:243], v[140:143], v[88:91]
    v_mul_u32_u24 v21, 1120, v21
    v_mfma_f32_16x16x32_bf16 v[104:107], v[244:247], v[140:143], v[104:107]
    v_lshl_add_u32 v24, v24, 4, v21
    v_mfma_f32_16x16x32_bf16 v[44:47], v[228:231], v[144:147], v[44:47]
    v_mfma_f32_16x16x32_bf16 v[60:63], v[232:235], v[144:147], v[60:63]
    v_mfma_f32_16x16x32_bf16 v[76:79], v[236:239], v[144:147], v[76:79]
    v_mfma_f32_16x16x32_bf16 v[92:95], v[240:243], v[144:147], v[92:95]
    v_mfma_f32_16x16x32_bf16 v[108:111], v[244:247], v[144:147], v[108:111]
    s_waitcnt vmcnt(2)
    s_nop 0
    v_mfma_f32_16x16x32_bf16 v[32:35], v[208:211], v[152:155], v[32:35]
    v_mfma_f32_16x16x32_bf16 v[48:51], v[212:215], v[152:155], v[48:51]
    v_mfma_f32_16x16x32_bf16 v[64:67], v[216:219], v[152:155], v[64:67]
    v_mfma_f32_16x16x32_bf16 v[80:83], v[220:223], v[152:155], v[80:83]
    v_mfma_f32_16x16x32_bf16 v[96:99], v[224:227], v[152:155], v[96:99]
    v_mfma_f32_16x16x32_bf16 v[36:39], v[208:211], v[156:159], v[36:39]
    v_mfma_f32_16x16x32_bf16 v[52:55], v[212:215], v[156:159], v[52:55]
    v_mfma_f32_16x16x32_bf16 v[68:71], v[216:219], v[156:159], v[68:71]
    v_mfma_f32_16x16x32_bf16 v[84:87], v[220:223], v[156:159], v[84:87]
    v_mfma_f32_16x16x32_bf16 v[100:103], v[224:227], v[156:159], v[100:103]
    v_mfma_f32_16x16x32_bf16 v[40:43], v[208:211], v[160:163], v[40:43]
    v_mfma_f32_16x16x32_bf16 v[56:59], v[212:215], v[160:163], v[56:59]
    v_mfma_f32_16x16x32_bf16 v[72:75], v[216:219], v[160:163], v[72:75]
    v_mfma_f32_16x16x32_bf16 v[88:91], v[220:223], v[160:163], v[88:91]
    v_mfma_f32_16x16x32_bf16 v[104:107], v[224:227], v[160:163], v[104:107]
    v_mfma_f32_16x16x32_bf16 v[44:47], v[208:211], v[164:167], v[44:47]
    v_mfma_f32_16x16x32_bf16 v[60:63], v[212:215], v[164:167], v[60:63]
    v_mfma_f32_16x16x32_bf16 v[76:79], v[216:219], v[164:167], v[76:79]
    v_mfma_f32_16x16x32_bf16 v[92:95], v[220:223], v[164:167], v[92:95]
    v_mfma_f32_16x16x32_bf16 v[108:111], v[224:227], v[164:167], v[108:111]
    s_waitcnt vmcnt(0) lgkmcnt(0)
    s_nop 0
    v_mfma_f32_16x16x32_bf16 v[32:35], v[168:171], v[248:251], v[32:35]
    v_mfma_f32_16x16x32_bf16 v[48:51], v[172:175], v[248:251], v[48:51]
    v_mfma_f32_16x16x32_bf16 v[64:67], v[176:179], v[248:251], v[64:67]
    v_mfma_f32_16x16x32_bf16 v[80:83], v[180:183], v[248:251], v[80:83]
    v_mfma_f32_16x16x32_bf16 v[96:99], v[184:187], v[248:251], v[96:99]
    v_mfma_f32_16x16x32_bf16 v[36:39], v[168:171], v[8:11], v[36:39]
    v_mfma_f32_16x16x32_bf16 v[52:55], v[172:175], v[8:11], v[52:55]
    v_mfma_f32_16x16x32_bf16 v[68:71], v[176:179], v[8:11], v[68:71]
    v_mfma_f32_16x16x32_bf16 v[84:87], v[180:183], v[8:11], v[84:87]
    ds_write_b128 v2, v[32:35] offset:0
    v_mfma_f32_16x16x32_bf16 v[100:103], v[184:187], v[8:11], v[100:103]
    ds_write_b128 v2, v[48:51] offset:1024
    v_mfma_f32_16x16x32_bf16 v[40:43], v[168:171], v[128:131], v[40:43]
    ds_write_b128 v2, v[64:67] offset:2048
    v_mfma_f32_16x16x32_bf16 v[56:59], v[172:175], v[128:131], v[56:59]
    ds_write_b128 v2, v[80:83] offset:3072
    v_mfma_f32_16x16x32_bf16 v[72:75], v[176:179], v[128:131], v[72:75]
    ds_write_b128 v2, v[96:99] offset:4096
    v_mfma_f32_16x16x32_bf16 v[88:91], v[180:183], v[128:131], v[88:91]
    ds_write_b128 v2, v[36:39] offset:5120
    v_mfma_f32_16x16x32_bf16 v[104:107], v[184:187], v[128:131], v[104:107]
    ds_write_b128 v2, v[52:55] offset:6144
    v_mfma_f32_16x16x32_bf16 v[44:47], v[168:171], v[148:151], v[44:47]
    ds_write_b128 v2, v[68:71] offset:7168
    v_mfma_f32_16x16x32_bf16 v[60:63], v[172:175], v[148:151], v[60:63]
    ds_write_b128 v2, v[84:87] offset:8192
    v_mfma_f32_16x16x32_bf16 v[76:79], v[176:179], v[148:151], v[76:79]
    ds_write_b128 v2, v[100:103] offset:9216
    v_mfma_f32_16x16x32_bf16 v[92:95], v[180:183], v[148:151], v[92:95]
    ds_write_b128 v2, v[40:43] offset:10240
    v_mfma_f32_16x16x32_bf16 v[108:111], v[184:187], v[148:151], v[108:111]
    ds_write_b128 v2, v[56:59] offset:11264
    ds_write_b128 v2, v[72:75] offset:12288
    ds_write_b128 v2, v[88:91] offset:13312
    ds_write_b128 v2, v[104:107] offset:14336
    ds_add_u32 v255, v12 offset:64
L_wc_43:
    ds_read_b32 v15, v255 offset:64
    s_waitcnt lgkmcnt(0)
    v_readfirstlane_b32 s96, v15
    s_cmp_ge_u32 s96, 4
    s_cbranch_scc1 L_wd_44
    s_add_u32 s97, s97, 1
    s_cmp_lt_u32 s97, 1048576
    s_cbranch_scc1 L_wc_43
L_wd_44:
    ds_read_b32 v252, v20
    ds_read_b128 v[32:35], v5 offset:0
    ds_read_b128 v[48:51], v5 offset:1024
    ds_read_b128 v[64:67], v5 offset:2048
    ds_read_b128 v[80:83], v5 offset:3072
    ds_read_b128 v[96:99], v5 offset:4096
    ds_read_b128 v[36:39], v6 offset:0
    ds_read_b128 v[52:55], v6 offset:1024
    ds_read_b128 v[68:71], v6 offset:2048
    ds_read_b128 v[84:87], v6 offset:3072
    ds_read_b128 v[100:103], v6 offset:4096
    ds_read_b128 v[40:43], v254 offset:0
    ds_read_b128 v[56:59], v254 offset:1024
    ds_read_b128 v[72:75], v254 offset:2048
    ds_read_b128 v[88:91], v254 offset:3072
    ds_read_b128 v[104:107], v254 offset:4096
    s_waitcnt lgkmcnt(14)
    v_add_f32 v252, 1.0, v252
    v_rcp_f32 v252, v252
    s_waitcnt lgkmcnt(10)
    v_pk_add_f32 v[44:45], v[44:45], v[32:33]
    v_pk_add_f32 v[46:47], v[46:47], v[34:35]
    v_pk_add_f32 v[60:61], v[60:61], v[48:49]
    v_pk_add_f32 v[62:63], v[62:63], v[50:51]
    v_pk_add_f32 v[76:77], v[76:77], v[64:65]
    v_pk_add_f32 v[78:79], v[78:79], v[66:67]
    v_pk_add_f32 v[92:93], v[92:93], v[80:81]
    v_pk_add_f32 v[94:95], v[94:95], v[82:83]
    v_pk_add_f32 v[108:109], v[108:109], v[96:97]
    v_pk_add_f32 v[110:111], v[110:111], v[98:99]
    s_waitcnt lgkmcnt(5)
    s_nop 0
    v_pk_add_f32 v[44:45], v[44:45], v[36:37]
    v_pk_add_f32 v[46:47], v[46:47], v[38:39]
    v_pk_add_f32 v[60:61], v[60:61], v[52:53]
    v_pk_add_f32 v[62:63], v[62:63], v[54:55]
    v_pk_add_f32 v[76:77], v[76:77], v[68:69]
    v_pk_add_f32 v[78:79], v[78:79], v[70:71]
    v_pk_add_f32 v[92:93], v[92:93], v[84:85]
    v_pk_add_f32 v[94:95], v[94:95], v[86:87]
    v_pk_add_f32 v[108:109], v[108:109], v[100:101]
    v_pk_add_f32 v[110:111], v[110:111], v[102:103]
    s_waitcnt lgkmcnt(0)
    s_nop 0
    v_pk_add_f32 v[44:45], v[44:45], v[40:41]
    v_pk_add_f32 v[46:47], v[46:47], v[42:43]
    v_pk_add_f32 v[60:61], v[60:61], v[56:57]
    v_pk_add_f32 v[62:63], v[62:63], v[58:59]
    v_pk_add_f32 v[76:77], v[76:77], v[72:73]
    v_pk_add_f32 v[78:79], v[78:79], v[74:75]
    v_pk_add_f32 v[92:93], v[92:93], v[88:89]
    v_pk_add_f32 v[94:95], v[94:95], v[90:91]
    v_pk_add_f32 v[108:109], v[108:109], v[104:105]
    v_pk_add_f32 v[110:111], v[110:111], v[106:107]
    v_mul_f32_e64 v253, v253, v252
    v_pk_fma_f32 v[44:45], v[44:45], v[252:253], v[252:253] op_sel:[0,0,1] op_sel_hi:[1,0,1]
    v_pk_fma_f32 v[46:47], v[46:47], v[252:253], v[252:253] op_sel:[0,0,1] op_sel_hi:[1,0,1]
    v_cvt_pk_bf16_f32 v152, v44, v45
    v_cvt_pk_bf16_f32 v153, v46, v47
    ds_write_b64 v18, v[152:153] offset:16384
    v_pk_fma_f32 v[60:61], v[60:61], v[252:253], v[252:253] op_sel:[0,0,1] op_sel_hi:[1,0,1]
    v_pk_fma_f32 v[62:63], v[62:63], v[252:253], v[252:253] op_sel:[0,0,1] op_sel_hi:[1,0,1]
    v_cvt_pk_bf16_f32 v154, v60, v61
    v_cvt_pk_bf16_f32 v155, v62, v63
    ds_write_b64 v18, v[154:155] offset:16416
    v_pk_fma_f32 v[76:77], v[76:77], v[252:253], v[252:253] op_sel:[0,0,1] op_sel_hi:[1,0,1]
    v_pk_fma_f32 v[78:79], v[78:79], v[252:253], v[252:253] op_sel:[0,0,1] op_sel_hi:[1,0,1]
    v_cvt_pk_bf16_f32 v156, v76, v77
    v_cvt_pk_bf16_f32 v157, v78, v79
    ds_write_b64 v18, v[156:157] offset:16448
    v_pk_fma_f32 v[92:93], v[92:93], v[252:253], v[252:253] op_sel:[0,0,1] op_sel_hi:[1,0,1]
    v_pk_fma_f32 v[94:95], v[94:95], v[252:253], v[252:253] op_sel:[0,0,1] op_sel_hi:[1,0,1]
    v_cvt_pk_bf16_f32 v158, v92, v93
    v_cvt_pk_bf16_f32 v159, v94, v95
    ds_write_b64 v18, v[158:159] offset:16480
    v_pk_fma_f32 v[108:109], v[108:109], v[252:253], v[252:253] op_sel:[0,0,1] op_sel_hi:[1,0,1]
    v_pk_fma_f32 v[110:111], v[110:111], v[252:253], v[252:253] op_sel:[0,0,1] op_sel_hi:[1,0,1]
    v_cvt_pk_bf16_f32 v160, v108, v109
    v_cvt_pk_bf16_f32 v161, v110, v111
    ds_write_b64 v18, v[160:161] offset:16512
    ds_read_b128 v[112:115], v2 offset:16384
    ds_read_b128 v[116:119], v2 offset:17408
    ds_read_b128 v[120:123], v2 offset:18432
    s_waitcnt lgkmcnt(2)
    buffer_store_dwordx4 v[112:115], v22, s[36:39], s54 offen nt
    s_waitcnt lgkmcnt(1)
    buffer_store_dwordx4 v[116:119], v23, s[36:39], s54 offen nt
    s_waitcnt lgkmcnt(0)
    s_mov_b32 exec_hi, 0
    buffer_store_dwordx4 v[120:123], v24, s[36:39], s54 offen nt
    s_or_b32 s54, s48, s2
    s_cmp_lg_u32 s54, 0
    s_cbranch_scc1 L_notag
    s_mov_b64 exec, 1
    v_mov_b32 v5, s52
    buffer_store_dword v5, v0, s[32:35], 0 offen
L_notag:
L_end:
    s_endpgm
L_verdict:
    s_cmp_lg_u32 s63, 0
    s_cbranch_scc1 L_alast
L_wc_45:
    ds_read_b32 v5, v4 offset:72
    s_waitcnt lgkmcnt(0)
    v_readfirstlane_b32 s96, v5
    s_cmp_ge_u32 s96, 1
    s_cbranch_scc1 L_wd_46
    s_sleep 1
    s_add_u32 s97, s97, 1
    s_cmp_lt_u32 s97, 1048576
    s_cbranch_scc1 L_wc_45
L_wd_46:
    s_cmp_eq_u32 s96, 1
    s_cbranch_scc1 L_alast
    s_waitcnt vmcnt(0)
    s_mov_b32 s63, 1
    s_mov_b32 s62, 16
    s_nop 7
    s_nop 0
    v_mov_b32 v86, 0xff800000
    v_mov_b32 v87, 0xff800000
    v_mov_b32 v88, 0xff800000
    v_mov_b32 v89, 0xff800000
    v_mov_b32 v90, 0xff800000
    v_mov_b32 v91, 0xff800000
    v_mov_b32 v92, 0xff800000
    v_mov_b32 v93, 0xff800000
    s_mov_b32 s60, s4
L_tm:
    buffer_load_dwordx4 v[214:217], v1, s[32:35], s60 offen sc1
    buffer_load_dwordx2 v[218:219], v2, s[32:35], s60 offen offset:1024 sc1
    s_addk_i32 s60, 3072
    s_waitcnt vmcnt(0)
    v_mfma_f32_32x32x16_bf16 v[54:69], v[214:217], v[6:9], 0
    v_mfma_f32_32x32x8_bf16 v[54:69], v[218:219], v[10:11], v[54:69]
    s_nop 11
    v_max3_f32 v86, v86, v54, v55
    v_max3_f32 v86, v86, v56, v57
    v_max3_f32 v86, v86, v58, v59
    v_max3_f32 v86, v86, v60, v61
    v_max3_f32 v86, v86, v62, v63
    v_max3_f32 v86, v86, v64, v65
    v_max3_f32 v86, v86, v66, v67
    v_max3_f32 v86, v86, v68, v69
    v_mfma_f32_32x32x16_bf16 v[54:69], v[214:217], v[12:15], 0
    v_mfma_f32_32x32x8_bf16 v[54:69], v[218:219], v[16:17], v[54:69]
    s_nop 11
    s_nop 0
    v_max3_f32 v87, v87, v54, v55
    v_max3_f32 v87, v87, v56, v57
    v_max3_f32 v87, v87, v58, v59
    v_max3_f32 v87, v87, v60, v61
    v_max3_f32 v87, v87, v62, v63
    v_max3_f32 v87, v87, v64, v65
    v_max3_f32 v87, v87, v66, v67
    v_max3_f32 v87, v87, v68, v69
    v_mfma_f32_32x32x16_bf16 v[54:69], v[214:217], v[18:21], 0
    v_mfma_f32_32x32x8_bf16 v[54:69], v[218:219], v[22:23], v[54:69]
    s_nop 11
    s_nop 0
    v_max3_f32 v88, v88, v54, v55
    v_max3_f32 v88, v88, v56, v57
    v_max3_f32 v88, v88, v58, v59
    v_max3_f32 v88, v88, v60, v61
    v_max3_f32 v88, v88, v62, v63
    v_max3_f32 v88, v88, v64, v65
    v_max3_f32 v88, v88, v66, v67
    v_max3_f32 v88, v88, v68, v69
    v_mfma_f32_32x32x16_bf16 v[54:69], v[214:217], v[24:27], 0
    v_mfma_f32_32x32x8_bf16 v[54:69], v[218:219], v[28:29], v[54:69]
    s_nop 11
    s_nop 0
    v_max3_f32 v89, v89, v54, v55
    v_max3_f32 v89, v89, v56, v57
    v_max3_f32 v89, v89, v58, v59
    v_max3_f32 v89, v89, v60, v61
    v_max3_f32 v89, v89, v62, v63
    v_max3_f32 v89, v89, v64, v65
    v_max3_f32 v89, v89, v66, v67
    v_max3_f32 v89, v89, v68, v69
    v_mfma_f32_32x32x16_bf16 v[54:69], v[214:217], v[30:33], 0
    v_mfma_f32_32x32x8_bf16 v[54:69], v[218:219], v[34:35], v[54:69]
    s_nop 11
    s_nop 0
    v_max3_f32 v90, v90, v54, v55
    v_max3_f32 v90, v90, v56, v57
    v_max3_f32 v90, v90, v58, v59
    v_max3_f32 v90, v90, v60, v61
    v_max3_f32 v90, v90, v62, v63
    v_max3_f32 v90, v90, v64, v65
    v_max3_f32 v90, v90, v66, v67
    v_max3_f32 v90, v90, v68, v69
    v_mfma_f32_32x32x16_bf16 v[54:69], v[214:217], v[36:39], 0
    v_mfma_f32_32x32x8_bf16 v[54:69], v[218:219], v[40:41], v[54:69]
    s_nop 11
    s_nop 0
    v_max3_f32 v91, v91, v54, v55
    v_max3_f32 v91, v91, v56, v57
    v_max3_f32 v91, v91, v58, v59
    v_max3_f32 v91, v91, v60, v61
    v_max3_f32 v91, v91, v62, v63
    v_max3_f32 v91, v91, v64, v65
    v_max3_f32 v91, v91, v66, v67
    v_max3_f32 v91, v91, v68, v69
    v_mfma_f32_32x32x16_bf16 v[54:69], v[214:217], v[42:45], 0
    v_mfma_f32_32x32x8_bf16 v[54:69], v[218:219], v[46:47], v[54:69]
    s_nop 11
    s_nop 0
    v_max3_f32 v92, v92, v54, v55
    v_max3_f32 v92, v92, v56, v57
    v_max3_f32 v92, v92, v58, v59
    v_max3_f32 v92, v92, v60, v61
    v_max3_f32 v92, v92, v62, v63
    v_max3_f32 v92, v92, v64, v65
    v_max3_f32 v92, v92, v66, v67
    v_max3_f32 v92, v92, v68, v69
    v_mfma_f32_32x32x16_bf16 v[54:69], v[214:217], v[48:51], 0
    v_mfma_f32_32x32x8_bf16 v[54:69], v[218:219], v[52:53], v[54:69]
    s_nop 11
    s_nop 0
    v_max3_f32 v93, v93, v54, v55
    v_max3_f32 v93, v93, v56, v57
    v_max3_f32 v93, v93, v58, v59
    v_max3_f32 v93, v93, v60, v61
    v_max3_f32 v93, v93, v62, v63
    v_max3_f32 v93, v93, v64, v65
    v_max3_f32 v93, v93, v66, v67
    v_max3_f32 v93, v93, v68, v69
    s_sub_u32 s62, s62, 1
    s_cmp_lg_u32 s62, 0
    s_cbranch_scc1 L_tm
    v_and_b32 v5, 127, v4
    s_lshl_b32 s55, s48, 10
    v_mov_b32 v79, 0
    v_writelane_b32 v79, 1, 0
    s_add_u32 s54, s48, 1
    s_and_b32 s54, s54, 3
    s_lshl_b32 s54, s54, 8
    s_add_u32 s54, s54, 16384
    v_add_u32 v70, s54, v5
    v_add_u32 v74, s55, v70
    s_add_u32 s54, s48, 2
    s_and_b32 s54, s54, 3
    s_lshl_b32 s54, s54, 8
    s_add_u32 s54, s54, 16384
    v_add_u32 v71, s54, v5
    v_add_u32 v75, s55, v71
    s_add_u32 s54, s48, 3
    s_and_b32 s54, s54, 3
    s_lshl_b32 s54, s54, 8
    s_add_u32 s54, s54, 16384
    v_add_u32 v72, s54, v5
    v_add_u32 v76, s55, v72
    s_add_u32 s54, s48, 4
    s_and_b32 s54, s54, 3
    s_lshl_b32 s54, s54, 8
    s_add_u32 s54, s54, 16384
    v_add_u32 v73, s54, v5
    v_add_u32 v77, s55, v73
    v_mov_b32 v5, v86
    s_nop 1
    v_permlane32_swap_b32 v86, v5
    v_max_f32 v5, v5, v86
    ds_write_b32 v74, v5 offset:0
    v_mov_b32 v5, v87
    s_nop 1
    v_permlane32_swap_b32 v87, v5
    v_max_f32 v5, v5, v87
    ds_write_b32 v74, v5 offset:128
    v_mov_b32 v5, v88
    s_nop 1
    v_permlane32_swap_b32 v88, v5
    v_max_f32 v5, v5, v88
    ds_write_b32 v75, v5 offset:0
    v_mov_b32 v5, v89
    s_nop 1
    v_permlane32_swap_b32 v89, v5
    v_max_f32 v5, v5, v89
    ds_write_b32 v75, v5 offset:128
    v_mov_b32 v5, v90
    s_nop 1
    v_permlane32_swap_b32 v90, v5
    v_max_f32 v5, v5, v90
    ds_write_b32 v76, v5 offset:0
    v_mov_b32 v5, v91
    s_nop 1
    v_permlane32_swap_b32 v91, v5
    v_max_f32 v5, v5, v91
    ds_write_b32 v76, v5 offset:128
    v_mov_b32 v5, v92
    s_nop 1
    v_permlane32_swap_b32 v92, v5
    v_max_f32 v5, v5, v92
    ds_write_b32 v77, v5 offset:0
    v_mov_b32 v5, v93
    s_nop 1
    v_permlane32_swap_b32 v93, v5
    v_max_f32 v5, v5, v93
    ds_write_b32 v77, v5 offset:128
    s_waitcnt lgkmcnt(0)
    ds_add_u32 v4, v79 offset:44
L_wc_47:
    ds_read_b32 v5, v4 offset:44
    s_waitcnt lgkmcnt(0)
    v_readfirstlane_b32 s96, v5
    s_cmp_ge_u32 s96, 4
    s_cbranch_scc1 L_wd_48
    s_sleep 1
    s_add_u32 s97, s97, 1
    s_cmp_lt_u32 s97, 1048576
    s_cbranch_scc1 L_wc_47
    s_nop 0
L_wd_48:
    ds_read_b32 v86, v70 offset:0
    ds_read_b32 v87, v70 offset:1024
    ds_read_b32 v88, v70 offset:2048
    ds_read_b32 v89, v70 offset:3072
    ds_read_b32 v90, v70 offset:128
    ds_read_b32 v91, v70 offset:1152
    ds_read_b32 v92, v70 offset:2176
    ds_read_b32 v93, v70 offset:3200
    ds_read_b32 v94, v71 offset:0
    ds_read_b32 v95, v71 offset:1024
    ds_read_b32 v96, v71 offset:2048
    ds_read_b32 v97, v71 offset:3072
    ds_read_b32 v98, v71 offset:128
    ds_read_b32 v99, v71 offset:1152
    ds_read_b32 v100, v71 offset:2176
    ds_read_b32 v101, v71 offset:3200
    ds_read_b32 v102, v72 offset:0
    ds_read_b32 v103, v72 offset:1024
    ds_read_b32 v104, v72 offset:2048
    ds_read_b32 v105, v72 offset:3072
    ds_read_b32 v106, v72 offset:128
    ds_read_b32 v107, v72 offset:1152
    ds_read_b32 v108, v72 offset:2176
    ds_read_b32 v109, v72 offset:3200
    ds_read_b32 v110, v73 offset:0
    ds_read_b32 v111, v73 offset:1024
    ds_read_b32 v112, v73 offset:2048
    ds_read_b32 v113, v73 offset:3072
    ds_read_b32 v114, v73 offset:128
    ds_read_b32 v115, v73 offset:1152
    ds_read_b32 v116, v73 offset:2176
    ds_read_b32 v117, v73 offset:3200
    s_waitcnt lgkmcnt(0)
    ds_add_u32 v4, v79 offset:44
    s_mov_b32 exec_lo, 0
    v_max3_f32 v86, v86, v87, v88
    v_max_f32 v86, v86, v89
    v_and_b32 v87, 0xffff0000, v86
    v_sub_f32 v86, v86, v87
    v_and_b32 v88, 0xffff0000, v86
    v_sub_f32 v86, v86, v88
    v_cvt_pk_bf16_f32 v10, -v87, -v88
    v_cvt_pk_bf16_f32 v11, -v86, 0
    v_max3_f32 v90, v90, v91, v92
    v_max_f32 v90, v90, v93
    v_and_b32 v91, 0xffff0000, v90
    v_sub_f32 v90, v90, v91
    v_and_b32 v92, 0xffff0000, v90
    v_sub_f32 v90, v90, v92
    v_cvt_pk_bf16_f32 v16, -v91, -v92
    v_cvt_pk_bf16_f32 v17, -v90, 0
    v_max3_f32 v94, v94, v95, v96
    v_max_f32 v94, v94, v97
    v_and_b32 v95, 0xffff0000, v94
    v_sub_f32 v94, v94, v95
    v_and_b32 v96, 0xffff0000, v94
    v_sub_f32 v94, v94, v96
    v_cvt_pk_bf16_f32 v22, -v95, -v96
    v_cvt_pk_bf16_f32 v23, -v94, 0
    v_max3_f32 v98, v98, v99, v100
    v_max_f32 v98, v98, v101
    v_and_b32 v99, 0xffff0000, v98
    v_sub_f32 v98, v98, v99
    v_and_b32 v100, 0xffff0000, v98
    v_sub_f32 v98, v98, v100
    v_cvt_pk_bf16_f32 v28, -v99, -v100
    v_cvt_pk_bf16_f32 v29, -v98, 0
    v_max3_f32 v102, v102, v103, v104
    v_max_f32 v102, v102, v105
    v_and_b32 v103, 0xffff0000, v102
    v_sub_f32 v102, v102, v103
    v_and_b32 v104, 0xffff0000, v102
    v_sub_f32 v102, v102, v104
    v_cvt_pk_bf16_f32 v34, -v103, -v104
    v_cvt_pk_bf16_f32 v35, -v102, 0
    v_max3_f32 v106, v106, v107, v108
    v_max_f32 v106, v106, v109
    v_and_b32 v107, 0xffff0000, v106
    v_sub_f32 v106, v106, v107
    v_and_b32 v108, 0xffff0000, v106
    v_sub_f32 v106, v106, v108
    v_cvt_pk_bf16_f32 v40, -v107, -v108
    v_cvt_pk_bf16_f32 v41, -v106, 0
    v_max3_f32 v110, v110, v111, v112
    v_max_f32 v110, v110, v113
    v_and_b32 v111, 0xffff0000, v110
    v_sub_f32 v110, v110, v111
    v_and_b32 v112, 0xffff0000, v110
    v_sub_f32 v110, v110, v112
    v_cvt_pk_bf16_f32 v46, -v111, -v112
    v_cvt_pk_bf16_f32 v47, -v110, 0
    v_max3_f32 v114, v114, v115, v116
    v_max_f32 v114, v114, v117
    v_and_b32 v115, 0xffff0000, v114
    v_sub_f32 v114, v114, v115
    v_and_b32 v116, 0xffff0000, v114
    v_sub_f32 v114, v114, v116
    v_cvt_pk_bf16_f32 v52, -v115, -v116
    v_cvt_pk_bf16_f32 v53, -v114, 0
    v_subrev_u32 v2, 1073740032, v2
    s_mov_b32 exec_lo, -1
L_wc_49:
    ds_read_b32 v5, v4 offset:44
    s_waitcnt lgkmcnt(0)
    v_readfirstlane_b32 s96, v5
    s_cmp_ge_u32 s96, 8
    s_cbranch_scc1 L_wd_50
    s_sleep 1
    s_add_u32 s97, s97, 1
    s_cmp_lt_u32 s97, 1048576
    s_cbranch_scc1 L_wc_49
L_wd_50:
    v_mov_b64 v[84:85], 0
    s_nop 1
    v_mfma_f32_32x32x8_bf16 v[86:101], v[84:85], v[84:85], 0
    v_mfma_f32_32x32x8_bf16 v[102:117], v[84:85], v[84:85], 0
    v_mfma_f32_32x32x8_bf16 v[118:133], v[84:85], v[84:85], 0
    v_mfma_f32_32x32x8_bf16 v[134:149], v[84:85], v[84:85], 0
    v_mfma_f32_32x32x8_bf16 v[150:165], v[84:85], v[84:85], 0
    v_mfma_f32_32x32x8_bf16 v[166:181], v[84:85], v[84:85], 0
    v_mfma_f32_32x32x8_bf16 v[182:197], v[84:85], v[84:85], 0
    v_mfma_f32_32x32x8_bf16 v[198:213], v[84:85], v[84:85], 0
    buffer_load_dwordx4 v[214:217], v1, s[32:35], s4 offen sc1
    buffer_load_dwordx2 v[218:219], v2, s[32:35], s4 offen offset:1024 sc1
    buffer_load_dwordx4 v[220:223], v3, s[32:35], s4 offen offset:1280 sc1
    buffer_load_dwordx4 v[224:227], v3, s[32:35], s4 offen offset:1952 sc1
    buffer_load_dwordx4 v[228:231], v1, s[32:35], s5 offen sc1
    buffer_load_dwordx2 v[232:233], v2, s[32:35], s5 offen offset:1024 sc1
    buffer_load_dwordx4 v[234:237], v3, s[32:35], s5 offen offset:1280 sc1
    buffer_load_dwordx4 v[238:241], v3, s[32:35], s5 offen offset:1952 sc1
    s_branch L_astart
L_last:
    s_endpgm
.section .rodata,"a"
.p2align 6
.amdhsa_kernel gated_mix__grouped_kv_mqa__mixer_token_mlp__prompt_kernel
  .amdhsa_next_free_vgpr 256
  .amdhsa_next_free_sgpr 102
  .amdhsa_accum_offset 256
  .amdhsa_group_segment_fixed_size 0
  .amdhsa_kernarg_size 112
  .amdhsa_user_sgpr_count 2
  .amdhsa_user_sgpr_kernarg_segment_ptr 1
  .amdhsa_system_sgpr_workgroup_id_x 1
.end_amdhsa_kernel
```
